```python
import torch

def _softmax(x, axis=-1):
    return torch.softmax(x, dim=axis)
def _gelu(x):
    return torch.nn.functional.gelu(x, approximate="tanh")
def _silu(x):
    return torch.nn.functional.silu(x)
def _sigmoid(x):
    return torch.sigmoid(x)
def _layernorm(x, axis=-1, eps=1e-5):
    m = x.mean(dim=axis, keepdim=True)
    v = x.var(dim=axis, keepdim=True, unbiased=False)
    return (x - m) / torch.sqrt(v + eps)
def _scatter_add(tgt, idx, src, axis=0):
    return tgt.clone().index_add_(axis, idx, src)
def _segment_sum(src, seg, n):
    out = torch.zeros((n,) + src.shape[1:], dtype=src.dtype)
    return out.index_add_(0, seg, src)
def _pad(x, pw):
    flat = tuple(v for pair in reversed(pw) for v in pair)
    return torch.nn.functional.pad(x, flat)

kernel_name = 'parallel_sum__sliding_local_dilated__mixer_channel_mlp__prompt'

def setup_inputs():

    _w = (lambda a: (lambda t: t.to(torch.bfloat16) if t.is_floating_point() else t)(torch.as_tensor(a)))
    def _A_setup():
        B, S, D = 1, 2048, 640
        return {
            "x": _w((lambda *s: torch.randn(*s, dtype=torch.bfloat16) * 0.05)(B, S, D)),
            "wqkv": _w((lambda *s: torch.randn(*s, dtype=torch.bfloat16) * 0.05)(D, 3 * D)),
            "wo": _w((lambda *s: torch.randn(*s, dtype=torch.bfloat16) * 0.05)(D, D)),
        }
    _A_in = _A_setup()

    def _B_setup():
        B, S, D, F = 1, 2048, 640, 1536
        return {
            "x": _w((lambda *s: torch.randn(*s, dtype=torch.bfloat16) * 0.05)(B, S, D)),
            "w1": _w((lambda *s: torch.randn(*s, dtype=torch.bfloat16) * 3.2)(D, F) * (D ** -0.5)),
            "b1": _w((lambda *s: torch.randn(*s, dtype=torch.bfloat16) * 1.6)(F)),
            "w2": _w((lambda *s: torch.randn(*s, dtype=torch.bfloat16) * 0.2)(F, D) * (F ** -0.5)),
            "b2": _w((lambda *s: torch.randn(*s, dtype=torch.bfloat16) * 0.4)(D)),
        }
    _B_in = _B_setup()

    return {
        "A_x": _A_in["x"],
        "A_wqkv": _A_in["wqkv"],
        "A_wo": _A_in["wo"],
        "B_x": _B_in["x"],
        "B_w1": _B_in["w1"],
        "B_b1": _B_in["b1"],
        "B_w2": _B_in["w2"],
        "B_b2": _B_in["b2"],
    }

def reference(A_x, A_wqkv, A_wo, B_x, B_w1, B_b1, B_w2, B_b2):
    def _A_ref(x, wqkv, wo):
        B, S, D = x.shape
        H = 32; Dh = D // H
        W, dil = 8, 2
        qkv = (lambda x, *d: x.permute(*d))((x @ wqkv).reshape(B, S, 3, H, Dh), 2, 0, 3, 1, 4)
        q, k, v = qkv[0], qkv[1], qkv[2]
        scale = Dh ** -0.5
        pos = torch.arange(S)
        off = torch.arange(W) * dil
        idx = pos[:, None] - off[None, :]
        mask = idx >= 0
        idx_c = torch.where(mask, idx, 0).reshape(-1)
        kg = k[:, :, idx_c, :].reshape(B, H, S, W, Dh)
        vg = v[:, :, idx_c, :].reshape(B, H, S, W, Dh)
        logits = torch.einsum("bhsd,bhswd->bhsw", q, kg) * scale
        logits = torch.where(mask[None, None, :, :], logits, -1e9)
        attn = _softmax(logits, axis=-1)
        o = torch.einsum("bhsw,bhswd->bhsd", attn, vg)
        return (lambda x, *d: x.permute(*d))(o, 0, 2, 1, 3).reshape(B, S, D) @ wo

    def _B_ref(x, w1, b1, w2, b2):
        y = _layernorm(x, axis=-1)
        h = _gelu(torch.einsum("bsd,df->bsf", y, w1) + b1)
        return torch.einsum("bsf,fd->bsd", h, w2) + b2

    x = A_x
    xn = _layernorm(x, axis=-1)
    return x + _A_ref(xn, A_wqkv, A_wo) + _B_ref(xn, B_w1, B_b1, B_w2, B_b2)
```

```asm
; @launch grid=(256,1,1) block=(512,1,1) lds=151552
.amdgcn_target "amdgcn-amd-amdhsa--gfx950"
.text
.globl parallel_sum__sliding_local_dilated__mixer_channel_mlp__prompt_kernel
.p2align 8
.type parallel_sum__sliding_local_dilated__mixer_channel_mlp__prompt_kernel,@function
parallel_sum__sliding_local_dilated__mixer_channel_mlp__prompt_kernel:
    s_cmp_ge_u32 s2, 256
    s_cbranch_scc1 K1_END
    s_load_dwordx4 s[4:7], s[0:1], 0
    s_load_dwordx4 s[28:31], s[0:1], 32
    s_load_dwordx2 s[34:35], s[0:1], 80
    s_load_dwordx2 s[74:75], s[0:1], 16
    s_load_dwordx2 s[76:77], s[0:1], 48
    s_and_b32 s38, s2, 7
    s_lshr_b32 s37, s2, 3
    s_and_b32 s36, s37, 1
    s_lshr_b32 s37, s37, 1
    s_lshl_b32 s40, s37, 7
    v_lshrrev_b32 v4, 6, v0
    v_and_b32 v1, 63, v0
    v_readfirstlane_b32 s39, v4
    v_and_b32 v2, 15, v1
    v_lshrrev_b32 v3, 4, v1
    s_lshr_b32 s43, s39, 2
    s_and_b32 s44, s39, 3
    s_lshl_b32 s45, s39, 10
    s_getpc_b64 s[46:47]
K1_PC:
    s_sub_u32 s46, s46, K1_PC-parallel_sum__sliding_local_dilated__mixer_channel_mlp__prompt_kernel
    s_subb_u32 s47, s47, 0
    v_lshlrev_b32 v4, 7, v0
    v_min_u32 v5, K1_END-parallel_sum__sliding_local_dilated__mixer_channel_mlp__prompt_kernel, v4
    global_load_dword v243, v5, s[46:47]
    v_add_u32 v4, 65536, v4
    v_min_u32 v5, K1_END-parallel_sum__sliding_local_dilated__mixer_channel_mlp__prompt_kernel, v4
    global_load_dword v243, v5, s[46:47]
    s_cmp_eq_u32 s36, 1
    s_cbranch_scc1 K1_MLP
    s_mul_i32 s42, s38, 160
    s_movk_i32 s41, 1280
    s_add_u32 s46, s39, 0
    s_lshl_b32 s47, s46, 6
    v_add_u32 v4, s47, v1
    v_mul_u32_u24 v5, 2185, v4
    v_lshrrev_b32 v5, 16, v5
    v_mul_u32_u24 v6, 30, v5
    v_sub_u32 v4, v4, v6
    v_mul_u32_u24 v6, 205, v4
    v_lshrrev_b32 v6, 11, v6
    v_mul_u32_u24 v7, 10, v6
    v_sub_u32 v4, v4, v7
    v_mul_u32_u24 v6, 1280, v6
    v_lshl_add_u32 v4, v4, 4, v6
    v_and_b32 v6, 0xfffffff3, v5
    v_and_b32 v7, 4, v5
    v_lshl_or_b32 v6, v7, 1, v6
    v_and_b32 v7, 8, v5
    v_lshrrev_b32 v7, 1, v7
    v_or_b32 v6, v6, v7
    v_mul_u32_u24 v6, 3840, v6
    v_add3_u32 v8, v6, v4, s42
    v_mov_b32 v12, v8
    s_add_u32 s46, s39, 8
    s_lshl_b32 s47, s46, 6
    v_add_u32 v4, s47, v1
    v_mul_u32_u24 v5, 2185, v4
    v_lshrrev_b32 v5, 16, v5
    v_mul_u32_u24 v6, 30, v5
    v_sub_u32 v4, v4, v6
    v_mul_u32_u24 v6, 205, v4
    v_lshrrev_b32 v6, 11, v6
    v_mul_u32_u24 v7, 10, v6
    v_sub_u32 v4, v4, v7
    v_mul_u32_u24 v6, 1280, v6
    v_lshl_add_u32 v4, v4, 4, v6
    v_and_b32 v6, 0xfffffff3, v5
    v_and_b32 v7, 4, v5
    v_lshl_or_b32 v6, v7, 1, v6
    v_and_b32 v7, 8, v5
    v_lshrrev_b32 v7, 1, v7
    v_or_b32 v6, v6, v7
    v_mul_u32_u24 v6, 3840, v6
    v_add3_u32 v8, v6, v4, s42
    s_sub_u32 s47, s46, 15
    s_lshl_b32 s47, s47, 3
    v_lshrrev_b32 v4, 3, v1
    v_add_u32 v4, s47, v4
    v_and_b32 v5, 7, v1
    v_and_b32 v6, 7, v4
    v_xor_b32 v5, v5, v6
    s_sub_u32 s47, s40, 16
    v_add_u32 v4, s47, v4
    v_mul_lo_u32 v4, v4, s41
    v_lshl_add_u32 v9, v5, 4, v4
    s_cmp_lt_u32 s46, 15
    s_cselect_b64 vcc, -1, 0
    v_cndmask_b32 v13, v9, v8, vcc
    s_add_u32 s46, s39, 16
    s_sub_u32 s47, s46, 15
    s_lshl_b32 s47, s47, 3
    v_lshrrev_b32 v4, 3, v1
    v_add_u32 v4, s47, v4
    v_and_b32 v5, 7, v1
    v_and_b32 v6, 7, v4
    v_xor_b32 v5, v5, v6
    s_sub_u32 s47, s40, 16
    v_add_u32 v4, s47, v4
    v_mul_lo_u32 v4, v4, s41
    v_lshl_add_u32 v9, v5, 4, v4
    v_mov_b32 v14, v9
    v_add_u32 v16, 92160, v14
    v_add_u32 v4, 92160, v13
    s_add_u32 s46, s39, 8
    s_cmp_lt_u32 s46, 15
    s_cselect_b64 vcc, -1, 0
    v_cndmask_b32 v15, v4, v13, vcc
    s_waitcnt lgkmcnt(0)
    s_mov_b32 s8, s4
    s_and_b32 s9, s5, 0xffff
    s_mov_b32 s10, 2621440
    s_mov_b32 s11, 0x00020000
    s_mov_b32 s12, s6
    s_and_b32 s13, s7, 0xffff
    s_mov_b32 s14, 2457600
    s_mov_b32 s15, 0x00020000
    s_mov_b32 s20, s34
    s_and_b32 s21, s35, 0xffff
    s_mov_b32 s22, 8912896
    s_mov_b32 s23, 0x00020000
    s_add_u32 s46, s39, 8
    s_cmp_lt_u32 s46, 15
    s_cselect_b32 s53, 1, 0
    s_cselect_b32 s16, s12, s8
    s_cselect_b32 s17, s13, s9
    s_cselect_b32 s18, s14, s10
    s_cselect_b32 s19, s15, s11
    s_mov_b32 s46, 0
    s_add_u32 m0, s45, 73728
    s_nop 0
    buffer_load_dwordx4 v12, s[12:15], s46 offen lds
    s_cmp_lg_u32 s53, 0
    s_mov_b32 s46, 0
    s_cmov_b32 s46, 0
    s_mov_b32 s47, 4294960128
    s_cmov_b32 s47, 81920
    s_add_u32 m0, s45, s47
    s_nop 0
    buffer_load_dwordx4 v13, s[16:19], s46 offen lds
    s_mov_b32 s46, 0
    s_add_u32 m0, s45, 1024
    s_nop 0
    buffer_load_dwordx4 v14, s[8:11], s46 offen lds
    s_mov_b32 s46, 122880
    s_add_u32 m0, s45, 89088
    s_nop 0
    buffer_load_dwordx4 v12, s[12:15], s46 offen lds
    s_cmp_lg_u32 s53, 0
    s_mov_b32 s46, 0
    s_cmov_b32 s46, 122880
    s_mov_b32 s47, 2048
    s_cmov_b32 s47, 97280
    s_add_u32 m0, s45, s47
    s_nop 0
    buffer_load_dwordx4 v15, s[16:19], s46 offen lds
    s_mov_b32 s46, 0
    s_add_u32 m0, s45, 10240
    s_nop 0
    buffer_load_dwordx4 v16, s[8:11], s46 offen lds
    v_and_b32 v4, 7, v2
    v_add_u32 v5, 0, v3
    v_xor_b32 v5, v5, v4
    v_lshlrev_b32 v5, 4, v5
    v_lshl_add_u32 v6, v2, 7, v5
    v_add_u32 v5, 4, v3
    v_xor_b32 v5, v5, v4
    v_lshlrev_b32 v5, 4, v5
    v_lshl_add_u32 v7, v2, 7, v5
    s_lshl_b32 s46, s43, 2
    s_add_u32 s47, s44, 0
    s_and_b32 s47, s47, 3
    s_add_u32 s47, s47, s46
    s_lshl_b32 s47, s47, 11
    s_add_u32 s47, s47, 2048
    v_add_u32 v17, s47, v6
    v_add_u32 v18, s47, v7
    s_add_u32 s47, s44, 1
    s_and_b32 s47, s47, 3
    s_add_u32 s47, s47, s46
    s_lshl_b32 s47, s47, 11
    s_add_u32 s47, s47, 2048
    v_add_u32 v19, s47, v6
    v_add_u32 v20, s47, v7
    s_add_u32 s47, s44, 2
    s_and_b32 s47, s47, 3
    s_add_u32 s47, s47, s46
    s_lshl_b32 s47, s47, 11
    s_add_u32 s47, s47, 2048
    v_add_u32 v21, s47, v6
    v_add_u32 v22, s47, v7
    s_add_u32 s47, s44, 3
    s_and_b32 s47, s47, 3
    s_add_u32 s47, s47, s46
    s_lshl_b32 s47, s47, 11
    s_add_u32 s47, s47, 2048
    v_add_u32 v23, s47, v6
    v_add_u32 v24, s47, v7
    v_mov_b32 v25, v6
    v_mov_b32 v26, v7
    v_lshrrev_b32 v4, 1, v3
    v_lshlrev_b32 v4, 4, v4
    v_and_b32 v5, 1, v3
    v_lshl_add_u32 v4, v5, 2, v4
    v_bfe_u32 v5, v1, 2, 2
    v_add_u32 v4, v4, v5
    v_bfe_u32 v5, v4, 1, 2
    v_mul_u32_u24 v4, 480, v4
    v_and_b32 v6, 3, v1
    v_lshl_add_u32 v4, v6, 3, v4
    v_add_u32 v4, 73728, v4
    s_lshl_b32 s47, s43, 1
    s_add_u32 s47, s47, 0
    s_and_b32 s47, s47, 3
    s_lshl_b32 s46, s44, 2
    s_add_u32 s56, s47, s46
    s_lshl_b32 s47, s56, 5
    v_add_u32 v27, s47, v4
    s_lshl_b32 s47, s43, 1
    s_add_u32 s47, s47, 1
    s_and_b32 s47, s47, 3
    s_lshl_b32 s46, s44, 2
    s_add_u32 s57, s47, s46
    s_lshl_b32 s47, s57, 5
    v_add_u32 v28, s47, v4
    s_lshl_b32 s47, s43, 1
    s_add_u32 s47, s47, 2
    s_and_b32 s47, s47, 3
    s_lshl_b32 s46, s44, 2
    s_add_u32 s58, s47, s46
    s_lshl_b32 s47, s58, 5
    v_add_u32 v29, s47, v4
    s_lshl_b32 s47, s43, 1
    s_add_u32 s47, s47, 3
    s_and_b32 s47, s47, 3
    s_lshl_b32 s46, s44, 2
    s_add_u32 s59, s47, s46
    s_lshl_b32 s47, s59, 5
    v_add_u32 v30, s47, v4
    v_add_u32 v31, 76800, v27
    v_add_u32 v32, 76800, v28
    v_add_u32 v33, 76800, v29
    v_add_u32 v34, 76800, v30
    v_mov_b32 v64, 0
    v_mov_b32 v65, 0
    v_mov_b32 v66, 0
    v_mov_b32 v67, 0
    v_mov_b32 v68, 0
    v_mov_b32 v69, 0
    v_mov_b32 v70, 0
    v_mov_b32 v71, 0
    v_mov_b32 v72, 0
    v_mov_b32 v73, 0
    v_mov_b32 v74, 0
    v_mov_b32 v75, 0
    v_mov_b32 v76, 0
    v_mov_b32 v77, 0
    v_mov_b32 v78, 0
    v_mov_b32 v79, 0
    v_mov_b32 v80, 0
    v_mov_b32 v81, 0
    v_mov_b32 v82, 0
    v_mov_b32 v83, 0
    v_mov_b32 v84, 0
    v_mov_b32 v85, 0
    v_mov_b32 v86, 0
    v_mov_b32 v87, 0
    v_mov_b32 v88, 0
    v_mov_b32 v89, 0
    v_mov_b32 v90, 0
    v_mov_b32 v91, 0
    v_mov_b32 v92, 0
    v_mov_b32 v93, 0
    v_mov_b32 v94, 0
    v_mov_b32 v95, 0
    v_mov_b32 v96, 0
    v_mov_b32 v97, 0
    v_mov_b32 v98, 0
    v_mov_b32 v99, 0
    v_mov_b32 v100, 0
    v_mov_b32 v101, 0
    v_mov_b32 v102, 0
    v_mov_b32 v103, 0
    v_mov_b32 v104, 0
    v_mov_b32 v105, 0
    v_mov_b32 v106, 0
    v_mov_b32 v107, 0
    v_mov_b32 v108, 0
    v_mov_b32 v109, 0
    v_mov_b32 v110, 0
    v_mov_b32 v111, 0
    v_mov_b32 v112, 0
    v_mov_b32 v113, 0
    v_mov_b32 v114, 0
    v_mov_b32 v115, 0
    v_mov_b32 v116, 0
    v_mov_b32 v117, 0
    v_mov_b32 v118, 0
    v_mov_b32 v119, 0
    v_mov_b32 v120, 0
    v_mov_b32 v121, 0
    v_mov_b32 v122, 0
    v_mov_b32 v123, 0
    v_mov_b32 v124, 0
    v_mov_b32 v125, 0
    v_mov_b32 v126, 0
    v_mov_b32 v127, 0
    v_mov_b32 v128, 0
    v_mov_b32 v129, 0
    v_mov_b32 v130, 0
    v_mov_b32 v131, 0
    v_mov_b32 v132, 0
    v_mov_b32 v133, 0
    v_mov_b32 v134, 0
    v_mov_b32 v135, 0
    v_mov_b32 v36, 0
    v_mov_b32 v37, 0
    v_mov_b32 v38, 0
    v_mov_b32 v39, 0
    v_mov_b32 v40, 0
    v_mov_b32 v41, 0
    v_mov_b32 v42, 0
    v_mov_b32 v43, 0
    v_mov_b32 v44, 0
    v_mov_b32 v45, 0
    v_mov_b32 v46, 0
    v_mov_b32 v47, 0
    v_mov_b32 v48, 0
    v_mov_b32 v49, 0
    v_mov_b32 v50, 0
    v_mov_b32 v51, 0
    v_mov_b32 v52, 0x3f803f80
    v_mov_b32 v53, 0x3f803f80
    v_mov_b32 v54, 0x3f803f80
    v_mov_b32 v55, 0x3f803f80
    v_cmp_eq_u32 s[54:55], 0, v2
    s_mov_b32 s60, 0x3f803f80
    s_and_b32 s46, s2, 7
    s_lshl_b32 s46, s46, 4
    s_lshr_b32 s47, s2, 4
    s_add_u32 s46, s46, s47
    s_add_u32 s46, s46, 0
    s_lshl_b32 s46, s46, 7
    s_add_u32 s46, s46, 16777216
    v_mov_b32 v4, s46
    v_mov_b32 v5, 2146435072
    v_cmp_eq_u32 vcc, 0, v0
    v_mov_b32 v6, 0
    v_mov_b32 v7, 0
    v_cndmask_b32 v4, v5, v4, vcc
    s_mov_b32 s92, s34
    s_and_b32 s93, s35, 0xffff
    s_mov_b32 s94, 33554432
    s_mov_b32 s95, 0x00020000
    buffer_store_dwordx2 v[6:7], v4, s[92:95], 0 offen sc1
    v_mul_u32_u24 v4, 10923, v1
    v_lshrrev_b32 v4, 16, v4
    v_mul_u32_u24 v5, 6, v4
    v_sub_u32 v5, v1, v5
    s_mul_i32 s46, s37, 40
    s_mul_i32 s47, s39, 5
    s_add_u32 s46, s46, s47
    v_add_u32 v4, s46, v4
    v_mul_u32_u24 v4, 3840, v4
    v_lshrrev_b32 v6, 1, v5
    v_and_b32 v5, 1, v5
    v_mul_u32_u24 v6, 1280, v6
    v_mul_u32_u24 v5, 156, v5
    v_add3_u32 v4, v4, v5, v6
    v_add_u32 v4, s42, v4
    v_mov_b32 v7, 2146435072
    v_cmp_gt_u32 vcc, 30, v1
    s_nop 1
    v_cndmask_b32 v4, v7, v4, vcc
    buffer_load_dword v11, v4, s[12:15], 0 offen
    s_lshl_b32 s46, s38, 1
    s_add_u32 s46, s46, s36
    s_mul_i32 s46, s46, 80
    s_mul_i32 s47, s39, 10
    s_add_u32 s46, s46, s47
    s_mul_i32 s47, s40, 10
    s_add_u32 s46, s46, s47
    v_add_u32 v4, s46, v1
    v_lshlrev_b32 v4, 7, v4
    v_cmp_gt_u32 vcc, 10, v1
    s_nop 1
    v_cndmask_b32 v4, v7, v4, vcc
    buffer_load_dword v11, v4, s[8:11], 0 offen
    s_waitcnt vmcnt(3)
    s_barrier
    ds_read_b64_tr_b16 v[176:177], v27 offset:0
    ds_read_b64_tr_b16 v[178:179], v27 offset:3840
    ds_read_b64_tr_b16 v[180:181], v28 offset:0
    ds_read_b64_tr_b16 v[182:183], v28 offset:3840
    ds_read_b64_tr_b16 v[184:185], v29 offset:0
    ds_read_b64_tr_b16 v[186:187], v29 offset:3840
    ds_read_b64_tr_b16 v[188:189], v30 offset:0
    ds_read_b64_tr_b16 v[190:191], v30 offset:3840
    ds_read_b128 v[136:139], v17 offset:0
    ds_read_b128 v[140:143], v19 offset:0
    ds_read_b128 v[144:147], v21 offset:0
    ds_read_b128 v[148:151], v23 offset:0
    ds_read_b128 v[152:155], v25 offset:0
    s_waitcnt lgkmcnt(0)
    s_barrier
    v_mfma_f32_16x16x32_bf16 v[64:67], v[176:179], v[136:139], v[64:67]
    ds_read_b64_tr_b16 v[192:193], v27 offset:15360
    ds_read_b64_tr_b16 v[194:195], v27 offset:19200
    ds_read_b64_tr_b16 v[196:197], v28 offset:15360
    v_mfma_f32_16x16x32_bf16 v[68:71], v[176:179], v[140:143], v[68:71]
    ds_read_b64_tr_b16 v[198:199], v28 offset:19200
    ds_read_b64_tr_b16 v[200:201], v29 offset:15360
    ds_read_b64_tr_b16 v[202:203], v29 offset:19200
    v_mfma_f32_16x16x32_bf16 v[72:75], v[176:179], v[144:147], v[72:75]
    ds_read_b64_tr_b16 v[204:205], v30 offset:15360
    ds_read_b64_tr_b16 v[206:207], v30 offset:19200
    ds_read_b128 v[156:159], v18 offset:0
    v_mfma_f32_16x16x32_bf16 v[76:79], v[176:179], v[148:151], v[76:79]
    ds_read_b128 v[160:163], v20 offset:0
    ds_read_b128 v[164:167], v22 offset:0
    v_mfma_f32_16x16x32_bf16 v[80:83], v[180:183], v[136:139], v[80:83]
    ds_read_b128 v[168:171], v24 offset:0
    ds_read_b128 v[172:175], v26 offset:0
    s_mov_b32 s46, 245760
    v_mfma_f32_16x16x32_bf16 v[84:87], v[180:183], v[140:143], v[84:87]
    s_add_u32 m0, s45, 104448
    s_nop 0
    buffer_load_dwordx4 v12, s[12:15], s46 offen lds
    v_mfma_f32_16x16x32_bf16 v[88:91], v[180:183], v[144:147], v[88:91]
    s_cmp_lg_u32 s53, 0
    s_mov_b32 s46, 128
    s_cmov_b32 s46, 245760
    v_mfma_f32_16x16x32_bf16 v[92:95], v[180:183], v[148:151], v[92:95]
    s_mov_b32 s47, 11264
    s_cmov_b32 s47, 112640
    v_mfma_f32_16x16x32_bf16 v[96:99], v[184:187], v[136:139], v[96:99]
    s_add_u32 m0, s45, s47
    s_nop 0
    buffer_load_dwordx4 v13, s[16:19], s46 offen lds
    v_mfma_f32_16x16x32_bf16 v[100:103], v[184:187], v[140:143], v[100:103]
    s_mov_b32 s46, 128
    s_add_u32 m0, s45, 19456
    s_nop 0
    v_mfma_f32_16x16x32_bf16 v[104:107], v[184:187], v[144:147], v[104:107]
    buffer_load_dwordx4 v14, s[8:11], s46 offen lds
    s_mov_b32 s46, 368640
    v_mfma_f32_16x16x32_bf16 v[108:111], v[184:187], v[148:151], v[108:111]
    s_add_u32 m0, s45, 119808
    s_nop 0
    buffer_load_dwordx4 v12, s[12:15], s46 offen lds
    v_mfma_f32_16x16x32_bf16 v[112:115], v[188:191], v[136:139], v[112:115]
    s_cmp_lg_u32 s53, 0
    s_mov_b32 s46, 128
    s_cmov_b32 s46, 368640
    v_mfma_f32_16x16x32_bf16 v[116:119], v[188:191], v[140:143], v[116:119]
    s_mov_b32 s47, 20480
    s_cmov_b32 s47, 128000
    s_add_u32 m0, s45, s47
    v_mfma_f32_16x16x32_bf16 v[120:123], v[188:191], v[144:147], v[120:123]
    s_nop 0
    buffer_load_dwordx4 v15, s[16:19], s46 offen lds
    v_mfma_f32_16x16x32_bf16 v[124:127], v[188:191], v[148:151], v[124:127]
    s_mov_b32 s46, 128
    s_add_u32 m0, s45, 28672
    s_nop 0
    v_mfma_f32_16x16x32_bf16 v[36:39], v[52:55], v[136:139], v[36:39]
    buffer_load_dwordx4 v16, s[8:11], s46 offen lds
    v_cndmask_b32 v152, v152, v52, s[54:55]
    v_cndmask_b32 v153, v153, v52, s[54:55]
    v_mfma_f32_16x16x32_bf16 v[40:43], v[136:139], v[136:139], v[40:43]
    v_cndmask_b32 v154, v154, v52, s[54:55]
    v_cndmask_b32 v155, v155, v52, s[54:55]
    s_nop 1
    v_mfma_f32_16x16x32_bf16 v[128:131], v[176:179], v[152:155], v[128:131]
    v_mfma_f32_16x16x32_bf16 v[132:135], v[180:183], v[152:155], v[132:135]
    s_cmp_lg_u32 s39, 7
    s_cbranch_scc1 HS_1
    v_mfma_f32_16x16x32_bf16 v[44:47], v[52:55], v[152:155], v[44:47]
    v_mfma_f32_16x16x32_bf16 v[48:51], v[152:155], v[152:155], v[48:51]
HS_1:
    s_waitcnt vmcnt(0) lgkmcnt(0)
    s_barrier
    v_mfma_f32_16x16x32_bf16 v[64:67], v[192:195], v[156:159], v[64:67]
    ds_read_b64_tr_b16 v[176:177], v27 offset:30720
    ds_read_b64_tr_b16 v[178:179], v27 offset:34560
    ds_read_b64_tr_b16 v[180:181], v28 offset:30720
    v_mfma_f32_16x16x32_bf16 v[68:71], v[192:195], v[160:163], v[68:71]
    ds_read_b64_tr_b16 v[182:183], v28 offset:34560
    ds_read_b64_tr_b16 v[184:185], v29 offset:30720
    ds_read_b64_tr_b16 v[186:187], v29 offset:34560
    v_mfma_f32_16x16x32_bf16 v[72:75], v[192:195], v[164:167], v[72:75]
    ds_read_b64_tr_b16 v[188:189], v30 offset:30720
    ds_read_b64_tr_b16 v[190:191], v30 offset:34560
    ds_read_b128 v[136:139], v17 offset:18432
    v_mfma_f32_16x16x32_bf16 v[76:79], v[192:195], v[168:171], v[76:79]
    ds_read_b128 v[140:143], v19 offset:18432
    ds_read_b128 v[144:147], v21 offset:18432
    v_mfma_f32_16x16x32_bf16 v[80:83], v[196:199], v[156:159], v[80:83]
    ds_read_b128 v[148:151], v23 offset:18432
    ds_read_b128 v[152:155], v25 offset:18432
    s_mov_b32 s46, 491520
    v_mfma_f32_16x16x32_bf16 v[84:87], v[196:199], v[160:163], v[84:87]
    s_add_u32 m0, s45, 135168
    s_nop 0
    buffer_load_dwordx4 v12, s[12:15], s46 offen lds
    v_mfma_f32_16x16x32_bf16 v[88:91], v[196:199], v[164:167], v[88:91]
    s_cmp_lg_u32 s53, 0
    s_mov_b32 s46, 256
    s_cmov_b32 s46, 491520
    v_mfma_f32_16x16x32_bf16 v[92:95], v[196:199], v[168:171], v[92:95]
    s_mov_b32 s47, 29696
    s_cmov_b32 s47, 143360
    v_mfma_f32_16x16x32_bf16 v[96:99], v[200:203], v[156:159], v[96:99]
    s_add_u32 m0, s45, s47
    s_nop 0
    buffer_load_dwordx4 v13, s[16:19], s46 offen lds
    v_mfma_f32_16x16x32_bf16 v[100:103], v[200:203], v[160:163], v[100:103]
    s_mov_b32 s46, 256
    s_add_u32 m0, s45, 37888
    s_nop 0
    v_mfma_f32_16x16x32_bf16 v[104:107], v[200:203], v[164:167], v[104:107]
    buffer_load_dwordx4 v14, s[8:11], s46 offen lds
    s_mov_b32 s46, 614400
    v_mfma_f32_16x16x32_bf16 v[108:111], v[200:203], v[168:171], v[108:111]
    s_add_u32 m0, s45, 73728
    s_nop 0
    buffer_load_dwordx4 v12, s[12:15], s46 offen lds
    v_mfma_f32_16x16x32_bf16 v[112:115], v[204:207], v[156:159], v[112:115]
    s_cmp_lg_u32 s53, 0
    s_mov_b32 s46, 256
    s_cmov_b32 s46, 614400
    v_mfma_f32_16x16x32_bf16 v[116:119], v[204:207], v[160:163], v[116:119]
    s_mov_b32 s47, 38912
    s_cmov_b32 s47, 81920
    s_add_u32 m0, s45, s47
    v_mfma_f32_16x16x32_bf16 v[120:123], v[204:207], v[164:167], v[120:123]
    s_nop 0
    buffer_load_dwordx4 v15, s[16:19], s46 offen lds
    v_mfma_f32_16x16x32_bf16 v[124:127], v[204:207], v[168:171], v[124:127]
    s_mov_b32 s46, 256
    s_add_u32 m0, s45, 47104
    s_nop 0
    v_mfma_f32_16x16x32_bf16 v[36:39], v[52:55], v[156:159], v[36:39]
    buffer_load_dwordx4 v16, s[8:11], s46 offen lds
    v_cndmask_b32 v172, v172, v52, s[54:55]
    v_cndmask_b32 v173, v173, v52, s[54:55]
    v_mfma_f32_16x16x32_bf16 v[40:43], v[156:159], v[156:159], v[40:43]
    v_cndmask_b32 v174, v174, v52, s[54:55]
    v_cndmask_b32 v175, v175, v52, s[54:55]
    s_nop 1
    v_mfma_f32_16x16x32_bf16 v[128:131], v[192:195], v[172:175], v[128:131]
    v_mfma_f32_16x16x32_bf16 v[132:135], v[196:199], v[172:175], v[132:135]
    s_cmp_lg_u32 s39, 7
    s_cbranch_scc1 HS_2
    v_mfma_f32_16x16x32_bf16 v[44:47], v[52:55], v[172:175], v[44:47]
    v_mfma_f32_16x16x32_bf16 v[48:51], v[172:175], v[172:175], v[48:51]
HS_2:
    s_waitcnt lgkmcnt(0)
    s_barrier
    v_mfma_f32_16x16x32_bf16 v[64:67], v[176:179], v[136:139], v[64:67]
    ds_read_b64_tr_b16 v[192:193], v27 offset:46080
    ds_read_b64_tr_b16 v[194:195], v27 offset:49920
    ds_read_b64_tr_b16 v[196:197], v28 offset:46080
    v_mfma_f32_16x16x32_bf16 v[68:71], v[176:179], v[140:143], v[68:71]
    ds_read_b64_tr_b16 v[198:199], v28 offset:49920
    ds_read_b64_tr_b16 v[200:201], v29 offset:46080
    v_mfma_f32_16x16x32_bf16 v[72:75], v[176:179], v[144:147], v[72:75]
    ds_read_b64_tr_b16 v[202:203], v29 offset:49920
    ds_read_b64_tr_b16 v[204:205], v30 offset:46080
    ds_read_b64_tr_b16 v[206:207], v30 offset:49920
    v_mfma_f32_16x16x32_bf16 v[76:79], v[176:179], v[148:151], v[76:79]
    ds_read_b128 v[156:159], v18 offset:18432
    ds_read_b128 v[160:163], v20 offset:18432
    v_mfma_f32_16x16x32_bf16 v[80:83], v[180:183], v[136:139], v[80:83]
    ds_read_b128 v[164:167], v22 offset:18432
    ds_read_b128 v[168:171], v24 offset:18432
    ds_read_b128 v[172:175], v26 offset:18432
    v_mfma_f32_16x16x32_bf16 v[84:87], v[180:183], v[140:143], v[84:87]
    s_mov_b32 s46, 737280
    s_add_u32 m0, s45, 89088
    v_mfma_f32_16x16x32_bf16 v[88:91], v[180:183], v[144:147], v[88:91]
    s_nop 0
    buffer_load_dwordx4 v12, s[12:15], s46 offen lds
    s_cmp_lg_u32 s53, 0
    v_mfma_f32_16x16x32_bf16 v[92:95], v[180:183], v[148:151], v[92:95]
    s_mov_b32 s46, 384
    s_cmov_b32 s46, 737280
    v_mfma_f32_16x16x32_bf16 v[96:99], v[184:187], v[136:139], v[96:99]
    s_mov_b32 s47, 48128
    s_cmov_b32 s47, 97280
    s_add_u32 m0, s45, s47
    v_mfma_f32_16x16x32_bf16 v[100:103], v[184:187], v[140:143], v[100:103]
    s_nop 0
    buffer_load_dwordx4 v13, s[16:19], s46 offen lds
    v_mfma_f32_16x16x32_bf16 v[104:107], v[184:187], v[144:147], v[104:107]
    s_mov_b32 s46, 384
    s_add_u32 m0, s45, 56320
    s_nop 0
    v_mfma_f32_16x16x32_bf16 v[108:111], v[184:187], v[148:151], v[108:111]
    buffer_load_dwordx4 v14, s[8:11], s46 offen lds
    s_cmp_lg_u32 s53, 0
    v_mfma_f32_16x16x32_bf16 v[112:115], v[188:191], v[136:139], v[112:115]
    s_mov_b32 s46, 384
    s_cmov_b32 s46, 2146435072
    s_mov_b32 s47, 57344
    v_mfma_f32_16x16x32_bf16 v[116:119], v[188:191], v[140:143], v[116:119]
    s_cmov_b32 s47, 196608
    s_add_u32 m0, s45, s47
    v_mfma_f32_16x16x32_bf16 v[120:123], v[188:191], v[144:147], v[120:123]
    s_nop 0
    buffer_load_dwordx4 v15, s[16:19], s46 offen lds
    s_mov_b32 s46, 384
    v_mfma_f32_16x16x32_bf16 v[124:127], v[188:191], v[148:151], v[124:127]
    s_add_u32 m0, s45, 65536
    s_nop 0
    v_mfma_f32_16x16x32_bf16 v[36:39], v[52:55], v[136:139], v[36:39]
    buffer_load_dwordx4 v16, s[8:11], s46 offen lds
    v_cndmask_b32 v152, v152, v52, s[54:55]
    v_cndmask_b32 v153, v153, v52, s[54:55]
    v_mfma_f32_16x16x32_bf16 v[40:43], v[136:139], v[136:139], v[40:43]
    v_cndmask_b32 v154, v154, v52, s[54:55]
    v_cndmask_b32 v155, v155, v52, s[54:55]
    s_nop 1
    v_mfma_f32_16x16x32_bf16 v[128:131], v[176:179], v[152:155], v[128:131]
    v_mfma_f32_16x16x32_bf16 v[132:135], v[180:183], v[152:155], v[132:135]
    s_cmp_lg_u32 s39, 7
    s_cbranch_scc1 HS_3
    v_mfma_f32_16x16x32_bf16 v[44:47], v[52:55], v[152:155], v[44:47]
    v_mfma_f32_16x16x32_bf16 v[48:51], v[152:155], v[152:155], v[48:51]
HS_3:
    s_waitcnt vmcnt(5) lgkmcnt(0)
    s_barrier
    v_mfma_f32_16x16x32_bf16 v[64:67], v[192:195], v[156:159], v[64:67]
    ds_read_b64_tr_b16 v[176:177], v27 offset:61440
    ds_read_b64_tr_b16 v[178:179], v27 offset:65280
    ds_read_b64_tr_b16 v[180:181], v28 offset:61440
    v_mfma_f32_16x16x32_bf16 v[68:71], v[192:195], v[160:163], v[68:71]
    ds_read_b64_tr_b16 v[182:183], v28 offset:65280
    ds_read_b64_tr_b16 v[184:185], v29 offset:61440
    v_mfma_f32_16x16x32_bf16 v[72:75], v[192:195], v[164:167], v[72:75]
    ds_read_b64_tr_b16 v[186:187], v29 offset:65280
    ds_read_b64_tr_b16 v[188:189], v30 offset:61440
    ds_read_b64_tr_b16 v[190:191], v30 offset:65280
    v_mfma_f32_16x16x32_bf16 v[76:79], v[192:195], v[168:171], v[76:79]
    ds_read_b128 v[136:139], v17 offset:36864
    ds_read_b128 v[140:143], v19 offset:36864
    v_mfma_f32_16x16x32_bf16 v[80:83], v[196:199], v[156:159], v[80:83]
    ds_read_b128 v[144:147], v21 offset:36864
    ds_read_b128 v[148:151], v23 offset:36864
    ds_read_b128 v[152:155], v25 offset:36864
    v_mfma_f32_16x16x32_bf16 v[84:87], v[196:199], v[160:163], v[84:87]
    s_mov_b32 s46, 860160
    s_add_u32 m0, s45, 104448
    v_mfma_f32_16x16x32_bf16 v[88:91], v[196:199], v[164:167], v[88:91]
    s_nop 0
    buffer_load_dwordx4 v12, s[12:15], s46 offen lds
    s_cmp_lg_u32 s53, 0
    v_mfma_f32_16x16x32_bf16 v[92:95], v[196:199], v[168:171], v[92:95]
    s_mov_b32 s46, 512
    s_cmov_b32 s46, 860160
    v_mfma_f32_16x16x32_bf16 v[96:99], v[200:203], v[156:159], v[96:99]
    s_mov_b32 s47, 4294960128
    s_cmov_b32 s47, 112640
    s_add_u32 m0, s45, s47
    v_mfma_f32_16x16x32_bf16 v[100:103], v[200:203], v[160:163], v[100:103]
    s_nop 0
    buffer_load_dwordx4 v13, s[16:19], s46 offen lds
    v_mfma_f32_16x16x32_bf16 v[104:107], v[200:203], v[164:167], v[104:107]
    s_mov_b32 s46, 512
    s_add_u32 m0, s45, 1024
    s_nop 0
    v_mfma_f32_16x16x32_bf16 v[108:111], v[200:203], v[168:171], v[108:111]
    buffer_load_dwordx4 v14, s[8:11], s46 offen lds
    s_cmp_lg_u32 s53, 0
    v_mfma_f32_16x16x32_bf16 v[112:115], v[204:207], v[156:159], v[112:115]
    s_mov_b32 s46, 512
    s_cmov_b32 s46, 2146435072
    s_mov_b32 s47, 2048
    v_mfma_f32_16x16x32_bf16 v[116:119], v[204:207], v[160:163], v[116:119]
    s_cmov_b32 s47, 196608
    s_add_u32 m0, s45, s47
    v_mfma_f32_16x16x32_bf16 v[120:123], v[204:207], v[164:167], v[120:123]
    s_nop 0
    buffer_load_dwordx4 v15, s[16:19], s46 offen lds
    s_mov_b32 s46, 512
    v_mfma_f32_16x16x32_bf16 v[124:127], v[204:207], v[168:171], v[124:127]
    s_add_u32 m0, s45, 10240
    s_nop 0
    v_mfma_f32_16x16x32_bf16 v[36:39], v[52:55], v[156:159], v[36:39]
    buffer_load_dwordx4 v16, s[8:11], s46 offen lds
    v_cndmask_b32 v172, v172, v52, s[54:55]
    v_cndmask_b32 v173, v173, v52, s[54:55]
    v_mfma_f32_16x16x32_bf16 v[40:43], v[156:159], v[156:159], v[40:43]
    v_cndmask_b32 v174, v174, v52, s[54:55]
    v_cndmask_b32 v175, v175, v52, s[54:55]
    s_nop 1
    v_mfma_f32_16x16x32_bf16 v[128:131], v[192:195], v[172:175], v[128:131]
    v_mfma_f32_16x16x32_bf16 v[132:135], v[196:199], v[172:175], v[132:135]
    s_cmp_lg_u32 s39, 7
    s_cbranch_scc1 HS_4
    v_mfma_f32_16x16x32_bf16 v[44:47], v[52:55], v[172:175], v[44:47]
    v_mfma_f32_16x16x32_bf16 v[48:51], v[172:175], v[172:175], v[48:51]
HS_4:
    s_waitcnt lgkmcnt(0)
    s_barrier
    v_mfma_f32_16x16x32_bf16 v[64:67], v[176:179], v[136:139], v[64:67]
    ds_read_b64_tr_b16 v[192:193], v27 offset:0
    ds_read_b64_tr_b16 v[194:195], v27 offset:3840
    v_mfma_f32_16x16x32_bf16 v[68:71], v[176:179], v[140:143], v[68:71]
    ds_read_b64_tr_b16 v[196:197], v28 offset:0
    ds_read_b64_tr_b16 v[198:199], v28 offset:3840
    v_mfma_f32_16x16x32_bf16 v[72:75], v[176:179], v[144:147], v[72:75]
    ds_read_b64_tr_b16 v[200:201], v29 offset:0
    ds_read_b64_tr_b16 v[202:203], v29 offset:3840
    v_mfma_f32_16x16x32_bf16 v[76:79], v[176:179], v[148:151], v[76:79]
    ds_read_b64_tr_b16 v[204:205], v30 offset:0
    ds_read_b64_tr_b16 v[206:207], v30 offset:3840
    v_mfma_f32_16x16x32_bf16 v[80:83], v[180:183], v[136:139], v[80:83]
    ds_read_b128 v[156:159], v18 offset:36864
    ds_read_b128 v[160:163], v20 offset:36864
    v_mfma_f32_16x16x32_bf16 v[84:87], v[180:183], v[140:143], v[84:87]
    ds_read_b128 v[164:167], v22 offset:36864
    v_mfma_f32_16x16x32_bf16 v[88:91], v[180:183], v[144:147], v[88:91]
    ds_read_b128 v[168:171], v24 offset:36864
    ds_read_b128 v[172:175], v26 offset:36864
    v_mfma_f32_16x16x32_bf16 v[92:95], v[180:183], v[148:151], v[92:95]
    s_mov_b32 s46, 983040
    s_add_u32 m0, s45, 119808
    v_mfma_f32_16x16x32_bf16 v[96:99], v[184:187], v[136:139], v[96:99]
    s_nop 0
    buffer_load_dwordx4 v12, s[12:15], s46 offen lds
    v_mfma_f32_16x16x32_bf16 v[100:103], v[184:187], v[140:143], v[100:103]
    s_cmp_lg_u32 s53, 0
    s_mov_b32 s46, 640
    v_mfma_f32_16x16x32_bf16 v[104:107], v[184:187], v[144:147], v[104:107]
    s_cmov_b32 s46, 983040
    s_mov_b32 s47, 11264
    v_mfma_f32_16x16x32_bf16 v[108:111], v[184:187], v[148:151], v[108:111]
    s_cmov_b32 s47, 128000
    v_mfma_f32_16x16x32_bf16 v[112:115], v[188:191], v[136:139], v[112:115]
    s_add_u32 m0, s45, s47
    s_nop 0
    v_mfma_f32_16x16x32_bf16 v[116:119], v[188:191], v[140:143], v[116:119]
    buffer_load_dwordx4 v13, s[16:19], s46 offen lds
    s_mov_b32 s46, 640
    v_mfma_f32_16x16x32_bf16 v[120:123], v[188:191], v[144:147], v[120:123]
    s_add_u32 m0, s45, 19456
    s_nop 0
    v_mfma_f32_16x16x32_bf16 v[124:127], v[188:191], v[148:151], v[124:127]
    buffer_load_dwordx4 v14, s[8:11], s46 offen lds
    v_cndmask_b32 v152, v152, v52, s[54:55]
    v_mfma_f32_16x16x32_bf16 v[36:39], v[52:55], v[136:139], v[36:39]
    v_cndmask_b32 v153, v153, v52, s[54:55]
    v_cndmask_b32 v154, v154, v52, s[54:55]
    v_mfma_f32_16x16x32_bf16 v[40:43], v[136:139], v[136:139], v[40:43]
    v_cndmask_b32 v155, v155, v52, s[54:55]
    s_nop 1
    v_mfma_f32_16x16x32_bf16 v[128:131], v[176:179], v[152:155], v[128:131]
    v_mfma_f32_16x16x32_bf16 v[132:135], v[180:183], v[152:155], v[132:135]
    s_cmp_lg_u32 s39, 7
    s_cbranch_scc1 HS_5
    v_mfma_f32_16x16x32_bf16 v[44:47], v[52:55], v[152:155], v[44:47]
    v_mfma_f32_16x16x32_bf16 v[48:51], v[152:155], v[152:155], v[48:51]
HS_5:
    s_waitcnt vmcnt(8) lgkmcnt(0)
    s_barrier
    v_mfma_f32_16x16x32_bf16 v[64:67], v[192:195], v[156:159], v[64:67]
    ds_read_b64_tr_b16 v[176:177], v27 offset:15360
    ds_read_b64_tr_b16 v[178:179], v27 offset:19200
    v_mfma_f32_16x16x32_bf16 v[68:71], v[192:195], v[160:163], v[68:71]
    ds_read_b64_tr_b16 v[180:181], v28 offset:15360
    ds_read_b64_tr_b16 v[182:183], v28 offset:19200
    v_mfma_f32_16x16x32_bf16 v[72:75], v[192:195], v[164:167], v[72:75]
    ds_read_b64_tr_b16 v[184:185], v29 offset:15360
    ds_read_b64_tr_b16 v[186:187], v29 offset:19200
    v_mfma_f32_16x16x32_bf16 v[76:79], v[192:195], v[168:171], v[76:79]
    ds_read_b64_tr_b16 v[188:189], v30 offset:15360
    ds_read_b64_tr_b16 v[190:191], v30 offset:19200
    v_mfma_f32_16x16x32_bf16 v[80:83], v[196:199], v[156:159], v[80:83]
    ds_read_b128 v[136:139], v17 offset:55296
    ds_read_b128 v[140:143], v19 offset:55296
    v_mfma_f32_16x16x32_bf16 v[84:87], v[196:199], v[160:163], v[84:87]
    ds_read_b128 v[144:147], v21 offset:55296
    ds_read_b128 v[148:151], v23 offset:55296
    v_mfma_f32_16x16x32_bf16 v[88:91], v[196:199], v[164:167], v[88:91]
    ds_read_b128 v[152:155], v25 offset:55296
    s_mov_b32 s46, 1105920
    v_mfma_f32_16x16x32_bf16 v[92:95], v[196:199], v[168:171], v[92:95]
    s_add_u32 m0, s45, 135168
    s_nop 0
    v_mfma_f32_16x16x32_bf16 v[96:99], v[200:203], v[156:159], v[96:99]
    buffer_load_dwordx4 v12, s[12:15], s46 offen lds
    v_mfma_f32_16x16x32_bf16 v[100:103], v[200:203], v[160:163], v[100:103]
    s_cmp_lg_u32 s53, 0
    s_mov_b32 s46, 640
    v_mfma_f32_16x16x32_bf16 v[104:107], v[200:203], v[164:167], v[104:107]
    s_cmov_b32 s46, 1105920
    s_mov_b32 s47, 20480
    v_mfma_f32_16x16x32_bf16 v[108:111], v[200:203], v[168:171], v[108:111]
    s_cmov_b32 s47, 143360
    s_add_u32 m0, s45, s47
    v_mfma_f32_16x16x32_bf16 v[112:115], v[204:207], v[156:159], v[112:115]
    s_nop 0
    buffer_load_dwordx4 v15, s[16:19], s46 offen lds
    v_mfma_f32_16x16x32_bf16 v[116:119], v[204:207], v[160:163], v[116:119]
    s_mov_b32 s46, 640
    s_add_u32 m0, s45, 28672
    v_mfma_f32_16x16x32_bf16 v[120:123], v[204:207], v[164:167], v[120:123]
    s_nop 0
    buffer_load_dwordx4 v16, s[8:11], s46 offen lds
    v_mfma_f32_16x16x32_bf16 v[124:127], v[204:207], v[168:171], v[124:127]
    s_load_dwordx2 s[92:93], s[0:1], 72
    v_cndmask_b32 v172, v172, v52, s[54:55]
    v_mfma_f32_16x16x32_bf16 v[36:39], v[52:55], v[156:159], v[36:39]
    v_cndmask_b32 v173, v173, v52, s[54:55]
    v_cndmask_b32 v174, v174, v52, s[54:55]
    v_mfma_f32_16x16x32_bf16 v[40:43], v[156:159], v[156:159], v[40:43]
    v_cndmask_b32 v175, v175, v52, s[54:55]
    s_nop 1
    v_mfma_f32_16x16x32_bf16 v[128:131], v[192:195], v[172:175], v[128:131]
    v_mfma_f32_16x16x32_bf16 v[132:135], v[196:199], v[172:175], v[132:135]
    s_cmp_lg_u32 s39, 7
    s_cbranch_scc1 HS_6
    v_mfma_f32_16x16x32_bf16 v[44:47], v[52:55], v[172:175], v[44:47]
    v_mfma_f32_16x16x32_bf16 v[48:51], v[172:175], v[172:175], v[48:51]
HS_6:
    s_waitcnt vmcnt(8) lgkmcnt(0)
    s_barrier
    v_mfma_f32_16x16x32_bf16 v[64:67], v[176:179], v[136:139], v[64:67]
    ds_read_b64_tr_b16 v[192:193], v27 offset:30720
    ds_read_b64_tr_b16 v[194:195], v27 offset:34560
    ds_read_b64_tr_b16 v[196:197], v28 offset:30720
    v_mfma_f32_16x16x32_bf16 v[68:71], v[176:179], v[140:143], v[68:71]
    ds_read_b64_tr_b16 v[198:199], v28 offset:34560
    ds_read_b64_tr_b16 v[200:201], v29 offset:30720
    v_mfma_f32_16x16x32_bf16 v[72:75], v[176:179], v[144:147], v[72:75]
    ds_read_b64_tr_b16 v[202:203], v29 offset:34560
    ds_read_b64_tr_b16 v[204:205], v30 offset:30720
    ds_read_b64_tr_b16 v[206:207], v30 offset:34560
    v_mfma_f32_16x16x32_bf16 v[76:79], v[176:179], v[148:151], v[76:79]
    ds_read_b128 v[156:159], v18 offset:55296
    ds_read_b128 v[160:163], v20 offset:55296
    v_mfma_f32_16x16x32_bf16 v[80:83], v[180:183], v[136:139], v[80:83]
    ds_read_b128 v[164:167], v22 offset:55296
    ds_read_b128 v[168:171], v24 offset:55296
    v_mfma_f32_16x16x32_bf16 v[84:87], v[180:183], v[140:143], v[84:87]
    ds_read_b128 v[172:175], v26 offset:55296
    s_mov_b32 s46, 1228800
    s_add_u32 m0, s45, 73728
    v_mfma_f32_16x16x32_bf16 v[88:91], v[180:183], v[144:147], v[88:91]
    s_nop 0
    buffer_load_dwordx4 v12, s[12:15], s46 offen lds
    v_mfma_f32_16x16x32_bf16 v[92:95], v[180:183], v[148:151], v[92:95]
    s_cmp_lg_u32 s53, 0
    s_mov_b32 s46, 768
    s_cmov_b32 s46, 1228800
    v_mfma_f32_16x16x32_bf16 v[96:99], v[184:187], v[136:139], v[96:99]
    s_mov_b32 s47, 29696
    s_cmov_b32 s47, 81920
    v_mfma_f32_16x16x32_bf16 v[100:103], v[184:187], v[140:143], v[100:103]
    s_add_u32 m0, s45, s47
    s_nop 0
    v_mfma_f32_16x16x32_bf16 v[104:107], v[184:187], v[144:147], v[104:107]
    buffer_load_dwordx4 v13, s[16:19], s46 offen lds
    s_mov_b32 s46, 768
    s_add_u32 m0, s45, 37888
    v_mfma_f32_16x16x32_bf16 v[108:111], v[184:187], v[148:151], v[108:111]
    s_nop 0
    buffer_load_dwordx4 v14, s[8:11], s46 offen lds
    v_mfma_f32_16x16x32_bf16 v[112:115], v[188:191], v[136:139], v[112:115]
    s_mov_b32 s92, s92
    s_and_b32 s93, s93, 0xffff
    s_mov_b32 s94, 256
    v_mfma_f32_16x16x32_bf16 v[116:119], v[188:191], v[140:143], v[116:119]
    s_mov_b32 s95, 0x00020000
    v_mov_b32 v9, 2146435072
    v_mfma_f32_16x16x32_bf16 v[120:123], v[188:191], v[144:147], v[120:123]
    v_cmp_eq_u32 vcc, 0, v0
    v_mov_b32 v10, 1
    v_mfma_f32_16x16x32_bf16 v[124:127], v[188:191], v[148:151], v[124:127]
    s_nop 0
    v_cndmask_b32 v9, v9, 0, vcc
    buffer_atomic_add v10, v9, s[92:95], 0 offen
    v_mfma_f32_16x16x32_bf16 v[36:39], v[52:55], v[136:139], v[36:39]
    v_cndmask_b32 v152, v152, v52, s[54:55]
    v_cndmask_b32 v153, v153, v52, s[54:55]
    v_mfma_f32_16x16x32_bf16 v[40:43], v[136:139], v[136:139], v[40:43]
    v_cndmask_b32 v154, v154, v52, s[54:55]
    v_cndmask_b32 v155, v155, v52, s[54:55]
    s_nop 1
    v_mfma_f32_16x16x32_bf16 v[128:131], v[176:179], v[152:155], v[128:131]
    v_mfma_f32_16x16x32_bf16 v[132:135], v[180:183], v[152:155], v[132:135]
    s_cmp_lg_u32 s39, 7
    s_cbranch_scc1 HS_7
    v_mfma_f32_16x16x32_bf16 v[44:47], v[52:55], v[152:155], v[44:47]
    v_mfma_f32_16x16x32_bf16 v[48:51], v[152:155], v[152:155], v[48:51]
HS_7:
    s_waitcnt vmcnt(7) lgkmcnt(0)
    s_barrier
    v_mfma_f32_16x16x32_bf16 v[64:67], v[192:195], v[156:159], v[64:67]
    ds_read_b64_tr_b16 v[176:177], v27 offset:46080
    ds_read_b64_tr_b16 v[178:179], v27 offset:49920
    ds_read_b64_tr_b16 v[180:181], v28 offset:46080
    ds_read_b64_tr_b16 v[182:183], v28 offset:49920
    v_mfma_f32_16x16x32_bf16 v[68:71], v[192:195], v[160:163], v[68:71]
    ds_read_b64_tr_b16 v[184:185], v29 offset:46080
    ds_read_b64_tr_b16 v[186:187], v29 offset:49920
    ds_read_b64_tr_b16 v[188:189], v30 offset:46080
    v_mfma_f32_16x16x32_bf16 v[72:75], v[192:195], v[164:167], v[72:75]
    ds_read_b64_tr_b16 v[190:191], v30 offset:49920
    ds_read_b128 v[136:139], v17 offset:0
    ds_read_b128 v[140:143], v19 offset:0
    v_mfma_f32_16x16x32_bf16 v[76:79], v[192:195], v[168:171], v[76:79]
    ds_read_b128 v[144:147], v21 offset:0
    ds_read_b128 v[148:151], v23 offset:0
    ds_read_b128 v[152:155], v25 offset:0
    v_mfma_f32_16x16x32_bf16 v[80:83], v[196:199], v[156:159], v[80:83]
    s_mov_b32 s46, 1351680
    s_add_u32 m0, s45, 89088
    s_nop 0
    buffer_load_dwordx4 v12, s[12:15], s46 offen lds
    v_mfma_f32_16x16x32_bf16 v[84:87], v[196:199], v[160:163], v[84:87]
    s_cmp_lg_u32 s53, 0
    s_mov_b32 s46, 768
    s_cmov_b32 s46, 1351680
    v_mfma_f32_16x16x32_bf16 v[88:91], v[196:199], v[164:167], v[88:91]
    s_mov_b32 s47, 38912
    s_cmov_b32 s47, 97280
    s_add_u32 m0, s45, s47
    v_mfma_f32_16x16x32_bf16 v[92:95], v[196:199], v[168:171], v[92:95]
    s_nop 0
    buffer_load_dwordx4 v15, s[16:19], s46 offen lds
    s_mov_b32 s46, 768
    v_mfma_f32_16x16x32_bf16 v[96:99], v[200:203], v[156:159], v[96:99]
    s_add_u32 m0, s45, 47104
    s_nop 0
    buffer_load_dwordx4 v16, s[8:11], s46 offen lds
    v_mfma_f32_16x16x32_bf16 v[100:103], v[200:203], v[160:163], v[100:103]
    v_mov_b32 v7, 2146435072
    s_mov_b32 s68, s74
    s_and_b32 s69, s75, 0xffff
    s_mov_b32 s70, 819200
    v_mfma_f32_16x16x32_bf16 v[104:107], v[200:203], v[164:167], v[104:107]
    s_mov_b32 s71, 0x00020000
    s_mov_b32 s76, s76
    s_and_b32 s77, s77, 0xffff
    v_mfma_f32_16x16x32_bf16 v[108:111], v[200:203], v[168:171], v[108:111]
    s_mov_b32 s78, 1966080
    s_mov_b32 s79, 0x00020000
    s_mul_i32 s46, s2, 25
    v_mfma_f32_16x16x32_bf16 v[112:115], v[204:207], v[156:159], v[112:115]
    s_mul_i32 s47, s2, 60
    v_add_u32 v4, s46, v1
    v_lshlrev_b32 v4, 7, v4
    v_mfma_f32_16x16x32_bf16 v[116:119], v[204:207], v[160:163], v[116:119]
    v_cmp_gt_u32 vcc, 25, v1
    s_cmp_eq_u32 s39, 0
    s_cselect_b64 s[48:49], vcc, 0
    v_add_u32 v5, s47, v1
    v_mfma_f32_16x16x32_bf16 v[120:123], v[204:207], v[164:167], v[120:123]
    v_lshlrev_b32 v5, 7, v5
    v_cmp_gt_u32 vcc, 60, v1
    s_cmp_eq_u32 s39, 1
    v_mfma_f32_16x16x32_bf16 v[124:127], v[204:207], v[168:171], v[124:127]
    s_cselect_b64 s[50:51], vcc, 0
    v_cndmask_b32 v4, v7, v4, s[48:49]
    v_cndmask_b32 v5, v7, v5, s[50:51]
    v_mfma_f32_16x16x32_bf16 v[36:39], v[52:55], v[156:159], v[36:39]
    buffer_load_dword v11, v4, s[68:71], 0 offen
    buffer_load_dword v11, v5, s[76:79], 0 offen
    v_cndmask_b32 v172, v172, v52, s[54:55]
    v_mfma_f32_16x16x32_bf16 v[40:43], v[156:159], v[156:159], v[40:43]
    v_cndmask_b32 v173, v173, v52, s[54:55]
    v_cndmask_b32 v174, v174, v52, s[54:55]
    v_cndmask_b32 v175, v175, v52, s[54:55]
    s_nop 1
    v_mfma_f32_16x16x32_bf16 v[128:131], v[192:195], v[172:175], v[128:131]
    v_mfma_f32_16x16x32_bf16 v[132:135], v[196:199], v[172:175], v[132:135]
    s_cmp_lg_u32 s39, 7
    s_cbranch_scc1 HS_8
    v_mfma_f32_16x16x32_bf16 v[44:47], v[52:55], v[172:175], v[44:47]
    v_mfma_f32_16x16x32_bf16 v[48:51], v[172:175], v[172:175], v[48:51]
HS_8:
    s_waitcnt vmcnt(9) lgkmcnt(0)
    s_barrier
    v_mfma_f32_16x16x32_bf16 v[64:67], v[176:179], v[136:139], v[64:67]
    ds_read_b64_tr_b16 v[192:193], v27 offset:61440
    ds_read_b64_tr_b16 v[194:195], v27 offset:65280
    v_mfma_f32_16x16x32_bf16 v[68:71], v[176:179], v[140:143], v[68:71]
    ds_read_b64_tr_b16 v[196:197], v28 offset:61440
    ds_read_b64_tr_b16 v[198:199], v28 offset:65280
    v_mfma_f32_16x16x32_bf16 v[72:75], v[176:179], v[144:147], v[72:75]
    ds_read_b64_tr_b16 v[200:201], v29 offset:61440
    ds_read_b64_tr_b16 v[202:203], v29 offset:65280
    v_mfma_f32_16x16x32_bf16 v[76:79], v[176:179], v[148:151], v[76:79]
    ds_read_b64_tr_b16 v[204:205], v30 offset:61440
    ds_read_b64_tr_b16 v[206:207], v30 offset:65280
    v_mfma_f32_16x16x32_bf16 v[80:83], v[180:183], v[136:139], v[80:83]
    ds_read_b128 v[156:159], v18 offset:0
    ds_read_b128 v[160:163], v20 offset:0
    v_mfma_f32_16x16x32_bf16 v[84:87], v[180:183], v[140:143], v[84:87]
    ds_read_b128 v[164:167], v22 offset:0
    v_mfma_f32_16x16x32_bf16 v[88:91], v[180:183], v[144:147], v[88:91]
    ds_read_b128 v[168:171], v24 offset:0
    ds_read_b128 v[172:175], v26 offset:0
    v_mfma_f32_16x16x32_bf16 v[92:95], v[180:183], v[148:151], v[92:95]
    s_mov_b32 s46, 1474560
    s_add_u32 m0, s45, 104448
    v_mfma_f32_16x16x32_bf16 v[96:99], v[184:187], v[136:139], v[96:99]
    s_nop 0
    buffer_load_dwordx4 v12, s[12:15], s46 offen lds
    v_mfma_f32_16x16x32_bf16 v[100:103], v[184:187], v[140:143], v[100:103]
    s_cmp_lg_u32 s53, 0
    s_mov_b32 s46, 896
    v_mfma_f32_16x16x32_bf16 v[104:107], v[184:187], v[144:147], v[104:107]
    s_cmov_b32 s46, 1474560
    s_mov_b32 s47, 48128
    v_mfma_f32_16x16x32_bf16 v[108:111], v[184:187], v[148:151], v[108:111]
    s_cmov_b32 s47, 112640
    v_mfma_f32_16x16x32_bf16 v[112:115], v[188:191], v[136:139], v[112:115]
    s_add_u32 m0, s45, s47
    s_nop 0
    v_mfma_f32_16x16x32_bf16 v[116:119], v[188:191], v[140:143], v[116:119]
    buffer_load_dwordx4 v13, s[16:19], s46 offen lds
    s_mov_b32 s46, 896
    v_mfma_f32_16x16x32_bf16 v[120:123], v[188:191], v[144:147], v[120:123]
    s_add_u32 m0, s45, 56320
    s_nop 0
    v_mfma_f32_16x16x32_bf16 v[124:127], v[188:191], v[148:151], v[124:127]
    buffer_load_dwordx4 v14, s[8:11], s46 offen lds
    v_cndmask_b32 v152, v152, v52, s[54:55]
    v_mfma_f32_16x16x32_bf16 v[36:39], v[52:55], v[136:139], v[36:39]
    v_cndmask_b32 v153, v153, v52, s[54:55]
    v_cndmask_b32 v154, v154, v52, s[54:55]
    v_mfma_f32_16x16x32_bf16 v[40:43], v[136:139], v[136:139], v[40:43]
    v_cndmask_b32 v155, v155, v52, s[54:55]
    s_nop 1
    v_mfma_f32_16x16x32_bf16 v[128:131], v[176:179], v[152:155], v[128:131]
    v_mfma_f32_16x16x32_bf16 v[132:135], v[180:183], v[152:155], v[132:135]
    s_cmp_lg_u32 s39, 7
    s_cbranch_scc1 HS_9
    v_mfma_f32_16x16x32_bf16 v[44:47], v[52:55], v[152:155], v[44:47]
    v_mfma_f32_16x16x32_bf16 v[48:51], v[152:155], v[152:155], v[48:51]
HS_9:
    s_waitcnt vmcnt(9) lgkmcnt(0)
    s_barrier
    v_mfma_f32_16x16x32_bf16 v[64:67], v[192:195], v[156:159], v[64:67]
    ds_read_b64_tr_b16 v[176:177], v27 offset:0
    ds_read_b64_tr_b16 v[178:179], v27 offset:3840
    v_mfma_f32_16x16x32_bf16 v[68:71], v[192:195], v[160:163], v[68:71]
    ds_read_b64_tr_b16 v[180:181], v28 offset:0
    ds_read_b64_tr_b16 v[182:183], v28 offset:3840
    v_mfma_f32_16x16x32_bf16 v[72:75], v[192:195], v[164:167], v[72:75]
    ds_read_b64_tr_b16 v[184:185], v29 offset:0
    ds_read_b64_tr_b16 v[186:187], v29 offset:3840
    v_mfma_f32_16x16x32_bf16 v[76:79], v[192:195], v[168:171], v[76:79]
    ds_read_b64_tr_b16 v[188:189], v30 offset:0
    ds_read_b64_tr_b16 v[190:191], v30 offset:3840
    v_mfma_f32_16x16x32_bf16 v[80:83], v[196:199], v[156:159], v[80:83]
    ds_read_b128 v[136:139], v17 offset:18432
    ds_read_b128 v[140:143], v19 offset:18432
    v_mfma_f32_16x16x32_bf16 v[84:87], v[196:199], v[160:163], v[84:87]
    ds_read_b128 v[144:147], v21 offset:18432
    v_mfma_f32_16x16x32_bf16 v[88:91], v[196:199], v[164:167], v[88:91]
    ds_read_b128 v[148:151], v23 offset:18432
    ds_read_b128 v[152:155], v25 offset:18432
    v_mfma_f32_16x16x32_bf16 v[92:95], v[196:199], v[168:171], v[92:95]
    s_mov_b32 s46, 1597440
    s_add_u32 m0, s45, 119808
    v_mfma_f32_16x16x32_bf16 v[96:99], v[200:203], v[156:159], v[96:99]
    s_nop 0
    buffer_load_dwordx4 v12, s[12:15], s46 offen lds
    v_mfma_f32_16x16x32_bf16 v[100:103], v[200:203], v[160:163], v[100:103]
    s_cmp_lg_u32 s53, 0
    s_mov_b32 s46, 896
    v_mfma_f32_16x16x32_bf16 v[104:107], v[200:203], v[164:167], v[104:107]
    s_cmov_b32 s46, 1597440
    s_mov_b32 s47, 57344
    v_mfma_f32_16x16x32_bf16 v[108:111], v[200:203], v[168:171], v[108:111]
    s_cmov_b32 s47, 128000
    v_mfma_f32_16x16x32_bf16 v[112:115], v[204:207], v[156:159], v[112:115]
    s_add_u32 m0, s45, s47
    s_nop 0
    v_mfma_f32_16x16x32_bf16 v[116:119], v[204:207], v[160:163], v[116:119]
    buffer_load_dwordx4 v15, s[16:19], s46 offen lds
    s_mov_b32 s46, 896
    v_mfma_f32_16x16x32_bf16 v[120:123], v[204:207], v[164:167], v[120:123]
    s_add_u32 m0, s45, 65536
    s_nop 0
    v_mfma_f32_16x16x32_bf16 v[124:127], v[204:207], v[168:171], v[124:127]
    buffer_load_dwordx4 v16, s[8:11], s46 offen lds
    v_cndmask_b32 v172, v172, v52, s[54:55]
    v_mfma_f32_16x16x32_bf16 v[36:39], v[52:55], v[156:159], v[36:39]
    v_cndmask_b32 v173, v173, v52, s[54:55]
    v_cndmask_b32 v174, v174, v52, s[54:55]
    v_mfma_f32_16x16x32_bf16 v[40:43], v[156:159], v[156:159], v[40:43]
    v_cndmask_b32 v175, v175, v52, s[54:55]
    s_nop 1
    v_mfma_f32_16x16x32_bf16 v[128:131], v[192:195], v[172:175], v[128:131]
    v_mfma_f32_16x16x32_bf16 v[132:135], v[196:199], v[172:175], v[132:135]
    s_cmp_lg_u32 s39, 7
    s_cbranch_scc1 HS_10
    v_mfma_f32_16x16x32_bf16 v[44:47], v[52:55], v[172:175], v[44:47]
    v_mfma_f32_16x16x32_bf16 v[48:51], v[172:175], v[172:175], v[48:51]
HS_10:
    s_waitcnt vmcnt(8) lgkmcnt(0)
    s_barrier
    v_mfma_f32_16x16x32_bf16 v[64:67], v[176:179], v[136:139], v[64:67]
    ds_read_b64_tr_b16 v[192:193], v27 offset:15360
    ds_read_b64_tr_b16 v[194:195], v27 offset:19200
    v_mfma_f32_16x16x32_bf16 v[68:71], v[176:179], v[140:143], v[68:71]
    ds_read_b64_tr_b16 v[196:197], v28 offset:15360
    ds_read_b64_tr_b16 v[198:199], v28 offset:19200
    v_mfma_f32_16x16x32_bf16 v[72:75], v[176:179], v[144:147], v[72:75]
    ds_read_b64_tr_b16 v[200:201], v29 offset:15360
    ds_read_b64_tr_b16 v[202:203], v29 offset:19200
    v_mfma_f32_16x16x32_bf16 v[76:79], v[176:179], v[148:151], v[76:79]
    ds_read_b64_tr_b16 v[204:205], v30 offset:15360
    ds_read_b64_tr_b16 v[206:207], v30 offset:19200
    v_mfma_f32_16x16x32_bf16 v[80:83], v[180:183], v[136:139], v[80:83]
    ds_read_b128 v[156:159], v18 offset:18432
    ds_read_b128 v[160:163], v20 offset:18432
    v_mfma_f32_16x16x32_bf16 v[84:87], v[180:183], v[140:143], v[84:87]
    ds_read_b128 v[164:167], v22 offset:18432
    v_mfma_f32_16x16x32_bf16 v[88:91], v[180:183], v[144:147], v[88:91]
    ds_read_b128 v[168:171], v24 offset:18432
    ds_read_b128 v[172:175], v26 offset:18432
    v_mfma_f32_16x16x32_bf16 v[92:95], v[180:183], v[148:151], v[92:95]
    s_mov_b32 s46, 1720320
    s_add_u32 m0, s45, 135168
    v_mfma_f32_16x16x32_bf16 v[96:99], v[184:187], v[136:139], v[96:99]
    s_nop 0
    buffer_load_dwordx4 v12, s[12:15], s46 offen lds
    v_mfma_f32_16x16x32_bf16 v[100:103], v[184:187], v[140:143], v[100:103]
    s_cmp_lg_u32 s53, 0
    s_mov_b32 s46, 1024
    v_mfma_f32_16x16x32_bf16 v[104:107], v[184:187], v[144:147], v[104:107]
    s_cmov_b32 s46, 1720320
    s_mov_b32 s47, 4294960128
    v_mfma_f32_16x16x32_bf16 v[108:111], v[184:187], v[148:151], v[108:111]
    s_cmov_b32 s47, 143360
    v_mfma_f32_16x16x32_bf16 v[112:115], v[188:191], v[136:139], v[112:115]
    s_add_u32 m0, s45, s47
    s_nop 0
    v_mfma_f32_16x16x32_bf16 v[116:119], v[188:191], v[140:143], v[116:119]
    buffer_load_dwordx4 v13, s[16:19], s46 offen lds
    s_mov_b32 s46, 1024
    v_mfma_f32_16x16x32_bf16 v[120:123], v[188:191], v[144:147], v[120:123]
    s_add_u32 m0, s45, 1024
    s_nop 0
    v_mfma_f32_16x16x32_bf16 v[124:127], v[188:191], v[148:151], v[124:127]
    buffer_load_dwordx4 v14, s[8:11], s46 offen lds
    v_cndmask_b32 v152, v152, v52, s[54:55]
    v_mfma_f32_16x16x32_bf16 v[36:39], v[52:55], v[136:139], v[36:39]
    v_cndmask_b32 v153, v153, v52, s[54:55]
    v_cndmask_b32 v154, v154, v52, s[54:55]
    v_mfma_f32_16x16x32_bf16 v[40:43], v[136:139], v[136:139], v[40:43]
    v_cndmask_b32 v155, v155, v52, s[54:55]
    s_nop 1
    v_mfma_f32_16x16x32_bf16 v[128:131], v[176:179], v[152:155], v[128:131]
    v_mfma_f32_16x16x32_bf16 v[132:135], v[180:183], v[152:155], v[132:135]
    s_cmp_lg_u32 s39, 7
    s_cbranch_scc1 HS_11
    v_mfma_f32_16x16x32_bf16 v[44:47], v[52:55], v[152:155], v[44:47]
    v_mfma_f32_16x16x32_bf16 v[48:51], v[152:155], v[152:155], v[48:51]
HS_11:
    s_waitcnt vmcnt(6) lgkmcnt(0)
    s_barrier
    v_mfma_f32_16x16x32_bf16 v[64:67], v[192:195], v[156:159], v[64:67]
    ds_read_b64_tr_b16 v[176:177], v27 offset:30720
    ds_read_b64_tr_b16 v[178:179], v27 offset:34560
    v_mfma_f32_16x16x32_bf16 v[68:71], v[192:195], v[160:163], v[68:71]
    ds_read_b64_tr_b16 v[180:181], v28 offset:30720
    ds_read_b64_tr_b16 v[182:183], v28 offset:34560
    v_mfma_f32_16x16x32_bf16 v[72:75], v[192:195], v[164:167], v[72:75]
    ds_read_b64_tr_b16 v[184:185], v29 offset:30720
    ds_read_b64_tr_b16 v[186:187], v29 offset:34560
    v_mfma_f32_16x16x32_bf16 v[76:79], v[192:195], v[168:171], v[76:79]
    ds_read_b64_tr_b16 v[188:189], v30 offset:30720
    ds_read_b64_tr_b16 v[190:191], v30 offset:34560
    v_mfma_f32_16x16x32_bf16 v[80:83], v[196:199], v[156:159], v[80:83]
    ds_read_b128 v[136:139], v17 offset:36864
    ds_read_b128 v[140:143], v19 offset:36864
    v_mfma_f32_16x16x32_bf16 v[84:87], v[196:199], v[160:163], v[84:87]
    ds_read_b128 v[144:147], v21 offset:36864
    v_mfma_f32_16x16x32_bf16 v[88:91], v[196:199], v[164:167], v[88:91]
    ds_read_b128 v[148:151], v23 offset:36864
    ds_read_b128 v[152:155], v25 offset:36864
    v_mfma_f32_16x16x32_bf16 v[92:95], v[196:199], v[168:171], v[92:95]
    s_mov_b32 s46, 1843200
    s_add_u32 m0, s45, 73728
    v_mfma_f32_16x16x32_bf16 v[96:99], v[200:203], v[156:159], v[96:99]
    s_nop 0
    buffer_load_dwordx4 v12, s[12:15], s46 offen lds
    v_mfma_f32_16x16x32_bf16 v[100:103], v[200:203], v[160:163], v[100:103]
    s_cmp_lg_u32 s53, 0
    s_mov_b32 s46, 1024
    v_mfma_f32_16x16x32_bf16 v[104:107], v[200:203], v[164:167], v[104:107]
    s_cmov_b32 s46, 1843200
    s_mov_b32 s47, 2048
    v_mfma_f32_16x16x32_bf16 v[108:111], v[200:203], v[168:171], v[108:111]
    s_cmov_b32 s47, 81920
    v_mfma_f32_16x16x32_bf16 v[112:115], v[204:207], v[156:159], v[112:115]
    s_add_u32 m0, s45, s47
    s_nop 0
    v_mfma_f32_16x16x32_bf16 v[116:119], v[204:207], v[160:163], v[116:119]
    buffer_load_dwordx4 v15, s[16:19], s46 offen lds
    s_mov_b32 s46, 1024
    v_mfma_f32_16x16x32_bf16 v[120:123], v[204:207], v[164:167], v[120:123]
    s_add_u32 m0, s45, 10240
    s_nop 0
    v_mfma_f32_16x16x32_bf16 v[124:127], v[204:207], v[168:171], v[124:127]
    buffer_load_dwordx4 v16, s[8:11], s46 offen lds
    v_cndmask_b32 v172, v172, v52, s[54:55]
    v_mfma_f32_16x16x32_bf16 v[36:39], v[52:55], v[156:159], v[36:39]
    v_cndmask_b32 v173, v173, v52, s[54:55]
    v_cndmask_b32 v174, v174, v52, s[54:55]
    v_mfma_f32_16x16x32_bf16 v[40:43], v[156:159], v[156:159], v[40:43]
    v_cndmask_b32 v175, v175, v52, s[54:55]
    s_nop 1
    v_mfma_f32_16x16x32_bf16 v[128:131], v[192:195], v[172:175], v[128:131]
    v_mfma_f32_16x16x32_bf16 v[132:135], v[196:199], v[172:175], v[132:135]
    s_cmp_lg_u32 s39, 7
    s_cbranch_scc1 HS_12
    v_mfma_f32_16x16x32_bf16 v[44:47], v[52:55], v[172:175], v[44:47]
    v_mfma_f32_16x16x32_bf16 v[48:51], v[172:175], v[172:175], v[48:51]
HS_12:
    s_waitcnt vmcnt(6) lgkmcnt(0)
    s_barrier
    v_mfma_f32_16x16x32_bf16 v[64:67], v[176:179], v[136:139], v[64:67]
    ds_read_b64_tr_b16 v[192:193], v27 offset:46080
    ds_read_b64_tr_b16 v[194:195], v27 offset:49920
    v_mfma_f32_16x16x32_bf16 v[68:71], v[176:179], v[140:143], v[68:71]
    ds_read_b64_tr_b16 v[196:197], v28 offset:46080
    ds_read_b64_tr_b16 v[198:199], v28 offset:49920
    v_mfma_f32_16x16x32_bf16 v[72:75], v[176:179], v[144:147], v[72:75]
    ds_read_b64_tr_b16 v[200:201], v29 offset:46080
    ds_read_b64_tr_b16 v[202:203], v29 offset:49920
    v_mfma_f32_16x16x32_bf16 v[76:79], v[176:179], v[148:151], v[76:79]
    ds_read_b64_tr_b16 v[204:205], v30 offset:46080
    ds_read_b64_tr_b16 v[206:207], v30 offset:49920
    v_mfma_f32_16x16x32_bf16 v[80:83], v[180:183], v[136:139], v[80:83]
    ds_read_b128 v[156:159], v18 offset:36864
    ds_read_b128 v[160:163], v20 offset:36864
    v_mfma_f32_16x16x32_bf16 v[84:87], v[180:183], v[140:143], v[84:87]
    ds_read_b128 v[164:167], v22 offset:36864
    v_mfma_f32_16x16x32_bf16 v[88:91], v[180:183], v[144:147], v[88:91]
    ds_read_b128 v[168:171], v24 offset:36864
    ds_read_b128 v[172:175], v26 offset:36864
    v_mfma_f32_16x16x32_bf16 v[92:95], v[180:183], v[148:151], v[92:95]
    s_mov_b32 s46, 1966080
    s_add_u32 m0, s45, 89088
    v_mfma_f32_16x16x32_bf16 v[96:99], v[184:187], v[136:139], v[96:99]
    s_nop 0
    buffer_load_dwordx4 v12, s[12:15], s46 offen lds
    v_mfma_f32_16x16x32_bf16 v[100:103], v[184:187], v[140:143], v[100:103]
    s_cmp_lg_u32 s53, 0
    s_mov_b32 s46, 1152
    v_mfma_f32_16x16x32_bf16 v[104:107], v[184:187], v[144:147], v[104:107]
    s_cmov_b32 s46, 1966080
    s_mov_b32 s47, 11264
    v_mfma_f32_16x16x32_bf16 v[108:111], v[184:187], v[148:151], v[108:111]
    s_cmov_b32 s47, 97280
    v_mfma_f32_16x16x32_bf16 v[112:115], v[188:191], v[136:139], v[112:115]
    s_add_u32 m0, s45, s47
    s_nop 0
    v_mfma_f32_16x16x32_bf16 v[116:119], v[188:191], v[140:143], v[116:119]
    buffer_load_dwordx4 v13, s[16:19], s46 offen lds
    s_mov_b32 s46, 1152
    v_mfma_f32_16x16x32_bf16 v[120:123], v[188:191], v[144:147], v[120:123]
    s_add_u32 m0, s45, 19456
    s_nop 0
    v_mfma_f32_16x16x32_bf16 v[124:127], v[188:191], v[148:151], v[124:127]
    buffer_load_dwordx4 v14, s[8:11], s46 offen lds
    v_cndmask_b32 v152, v152, v52, s[54:55]
    v_mfma_f32_16x16x32_bf16 v[36:39], v[52:55], v[136:139], v[36:39]
    v_cndmask_b32 v153, v153, v52, s[54:55]
    v_cndmask_b32 v154, v154, v52, s[54:55]
    v_mfma_f32_16x16x32_bf16 v[40:43], v[136:139], v[136:139], v[40:43]
    v_cndmask_b32 v155, v155, v52, s[54:55]
    s_nop 1
    v_mfma_f32_16x16x32_bf16 v[128:131], v[176:179], v[152:155], v[128:131]
    v_mfma_f32_16x16x32_bf16 v[132:135], v[180:183], v[152:155], v[132:135]
    s_cmp_lg_u32 s39, 7
    s_cbranch_scc1 HS_13
    v_mfma_f32_16x16x32_bf16 v[44:47], v[52:55], v[152:155], v[44:47]
    v_mfma_f32_16x16x32_bf16 v[48:51], v[152:155], v[152:155], v[48:51]
HS_13:
    s_waitcnt vmcnt(6) lgkmcnt(0)
    s_barrier
    v_mfma_f32_16x16x32_bf16 v[64:67], v[192:195], v[156:159], v[64:67]
    ds_read_b64_tr_b16 v[176:177], v27 offset:61440
    ds_read_b64_tr_b16 v[178:179], v27 offset:65280
    v_mfma_f32_16x16x32_bf16 v[68:71], v[192:195], v[160:163], v[68:71]
    ds_read_b64_tr_b16 v[180:181], v28 offset:61440
    ds_read_b64_tr_b16 v[182:183], v28 offset:65280
    v_mfma_f32_16x16x32_bf16 v[72:75], v[192:195], v[164:167], v[72:75]
    ds_read_b64_tr_b16 v[184:185], v29 offset:61440
    ds_read_b64_tr_b16 v[186:187], v29 offset:65280
    v_mfma_f32_16x16x32_bf16 v[76:79], v[192:195], v[168:171], v[76:79]
    ds_read_b64_tr_b16 v[188:189], v30 offset:61440
    ds_read_b64_tr_b16 v[190:191], v30 offset:65280
    v_mfma_f32_16x16x32_bf16 v[80:83], v[196:199], v[156:159], v[80:83]
    ds_read_b128 v[136:139], v17 offset:55296
    ds_read_b128 v[140:143], v19 offset:55296
    v_mfma_f32_16x16x32_bf16 v[84:87], v[196:199], v[160:163], v[84:87]
    ds_read_b128 v[144:147], v21 offset:55296
    v_mfma_f32_16x16x32_bf16 v[88:91], v[196:199], v[164:167], v[88:91]
    ds_read_b128 v[148:151], v23 offset:55296
    ds_read_b128 v[152:155], v25 offset:55296
    v_mfma_f32_16x16x32_bf16 v[92:95], v[196:199], v[168:171], v[92:95]
    s_mov_b32 s46, 2088960
    s_add_u32 m0, s45, 104448
    v_mfma_f32_16x16x32_bf16 v[96:99], v[200:203], v[156:159], v[96:99]
    s_nop 0
    buffer_load_dwordx4 v12, s[12:15], s46 offen lds
    v_mfma_f32_16x16x32_bf16 v[100:103], v[200:203], v[160:163], v[100:103]
    s_cmp_lg_u32 s53, 0
    s_mov_b32 s46, 1152
    v_mfma_f32_16x16x32_bf16 v[104:107], v[200:203], v[164:167], v[104:107]
    s_cmov_b32 s46, 2088960
    s_mov_b32 s47, 20480
    v_mfma_f32_16x16x32_bf16 v[108:111], v[200:203], v[168:171], v[108:111]
    s_cmov_b32 s47, 112640
    v_mfma_f32_16x16x32_bf16 v[112:115], v[204:207], v[156:159], v[112:115]
    s_add_u32 m0, s45, s47
    s_nop 0
    v_mfma_f32_16x16x32_bf16 v[116:119], v[204:207], v[160:163], v[116:119]
    buffer_load_dwordx4 v15, s[16:19], s46 offen lds
    s_mov_b32 s46, 1152
    v_mfma_f32_16x16x32_bf16 v[120:123], v[204:207], v[164:167], v[120:123]
    s_add_u32 m0, s45, 28672
    s_nop 0
    v_mfma_f32_16x16x32_bf16 v[124:127], v[204:207], v[168:171], v[124:127]
    buffer_load_dwordx4 v16, s[8:11], s46 offen lds
    v_cndmask_b32 v172, v172, v52, s[54:55]
    v_mfma_f32_16x16x32_bf16 v[36:39], v[52:55], v[156:159], v[36:39]
    v_cndmask_b32 v173, v173, v52, s[54:55]
    v_cndmask_b32 v174, v174, v52, s[54:55]
    v_mfma_f32_16x16x32_bf16 v[40:43], v[156:159], v[156:159], v[40:43]
    v_cndmask_b32 v175, v175, v52, s[54:55]
    s_nop 1
    v_mfma_f32_16x16x32_bf16 v[128:131], v[192:195], v[172:175], v[128:131]
    v_mfma_f32_16x16x32_bf16 v[132:135], v[196:199], v[172:175], v[132:135]
    s_cmp_lg_u32 s39, 7
    s_cbranch_scc1 HS_14
    v_mfma_f32_16x16x32_bf16 v[44:47], v[52:55], v[172:175], v[44:47]
    v_mfma_f32_16x16x32_bf16 v[48:51], v[172:175], v[172:175], v[48:51]
HS_14:
    s_waitcnt vmcnt(6) lgkmcnt(0)
    s_barrier
    v_mfma_f32_16x16x32_bf16 v[64:67], v[176:179], v[136:139], v[64:67]
    ds_read_b64_tr_b16 v[192:193], v27 offset:0
    ds_read_b64_tr_b16 v[194:195], v27 offset:3840
    v_mfma_f32_16x16x32_bf16 v[68:71], v[176:179], v[140:143], v[68:71]
    ds_read_b64_tr_b16 v[196:197], v28 offset:0
    ds_read_b64_tr_b16 v[198:199], v28 offset:3840
    v_mfma_f32_16x16x32_bf16 v[72:75], v[176:179], v[144:147], v[72:75]
    ds_read_b64_tr_b16 v[200:201], v29 offset:0
    v_mfma_f32_16x16x32_bf16 v[76:79], v[176:179], v[148:151], v[76:79]
    ds_read_b64_tr_b16 v[202:203], v29 offset:3840
    ds_read_b64_tr_b16 v[204:205], v30 offset:0
    v_mfma_f32_16x16x32_bf16 v[80:83], v[180:183], v[136:139], v[80:83]
    ds_read_b64_tr_b16 v[206:207], v30 offset:3840
    ds_read_b128 v[156:159], v18 offset:55296
    v_mfma_f32_16x16x32_bf16 v[84:87], v[180:183], v[140:143], v[84:87]
    ds_read_b128 v[160:163], v20 offset:55296
    v_mfma_f32_16x16x32_bf16 v[88:91], v[180:183], v[144:147], v[88:91]
    ds_read_b128 v[164:167], v22 offset:55296
    ds_read_b128 v[168:171], v24 offset:55296
    v_mfma_f32_16x16x32_bf16 v[92:95], v[180:183], v[148:151], v[92:95]
    ds_read_b128 v[172:175], v26 offset:55296
    v_mfma_f32_16x16x32_bf16 v[96:99], v[184:187], v[136:139], v[96:99]
    s_mov_b32 s46, 2211840
    s_add_u32 m0, s45, 119808
    v_mfma_f32_16x16x32_bf16 v[100:103], v[184:187], v[140:143], v[100:103]
    s_nop 0
    buffer_load_dwordx4 v12, s[12:15], s46 offen lds
    v_mfma_f32_16x16x32_bf16 v[104:107], v[184:187], v[144:147], v[104:107]
    s_cmp_lg_u32 s53, 0
    v_mfma_f32_16x16x32_bf16 v[108:111], v[184:187], v[148:151], v[108:111]
    s_mov_b32 s46, 2146435072
    s_cmov_b32 s46, 2211840
    v_mfma_f32_16x16x32_bf16 v[112:115], v[188:191], v[136:139], v[112:115]
    s_mov_b32 s47, 196608
    v_mfma_f32_16x16x32_bf16 v[116:119], v[188:191], v[140:143], v[116:119]
    s_cmov_b32 s47, 128000
    s_add_u32 m0, s45, s47
    v_mfma_f32_16x16x32_bf16 v[120:123], v[188:191], v[144:147], v[120:123]
    s_nop 0
    buffer_load_dwordx4 v13, s[16:19], s46 offen lds
    v_mfma_f32_16x16x32_bf16 v[124:127], v[188:191], v[148:151], v[124:127]
    v_cndmask_b32 v152, v152, v52, s[54:55]
    v_mfma_f32_16x16x32_bf16 v[36:39], v[52:55], v[136:139], v[36:39]
    v_cndmask_b32 v153, v153, v52, s[54:55]
    v_cndmask_b32 v154, v154, v52, s[54:55]
    v_mfma_f32_16x16x32_bf16 v[40:43], v[136:139], v[136:139], v[40:43]
    v_cndmask_b32 v155, v155, v52, s[54:55]
    s_nop 1
    v_mfma_f32_16x16x32_bf16 v[128:131], v[176:179], v[152:155], v[128:131]
    v_mfma_f32_16x16x32_bf16 v[132:135], v[180:183], v[152:155], v[132:135]
    s_cmp_lg_u32 s39, 7
    s_cbranch_scc1 HS_15
    v_mfma_f32_16x16x32_bf16 v[44:47], v[52:55], v[152:155], v[44:47]
    v_mfma_f32_16x16x32_bf16 v[48:51], v[152:155], v[152:155], v[48:51]
HS_15:
    s_waitcnt vmcnt(5) lgkmcnt(0)
    s_barrier
    v_mfma_f32_16x16x32_bf16 v[64:67], v[192:195], v[156:159], v[64:67]
    ds_read_b64_tr_b16 v[176:177], v27 offset:15360
    ds_read_b64_tr_b16 v[178:179], v27 offset:19200
    v_mfma_f32_16x16x32_bf16 v[68:71], v[192:195], v[160:163], v[68:71]
    ds_read_b64_tr_b16 v[180:181], v28 offset:15360
    ds_read_b64_tr_b16 v[182:183], v28 offset:19200
    v_mfma_f32_16x16x32_bf16 v[72:75], v[192:195], v[164:167], v[72:75]
    ds_read_b64_tr_b16 v[184:185], v29 offset:15360
    v_mfma_f32_16x16x32_bf16 v[76:79], v[192:195], v[168:171], v[76:79]
    ds_read_b64_tr_b16 v[186:187], v29 offset:19200
    ds_read_b64_tr_b16 v[188:189], v30 offset:15360
    v_mfma_f32_16x16x32_bf16 v[80:83], v[196:199], v[156:159], v[80:83]
    ds_read_b64_tr_b16 v[190:191], v30 offset:19200
    ds_read_b128 v[136:139], v17 offset:0
    v_mfma_f32_16x16x32_bf16 v[84:87], v[196:199], v[160:163], v[84:87]
    ds_read_b128 v[140:143], v19 offset:0
    v_mfma_f32_16x16x32_bf16 v[88:91], v[196:199], v[164:167], v[88:91]
    ds_read_b128 v[144:147], v21 offset:0
    ds_read_b128 v[148:151], v23 offset:0
    v_mfma_f32_16x16x32_bf16 v[92:95], v[196:199], v[168:171], v[92:95]
    ds_read_b128 v[152:155], v25 offset:0
    v_mfma_f32_16x16x32_bf16 v[96:99], v[200:203], v[156:159], v[96:99]
    s_mov_b32 s46, 2334720
    s_add_u32 m0, s45, 135168
    v_mfma_f32_16x16x32_bf16 v[100:103], v[200:203], v[160:163], v[100:103]
    s_nop 0
    buffer_load_dwordx4 v12, s[12:15], s46 offen lds
    v_mfma_f32_16x16x32_bf16 v[104:107], v[200:203], v[164:167], v[104:107]
    s_cmp_lg_u32 s53, 0
    v_mfma_f32_16x16x32_bf16 v[108:111], v[200:203], v[168:171], v[108:111]
    s_mov_b32 s46, 2146435072
    s_cmov_b32 s46, 2334720
    v_mfma_f32_16x16x32_bf16 v[112:115], v[204:207], v[156:159], v[112:115]
    s_mov_b32 s47, 196608
    v_mfma_f32_16x16x32_bf16 v[116:119], v[204:207], v[160:163], v[116:119]
    s_cmov_b32 s47, 143360
    s_add_u32 m0, s45, s47
    v_mfma_f32_16x16x32_bf16 v[120:123], v[204:207], v[164:167], v[120:123]
    s_nop 0
    buffer_load_dwordx4 v13, s[16:19], s46 offen lds
    v_mfma_f32_16x16x32_bf16 v[124:127], v[204:207], v[168:171], v[124:127]
    v_cndmask_b32 v172, v172, v52, s[54:55]
    v_mfma_f32_16x16x32_bf16 v[36:39], v[52:55], v[156:159], v[36:39]
    v_cndmask_b32 v173, v173, v52, s[54:55]
    v_cndmask_b32 v174, v174, v52, s[54:55]
    v_mfma_f32_16x16x32_bf16 v[40:43], v[156:159], v[156:159], v[40:43]
    v_cndmask_b32 v175, v175, v52, s[54:55]
    s_nop 1
    v_mfma_f32_16x16x32_bf16 v[128:131], v[192:195], v[172:175], v[128:131]
    v_mfma_f32_16x16x32_bf16 v[132:135], v[196:199], v[172:175], v[132:135]
    s_cmp_lg_u32 s39, 7
    s_cbranch_scc1 HS_16
    v_mfma_f32_16x16x32_bf16 v[44:47], v[52:55], v[172:175], v[44:47]
    v_mfma_f32_16x16x32_bf16 v[48:51], v[172:175], v[172:175], v[48:51]
HS_16:
    s_waitcnt vmcnt(4) lgkmcnt(0)
    s_barrier
    v_mfma_f32_16x16x32_bf16 v[64:67], v[176:179], v[136:139], v[64:67]
    ds_read_b64_tr_b16 v[192:193], v27 offset:30720
    v_mfma_f32_16x16x32_bf16 v[68:71], v[176:179], v[140:143], v[68:71]
    ds_read_b64_tr_b16 v[194:195], v27 offset:34560
    v_mfma_f32_16x16x32_bf16 v[72:75], v[176:179], v[144:147], v[72:75]
    ds_read_b64_tr_b16 v[196:197], v28 offset:30720
    v_mfma_f32_16x16x32_bf16 v[76:79], v[176:179], v[148:151], v[76:79]
    ds_read_b64_tr_b16 v[198:199], v28 offset:34560
    v_mfma_f32_16x16x32_bf16 v[80:83], v[180:183], v[136:139], v[80:83]
    ds_read_b64_tr_b16 v[200:201], v29 offset:30720
    v_mfma_f32_16x16x32_bf16 v[84:87], v[180:183], v[140:143], v[84:87]
    ds_read_b64_tr_b16 v[202:203], v29 offset:34560
    v_mfma_f32_16x16x32_bf16 v[88:91], v[180:183], v[144:147], v[88:91]
    ds_read_b64_tr_b16 v[204:205], v30 offset:30720
    v_mfma_f32_16x16x32_bf16 v[92:95], v[180:183], v[148:151], v[92:95]
    ds_read_b64_tr_b16 v[206:207], v30 offset:34560
    v_mfma_f32_16x16x32_bf16 v[96:99], v[184:187], v[136:139], v[96:99]
    ds_read_b128 v[156:159], v18 offset:0
    v_mfma_f32_16x16x32_bf16 v[100:103], v[184:187], v[140:143], v[100:103]
    ds_read_b128 v[160:163], v20 offset:0
    v_mfma_f32_16x16x32_bf16 v[104:107], v[184:187], v[144:147], v[104:107]
    ds_read_b128 v[164:167], v22 offset:0
    v_mfma_f32_16x16x32_bf16 v[108:111], v[184:187], v[148:151], v[108:111]
    ds_read_b128 v[168:171], v24 offset:0
    v_mfma_f32_16x16x32_bf16 v[112:115], v[188:191], v[136:139], v[112:115]
    ds_read_b128 v[172:175], v26 offset:0
    v_mfma_f32_16x16x32_bf16 v[116:119], v[188:191], v[140:143], v[116:119]
    v_cndmask_b32 v152, v152, v52, s[54:55]
    v_mfma_f32_16x16x32_bf16 v[120:123], v[188:191], v[144:147], v[120:123]
    v_cndmask_b32 v153, v153, v52, s[54:55]
    v_mfma_f32_16x16x32_bf16 v[124:127], v[188:191], v[148:151], v[124:127]
    v_cndmask_b32 v154, v154, v52, s[54:55]
    v_mfma_f32_16x16x32_bf16 v[36:39], v[52:55], v[136:139], v[36:39]
    v_cndmask_b32 v155, v155, v52, s[54:55]
    v_mfma_f32_16x16x32_bf16 v[40:43], v[136:139], v[136:139], v[40:43]
    s_nop 1
    v_mfma_f32_16x16x32_bf16 v[128:131], v[176:179], v[152:155], v[128:131]
    v_mfma_f32_16x16x32_bf16 v[132:135], v[180:183], v[152:155], v[132:135]
    s_cmp_lg_u32 s39, 7
    s_cbranch_scc1 HS_17
    v_mfma_f32_16x16x32_bf16 v[44:47], v[52:55], v[152:155], v[44:47]
    v_mfma_f32_16x16x32_bf16 v[48:51], v[152:155], v[152:155], v[48:51]
HS_17:
    s_waitcnt vmcnt(2) lgkmcnt(0)
    s_barrier
    v_mfma_f32_16x16x32_bf16 v[64:67], v[192:195], v[156:159], v[64:67]
    ds_read_b64_tr_b16 v[176:177], v27 offset:46080
    v_mfma_f32_16x16x32_bf16 v[68:71], v[192:195], v[160:163], v[68:71]
    ds_read_b64_tr_b16 v[178:179], v27 offset:49920
    v_mfma_f32_16x16x32_bf16 v[72:75], v[192:195], v[164:167], v[72:75]
    ds_read_b64_tr_b16 v[180:181], v28 offset:46080
    v_mfma_f32_16x16x32_bf16 v[76:79], v[192:195], v[168:171], v[76:79]
    ds_read_b64_tr_b16 v[182:183], v28 offset:49920
    v_mfma_f32_16x16x32_bf16 v[80:83], v[196:199], v[156:159], v[80:83]
    ds_read_b64_tr_b16 v[184:185], v29 offset:46080
    v_mfma_f32_16x16x32_bf16 v[84:87], v[196:199], v[160:163], v[84:87]
    ds_read_b64_tr_b16 v[186:187], v29 offset:49920
    v_mfma_f32_16x16x32_bf16 v[88:91], v[196:199], v[164:167], v[88:91]
    ds_read_b64_tr_b16 v[188:189], v30 offset:46080
    v_mfma_f32_16x16x32_bf16 v[92:95], v[196:199], v[168:171], v[92:95]
    ds_read_b64_tr_b16 v[190:191], v30 offset:49920
    v_mfma_f32_16x16x32_bf16 v[96:99], v[200:203], v[156:159], v[96:99]
    ds_read_b128 v[136:139], v17 offset:18432
    v_mfma_f32_16x16x32_bf16 v[100:103], v[200:203], v[160:163], v[100:103]
    ds_read_b128 v[140:143], v19 offset:18432
    v_mfma_f32_16x16x32_bf16 v[104:107], v[200:203], v[164:167], v[104:107]
    ds_read_b128 v[144:147], v21 offset:18432
    v_mfma_f32_16x16x32_bf16 v[108:111], v[200:203], v[168:171], v[108:111]
    ds_read_b128 v[148:151], v23 offset:18432
    v_mfma_f32_16x16x32_bf16 v[112:115], v[204:207], v[156:159], v[112:115]
    ds_read_b128 v[152:155], v25 offset:18432
    v_mfma_f32_16x16x32_bf16 v[116:119], v[204:207], v[160:163], v[116:119]
    v_cndmask_b32 v172, v172, v52, s[54:55]
    v_mfma_f32_16x16x32_bf16 v[120:123], v[204:207], v[164:167], v[120:123]
    v_cndmask_b32 v173, v173, v52, s[54:55]
    v_mfma_f32_16x16x32_bf16 v[124:127], v[204:207], v[168:171], v[124:127]
    v_cndmask_b32 v174, v174, v52, s[54:55]
    v_mfma_f32_16x16x32_bf16 v[36:39], v[52:55], v[156:159], v[36:39]
    v_cndmask_b32 v175, v175, v52, s[54:55]
    v_mfma_f32_16x16x32_bf16 v[40:43], v[156:159], v[156:159], v[40:43]
    s_nop 1
    v_mfma_f32_16x16x32_bf16 v[128:131], v[192:195], v[172:175], v[128:131]
    v_mfma_f32_16x16x32_bf16 v[132:135], v[196:199], v[172:175], v[132:135]
    s_cmp_lg_u32 s39, 7
    s_cbranch_scc1 HS_18
    v_mfma_f32_16x16x32_bf16 v[44:47], v[52:55], v[172:175], v[44:47]
    v_mfma_f32_16x16x32_bf16 v[48:51], v[172:175], v[172:175], v[48:51]
HS_18:
    s_waitcnt vmcnt(0) lgkmcnt(0)
    s_barrier
    v_mfma_f32_16x16x32_bf16 v[64:67], v[176:179], v[136:139], v[64:67]
    ds_read_b64_tr_b16 v[192:193], v27 offset:61440
    v_mfma_f32_16x16x32_bf16 v[68:71], v[176:179], v[140:143], v[68:71]
    ds_read_b64_tr_b16 v[194:195], v27 offset:65280
    v_mfma_f32_16x16x32_bf16 v[72:75], v[176:179], v[144:147], v[72:75]
    ds_read_b64_tr_b16 v[196:197], v28 offset:61440
    v_mfma_f32_16x16x32_bf16 v[76:79], v[176:179], v[148:151], v[76:79]
    ds_read_b64_tr_b16 v[198:199], v28 offset:65280
    v_mfma_f32_16x16x32_bf16 v[80:83], v[180:183], v[136:139], v[80:83]
    ds_read_b64_tr_b16 v[200:201], v29 offset:61440
    v_mfma_f32_16x16x32_bf16 v[84:87], v[180:183], v[140:143], v[84:87]
    ds_read_b64_tr_b16 v[202:203], v29 offset:65280
    v_mfma_f32_16x16x32_bf16 v[88:91], v[180:183], v[144:147], v[88:91]
    ds_read_b64_tr_b16 v[204:205], v30 offset:61440
    v_mfma_f32_16x16x32_bf16 v[92:95], v[180:183], v[148:151], v[92:95]
    ds_read_b64_tr_b16 v[206:207], v30 offset:65280
    v_mfma_f32_16x16x32_bf16 v[96:99], v[184:187], v[136:139], v[96:99]
    ds_read_b128 v[156:159], v18 offset:18432
    v_mfma_f32_16x16x32_bf16 v[100:103], v[184:187], v[140:143], v[100:103]
    ds_read_b128 v[160:163], v20 offset:18432
    v_mfma_f32_16x16x32_bf16 v[104:107], v[184:187], v[144:147], v[104:107]
    ds_read_b128 v[164:167], v22 offset:18432
    v_mfma_f32_16x16x32_bf16 v[108:111], v[184:187], v[148:151], v[108:111]
    ds_read_b128 v[168:171], v24 offset:18432
    v_mfma_f32_16x16x32_bf16 v[112:115], v[188:191], v[136:139], v[112:115]
    ds_read_b128 v[172:175], v26 offset:18432
    v_mfma_f32_16x16x32_bf16 v[116:119], v[188:191], v[140:143], v[116:119]
    v_cndmask_b32 v152, v152, v52, s[54:55]
    v_mfma_f32_16x16x32_bf16 v[120:123], v[188:191], v[144:147], v[120:123]
    v_cndmask_b32 v153, v153, v52, s[54:55]
    v_mfma_f32_16x16x32_bf16 v[124:127], v[188:191], v[148:151], v[124:127]
    v_cndmask_b32 v154, v154, v52, s[54:55]
    v_mfma_f32_16x16x32_bf16 v[36:39], v[52:55], v[136:139], v[36:39]
    v_cndmask_b32 v155, v155, v52, s[54:55]
    v_mfma_f32_16x16x32_bf16 v[40:43], v[136:139], v[136:139], v[40:43]
    s_nop 1
    v_mfma_f32_16x16x32_bf16 v[128:131], v[176:179], v[152:155], v[128:131]
    v_mfma_f32_16x16x32_bf16 v[132:135], v[180:183], v[152:155], v[132:135]
    s_cmp_lg_u32 s39, 7
    s_cbranch_scc1 HS_19
    v_mfma_f32_16x16x32_bf16 v[44:47], v[52:55], v[152:155], v[44:47]
    v_mfma_f32_16x16x32_bf16 v[48:51], v[152:155], v[152:155], v[48:51]
HS_19:
    s_waitcnt lgkmcnt(0)
    v_mfma_f32_16x16x32_bf16 v[64:67], v[192:195], v[156:159], v[64:67]
    v_cndmask_b32 v172, v172, v52, s[54:55]
    v_mfma_f32_16x16x32_bf16 v[68:71], v[192:195], v[160:163], v[68:71]
    v_mfma_f32_16x16x32_bf16 v[72:75], v[192:195], v[164:167], v[72:75]
    v_mfma_f32_16x16x32_bf16 v[76:79], v[192:195], v[168:171], v[76:79]
    v_mfma_f32_16x16x32_bf16 v[80:83], v[196:199], v[156:159], v[80:83]
    v_cndmask_b32 v173, v173, v52, s[54:55]
    v_mfma_f32_16x16x32_bf16 v[84:87], v[196:199], v[160:163], v[84:87]
    v_mfma_f32_16x16x32_bf16 v[88:91], v[196:199], v[164:167], v[88:91]
    v_mfma_f32_16x16x32_bf16 v[92:95], v[196:199], v[168:171], v[92:95]
    v_mfma_f32_16x16x32_bf16 v[96:99], v[200:203], v[156:159], v[96:99]
    v_mfma_f32_16x16x32_bf16 v[100:103], v[200:203], v[160:163], v[100:103]
    v_cndmask_b32 v174, v174, v52, s[54:55]
    v_mfma_f32_16x16x32_bf16 v[104:107], v[200:203], v[164:167], v[104:107]
    v_mfma_f32_16x16x32_bf16 v[108:111], v[200:203], v[168:171], v[108:111]
    v_mfma_f32_16x16x32_bf16 v[112:115], v[204:207], v[156:159], v[112:115]
    v_mfma_f32_16x16x32_bf16 v[116:119], v[204:207], v[160:163], v[116:119]
    v_cndmask_b32 v175, v175, v52, s[54:55]
    v_mfma_f32_16x16x32_bf16 v[120:123], v[204:207], v[164:167], v[120:123]
    v_mfma_f32_16x16x32_bf16 v[124:127], v[204:207], v[168:171], v[124:127]
    v_mfma_f32_16x16x32_bf16 v[36:39], v[52:55], v[156:159], v[36:39]
    v_mfma_f32_16x16x32_bf16 v[40:43], v[156:159], v[156:159], v[40:43]
    s_nop 1
    v_mfma_f32_16x16x32_bf16 v[128:131], v[192:195], v[172:175], v[128:131]
    v_mfma_f32_16x16x32_bf16 v[132:135], v[196:199], v[172:175], v[132:135]
    s_cmp_lg_u32 s39, 7
    s_cbranch_scc1 HS_20
    v_mfma_f32_16x16x32_bf16 v[44:47], v[52:55], v[172:175], v[44:47]
    v_mfma_f32_16x16x32_bf16 v[48:51], v[172:175], v[172:175], v[48:51]
HS_20:
    s_nop 7
    v_and_b32 v4, 3, v2
    v_cmp_eq_u32 s[66:67], 1, v4
    v_cmp_eq_u32 s[68:69], 2, v4
    v_cmp_eq_u32 s[70:71], 3, v4
    v_lshrrev_b32 v5, 2, v2
    v_cmp_eq_u32 s[72:73], v5, v3
    s_mov_b32 s46, 986500301
    s_mov_b32 s47, 925353388
    v_cndmask_b32 v37, v40, v41, s[66:67]
    v_cndmask_b32 v37, v37, v42, s[68:69]
    v_cndmask_b32 v37, v37, v43, s[70:71]
    v_mul_f32 v36, s46, v36
    v_mul_f32 v37, s46, v37
    v_fma_f32 v37, -v36, v36, v37
    v_max_f32 v37, 0, v37
    v_cvt_pk_bf16_f32 v4, v36, v36
    v_lshlrev_b32 v4, 16, v4
    v_cvt_pk_bf16_f32 v5, v37, v37
    v_lshlrev_b32 v5, 16, v5
    v_add_f32 v5, s47, v5
    v_cvt_pk_bf16_f32 v5, v5, v5
    v_lshlrev_b32 v5, 16, v5
    v_sqrt_f32 v5, v5
    s_nop 0
    v_cvt_pk_bf16_f32 v5, v5, v5
    v_lshlrev_b32 v5, 16, v5
    v_rcp_f32 v5, v5
    s_nop 0
    v_mov_b32 v36, v5
    v_sub_f32 v37, 0, v4
    s_cmp_lg_u32 s39, 7
    s_cbranch_scc1 HM_21
    v_cndmask_b32 v45, v48, v49, s[66:67]
    v_cndmask_b32 v45, v45, v50, s[68:69]
    v_cndmask_b32 v45, v45, v51, s[70:71]
    v_mul_f32 v44, s46, v44
    v_mul_f32 v45, s46, v45
    v_fma_f32 v45, -v44, v44, v45
    v_max_f32 v45, 0, v45
    v_cvt_pk_bf16_f32 v4, v44, v44
    v_lshlrev_b32 v4, 16, v4
    v_cvt_pk_bf16_f32 v5, v45, v45
    v_lshlrev_b32 v5, 16, v5
    v_add_f32 v5, s47, v5
    v_cvt_pk_bf16_f32 v5, v5, v5
    v_lshlrev_b32 v5, 16, v5
    v_sqrt_f32 v5, v5
    s_nop 0
    v_cvt_pk_bf16_f32 v5, v5, v5
    v_lshlrev_b32 v5, 16, v5
    v_rcp_f32 v5, v5
    s_nop 0
    v_mov_b32 v44, v5
    v_sub_f32 v45, 0, v4
HM_21:
    s_lshl_b32 s46, s43, 2
    s_add_u32 s46, s46, s44
    s_lshl_b32 s46, s46, 7
    s_add_u32 s46, s46, 128
    v_lshl_add_u32 v4, v2, 3, s46
    v_lshlrev_b32 v5, 3, v2
    s_barrier
    s_mov_b64 s[48:49], exec
    s_mov_b64 exec, s[72:73]
    ds_write_b64 v4, v[36:37]
    s_cmp_lg_u32 s39, 7
    s_cbranch_scc1 HW_22
    ds_write_b64 v5, v[44:45] offset:0
HW_22:
    s_mov_b64 exec, s[54:55]
    s_lshl_b32 s46, s56, 6
    v_lshl_add_u32 v6, v3, 4, s46
    ds_write_b128 v6, v[128:131] offset:1280
    s_lshl_b32 s46, s57, 6
    v_lshl_add_u32 v6, v3, 4, s46
    ds_write_b128 v6, v[132:135] offset:1280
    s_mov_b64 exec, s[48:49]
    s_add_u32 s47, s44, 0
    s_and_b32 s47, s47, 3
    s_lshl_b32 s46, s43, 2
    s_add_u32 s62, s47, s46
    s_add_u32 s47, s44, 1
    s_and_b32 s47, s47, 3
    s_lshl_b32 s46, s43, 2
    s_add_u32 s63, s47, s46
    s_add_u32 s47, s44, 2
    s_and_b32 s47, s47, 3
    s_lshl_b32 s46, s43, 2
    s_add_u32 s64, s47, s46
    s_add_u32 s47, s44, 3
    s_and_b32 s47, s47, 3
    s_lshl_b32 s46, s43, 2
    s_add_u32 s65, s47, s46
    v_mul_u32_u24 v6, 488, v2
    v_lshl_add_u32 v180, v3, 3, v6
    s_mul_i32 s46, s62, 7808
    s_add_u32 s46, s46, 7808
    v_add_u32 v176, s46, v180
    s_mul_i32 s46, s63, 7808
    s_add_u32 s46, s46, 7808
    v_add_u32 v177, s46, v180
    s_mul_i32 s46, s64, 7808
    s_add_u32 s46, s46, 7808
    v_add_u32 v178, s46, v180
    s_mul_i32 s46, s65, 7808
    s_add_u32 s46, s46, 7808
    v_add_u32 v179, s46, v180
    s_and_b32 s66, s39, 1
    s_lshr_b32 s67, s39, 1
    s_mul_i32 s68, s67, 40
    v_lshl_add_u32 v227, v2, 1, s66
    v_mul_u32_u24 v228, 488, v227
    v_lshl_add_u32 v228, v3, 4, v228
    v_add_u32 v228, s68, v228
    v_add_u32 v220, 10368, v228
    v_add_u32 v221, 160, v220
    v_subrev_u32 v229, 16, v227
    v_max_i32 v229, 0, v229
    v_mul_u32_u24 v229, 488, v229
    v_lshl_add_u32 v229, v3, 4, v229
    v_add_u32 v229, s68, v229
    v_add_u32 v224, 2720, v229
    v_mul_u32_u24 v227, 176, v227
    v_lshl_add_u32 v227, v3, 3, v227
    s_add_u32 s69, s68, 73728
    v_add_u32 v223, s69, v227
    v_mov_b32 v228, 0x40000000
    v_cmp_eq_u32 vcc, 0, v3
    v_bfe_u32 v229, v1, 2, 2
    v_lshl_add_u32 v229, v3, 2, v229
    v_cndmask_b32 v226, v228, v223, vcc
    v_lshl_add_u32 v229, v229, 1, s66
    v_and_b32 v230, 3, v1
    v_lshl_add_u32 v230, v230, 3, s68
    v_mul_u32_u24 v231, 488, v229
    v_add_u32 v231, v231, v230
    v_add_u32 v222, 10688, v231
    v_subrev_u32 v229, 16, v229
    v_max_i32 v229, 0, v229
    v_mul_u32_u24 v231, 488, v229
    v_add_u32 v231, v231, v230
    v_add_u32 v225, 2880, v231
    v_lshlrev_b32 v229, 2, v3
    v_sub_u32 v229, v2, v229
    v_mov_b32 v230, 3463342888
    v_add_u32 v231, 16, v229
    v_cmp_gt_u32 vcc, 8, v231
    s_nop 1
    v_cndmask_b32 v232, v230, 0, vcc
    v_add_u32 v231, 15, v229
    v_cmp_gt_u32 vcc, 8, v231
    s_nop 1
    v_cndmask_b32 v233, v230, 0, vcc
    v_add_u32 v231, 14, v229
    v_cmp_gt_u32 vcc, 8, v231
    s_nop 1
    v_cndmask_b32 v234, v230, 0, vcc
    v_add_u32 v231, 13, v229
    v_cmp_gt_u32 vcc, 8, v231
    s_nop 1
    v_cndmask_b32 v235, v230, 0, vcc
    v_add_u32 v231, 0, v229
    v_cmp_gt_u32 vcc, 8, v231
    s_nop 1
    v_cndmask_b32 v236, v230, 0, vcc
    v_add_u32 v231, 4294967295, v229
    v_cmp_gt_u32 vcc, 8, v231
    s_nop 1
    v_cndmask_b32 v237, v230, 0, vcc
    v_add_u32 v231, 4294967294, v229
    v_cmp_gt_u32 vcc, 8, v231
    s_nop 1
    v_cndmask_b32 v238, v230, 0, vcc
    v_add_u32 v231, 4294967293, v229
    v_cmp_gt_u32 vcc, 8, v231
    s_nop 1
    v_cndmask_b32 v239, v230, 0, vcc
    v_cmp_lt_u32 s[70:71], 1, v3
    v_cmp_eq_u32 s[72:73], 3, v3
    s_cmp_eq_u32 s37, 0
    s_mov_b32 s74, 0
    s_cmov_b32 s74, 3463342888
    s_mov_b32 s75, 1051011932
    s_waitcnt lgkmcnt(0)
    s_barrier
    s_lshl_b32 s47, s62, 7
    v_add_u32 v4, s47, v5
    ds_read_b64 v[136:137], v4 offset:128
    s_lshl_b32 s47, s63, 7
    v_add_u32 v4, s47, v5
    ds_read_b64 v[138:139], v4 offset:128
    s_lshl_b32 s47, s64, 7
    v_add_u32 v4, s47, v5
    ds_read_b64 v[140:141], v4 offset:128
    s_lshl_b32 s47, s65, 7
    v_add_u32 v4, s47, v5
    ds_read_b64 v[142:143], v4 offset:128
    ds_read_b64 v[144:145], v5 offset:0
    s_lshl_b32 s46, s56, 6
    v_lshl_add_u32 v4, v3, 4, s46
    ds_read_b128 v[148:151], v4 offset:1280
    s_lshl_b32 s46, s57, 6
    v_lshl_add_u32 v4, v3, 4, s46
    ds_read_b128 v[152:155], v4 offset:1280
    s_lshl_b32 s46, s58, 6
    v_lshl_add_u32 v4, v3, 4, s46
    ds_read_b128 v[156:159], v4 offset:1280
    s_lshl_b32 s46, s59, 6
    v_lshl_add_u32 v4, v3, 4, s46
    ds_read_b128 v[160:163], v4 offset:1280
    s_waitcnt lgkmcnt(0)
    s_lshl_b32 s46, s56, 5
    s_cmp_eq_u32 s56, 15
    s_cmov_b32 s46, 0x40000000
    v_fma_f32 v64, v148, v137, v64
    v_fma_f32 v65, v149, v137, v65
    v_fma_f32 v66, v150, v137, v66
    v_fma_f32 v67, v151, v137, v67
    v_add_u32 v4, s46, v176
    v_mul_f32 v64, v64, v136
    v_mul_f32 v65, v65, v136
    v_mul_f32 v66, v66, v136
    v_mul_f32 v67, v67, v136
    v_cvt_pk_bf16_f32 v64, v64, v65
    v_cvt_pk_bf16_f32 v65, v66, v67
    ds_write_b64 v4, v[64:65] offset:2560
    v_fma_f32 v68, v148, v139, v68
    v_fma_f32 v69, v149, v139, v69
    v_fma_f32 v70, v150, v139, v70
    v_fma_f32 v71, v151, v139, v71
    v_add_u32 v5, s46, v177
    v_mul_f32 v68, v68, v138
    v_mul_f32 v69, v69, v138
    v_mul_f32 v70, v70, v138
    v_mul_f32 v71, v71, v138
    v_cvt_pk_bf16_f32 v68, v68, v69
    v_cvt_pk_bf16_f32 v69, v70, v71
    ds_write_b64 v5, v[68:69] offset:2560
    v_fma_f32 v72, v148, v141, v72
    v_fma_f32 v73, v149, v141, v73
    v_fma_f32 v74, v150, v141, v74
    v_fma_f32 v75, v151, v141, v75
    v_add_u32 v6, s46, v178
    v_mul_f32 v72, v72, v140
    v_mul_f32 v73, v73, v140
    v_mul_f32 v74, v74, v140
    v_mul_f32 v75, v75, v140
    v_cvt_pk_bf16_f32 v72, v72, v73
    v_cvt_pk_bf16_f32 v73, v74, v75
    ds_write_b64 v6, v[72:73] offset:2560
    v_fma_f32 v76, v148, v143, v76
    v_fma_f32 v77, v149, v143, v77
    v_fma_f32 v78, v150, v143, v78
    v_fma_f32 v79, v151, v143, v79
    v_add_u32 v7, s46, v179
    v_mul_f32 v76, v76, v142
    v_mul_f32 v77, v77, v142
    v_mul_f32 v78, v78, v142
    v_mul_f32 v79, v79, v142
    v_cvt_pk_bf16_f32 v76, v76, v77
    v_cvt_pk_bf16_f32 v77, v78, v79
    ds_write_b64 v7, v[76:77] offset:2560
    v_fma_f32 v128, v148, v145, v128
    v_fma_f32 v129, v149, v145, v129
    v_fma_f32 v130, v150, v145, v130
    v_fma_f32 v131, v151, v145, v131
    v_add_u32 v8, s46, v180
    v_mul_f32 v128, v128, v144
    v_mul_f32 v129, v129, v144
    v_mul_f32 v130, v130, v144
    v_mul_f32 v131, v131, v144
    v_cvt_pk_bf16_f32 v128, v128, v129
    v_cvt_pk_bf16_f32 v129, v130, v131
    ds_write_b64 v8, v[128:129] offset:2560
    s_lshl_b32 s46, s57, 5
    s_cmp_eq_u32 s57, 15
    s_cmov_b32 s46, 0x40000000
    v_fma_f32 v80, v152, v137, v80
    v_fma_f32 v81, v153, v137, v81
    v_fma_f32 v82, v154, v137, v82
    v_fma_f32 v83, v155, v137, v83
    v_add_u32 v4, s46, v176
    v_mul_f32 v80, v80, v136
    v_mul_f32 v81, v81, v136
    v_mul_f32 v82, v82, v136
    v_mul_f32 v83, v83, v136
    v_cvt_pk_bf16_f32 v80, v80, v81
    v_cvt_pk_bf16_f32 v81, v82, v83
    ds_write_b64 v4, v[80:81] offset:2560
    v_fma_f32 v84, v152, v139, v84
    v_fma_f32 v85, v153, v139, v85
    v_fma_f32 v86, v154, v139, v86
    v_fma_f32 v87, v155, v139, v87
    v_add_u32 v5, s46, v177
    v_mul_f32 v84, v84, v138
    v_mul_f32 v85, v85, v138
    v_mul_f32 v86, v86, v138
    v_mul_f32 v87, v87, v138
    v_cvt_pk_bf16_f32 v84, v84, v85
    v_cvt_pk_bf16_f32 v85, v86, v87
    ds_write_b64 v5, v[84:85] offset:2560
    v_fma_f32 v88, v152, v141, v88
    v_fma_f32 v89, v153, v141, v89
    v_fma_f32 v90, v154, v141, v90
    v_fma_f32 v91, v155, v141, v91
    v_add_u32 v6, s46, v178
    v_mul_f32 v88, v88, v140
    v_mul_f32 v89, v89, v140
    v_mul_f32 v90, v90, v140
    v_mul_f32 v91, v91, v140
    v_cvt_pk_bf16_f32 v88, v88, v89
    v_cvt_pk_bf16_f32 v89, v90, v91
    ds_write_b64 v6, v[88:89] offset:2560
    v_fma_f32 v92, v152, v143, v92
    v_fma_f32 v93, v153, v143, v93
    v_fma_f32 v94, v154, v143, v94
    v_fma_f32 v95, v155, v143, v95
    v_add_u32 v7, s46, v179
    v_mul_f32 v92, v92, v142
    v_mul_f32 v93, v93, v142
    v_mul_f32 v94, v94, v142
    v_mul_f32 v95, v95, v142
    v_cvt_pk_bf16_f32 v92, v92, v93
    v_cvt_pk_bf16_f32 v93, v94, v95
    ds_write_b64 v7, v[92:93] offset:2560
    v_fma_f32 v132, v152, v145, v132
    v_fma_f32 v133, v153, v145, v133
    v_fma_f32 v134, v154, v145, v134
    v_fma_f32 v135, v155, v145, v135
    v_add_u32 v8, s46, v180
    v_mul_f32 v132, v132, v144
    v_mul_f32 v133, v133, v144
    v_mul_f32 v134, v134, v144
    v_mul_f32 v135, v135, v144
    v_cvt_pk_bf16_f32 v132, v132, v133
    v_cvt_pk_bf16_f32 v133, v134, v135
    ds_write_b64 v8, v[132:133] offset:2560
    s_lshl_b32 s46, s58, 5
    s_cmp_eq_u32 s58, 15
    s_cmov_b32 s46, 0x40000000
    v_fma_f32 v96, v156, v137, v96
    v_fma_f32 v97, v157, v137, v97
    v_fma_f32 v98, v158, v137, v98
    v_fma_f32 v99, v159, v137, v99
    v_add_u32 v4, s46, v176
    v_mul_f32 v96, v96, v136
    v_mul_f32 v97, v97, v136
    v_mul_f32 v98, v98, v136
    v_mul_f32 v99, v99, v136
    v_cvt_pk_bf16_f32 v96, v96, v97
    v_cvt_pk_bf16_f32 v97, v98, v99
    ds_write_b64 v4, v[96:97] offset:2560
    v_fma_f32 v100, v156, v139, v100
    v_fma_f32 v101, v157, v139, v101
    v_fma_f32 v102, v158, v139, v102
    v_fma_f32 v103, v159, v139, v103
    v_add_u32 v5, s46, v177
    v_mul_f32 v100, v100, v138
    v_mul_f32 v101, v101, v138
    v_mul_f32 v102, v102, v138
    v_mul_f32 v103, v103, v138
    v_cvt_pk_bf16_f32 v100, v100, v101
    v_cvt_pk_bf16_f32 v101, v102, v103
    ds_write_b64 v5, v[100:101] offset:2560
    v_fma_f32 v104, v156, v141, v104
    v_fma_f32 v105, v157, v141, v105
    v_fma_f32 v106, v158, v141, v106
    v_fma_f32 v107, v159, v141, v107
    v_add_u32 v6, s46, v178
    v_mul_f32 v104, v104, v140
    v_mul_f32 v105, v105, v140
    v_mul_f32 v106, v106, v140
    v_mul_f32 v107, v107, v140
    v_cvt_pk_bf16_f32 v104, v104, v105
    v_cvt_pk_bf16_f32 v105, v106, v107
    ds_write_b64 v6, v[104:105] offset:2560
    v_fma_f32 v108, v156, v143, v108
    v_fma_f32 v109, v157, v143, v109
    v_fma_f32 v110, v158, v143, v110
    v_fma_f32 v111, v159, v143, v111
    v_add_u32 v7, s46, v179
    v_mul_f32 v108, v108, v142
    v_mul_f32 v109, v109, v142
    v_mul_f32 v110, v110, v142
    v_mul_f32 v111, v111, v142
    v_cvt_pk_bf16_f32 v108, v108, v109
    v_cvt_pk_bf16_f32 v109, v110, v111
    ds_write_b64 v7, v[108:109] offset:2560
    s_lshl_b32 s46, s59, 5
    s_cmp_eq_u32 s59, 15
    s_cmov_b32 s46, 0x40000000
    v_fma_f32 v112, v160, v137, v112
    v_fma_f32 v113, v161, v137, v113
    v_fma_f32 v114, v162, v137, v114
    v_fma_f32 v115, v163, v137, v115
    v_add_u32 v4, s46, v176
    v_mul_f32 v112, v112, v136
    v_mul_f32 v113, v113, v136
    v_mul_f32 v114, v114, v136
    v_mul_f32 v115, v115, v136
    v_cvt_pk_bf16_f32 v112, v112, v113
    v_cvt_pk_bf16_f32 v113, v114, v115
    ds_write_b64 v4, v[112:113] offset:2560
    v_fma_f32 v116, v160, v139, v116
    v_fma_f32 v117, v161, v139, v117
    v_fma_f32 v118, v162, v139, v118
    v_fma_f32 v119, v163, v139, v119
    v_add_u32 v5, s46, v177
    v_mul_f32 v116, v116, v138
    v_mul_f32 v117, v117, v138
    v_mul_f32 v118, v118, v138
    v_mul_f32 v119, v119, v138
    v_cvt_pk_bf16_f32 v116, v116, v117
    v_cvt_pk_bf16_f32 v117, v118, v119
    ds_write_b64 v5, v[116:117] offset:2560
    v_fma_f32 v120, v160, v141, v120
    v_fma_f32 v121, v161, v141, v121
    v_fma_f32 v122, v162, v141, v122
    v_fma_f32 v123, v163, v141, v123
    v_add_u32 v6, s46, v178
    v_mul_f32 v120, v120, v140
    v_mul_f32 v121, v121, v140
    v_mul_f32 v122, v122, v140
    v_mul_f32 v123, v123, v140
    v_cvt_pk_bf16_f32 v120, v120, v121
    v_cvt_pk_bf16_f32 v121, v122, v123
    ds_write_b64 v6, v[120:121] offset:2560
    v_fma_f32 v124, v160, v143, v124
    v_fma_f32 v125, v161, v143, v125
    v_fma_f32 v126, v162, v143, v126
    v_fma_f32 v127, v163, v143, v127
    v_add_u32 v7, s46, v179
    v_mul_f32 v124, v124, v142
    v_mul_f32 v125, v125, v142
    v_mul_f32 v126, v126, v142
    v_mul_f32 v127, v127, v142
    v_cvt_pk_bf16_f32 v124, v124, v125
    v_cvt_pk_bf16_f32 v125, v126, v127
    ds_write_b64 v7, v[124:125] offset:2560
    s_waitcnt lgkmcnt(0)
    s_barrier
    ds_read_b64 v[24:25], v220 offset:0
    ds_read_b64 v[26:27], v220 offset:8
    ds_read_b64 v[40:41], v224 offset:0
    ds_read_b64 v[44:45], v221 offset:0
    ds_read_b64 v[42:43], v224 offset:8
    ds_read_b64 v[46:47], v221 offset:8
    ds_read_b64 v[28:29], v220 offset:15616
    ds_read_b64 v[30:31], v220 offset:15624
    ds_read_b64 v[48:49], v221 offset:0
    ds_read_b64 v[52:53], v221 offset:15616
    ds_read_b64 v[50:51], v221 offset:8
    ds_read_b64 v[54:55], v221 offset:15624
    ds_read_b64 v[32:33], v220 offset:31232
    ds_read_b64 v[34:35], v220 offset:31240
    ds_read_b64 v[56:57], v221 offset:15616
    ds_read_b64 v[60:61], v221 offset:31232
    ds_read_b64 v[58:59], v221 offset:15624
    ds_read_b64 v[62:63], v221 offset:31240
    ds_read_b64 v[36:37], v220 offset:46848
    ds_read_b64 v[38:39], v220 offset:46856
    ds_read_b64 v[64:65], v221 offset:31232
    ds_read_b64 v[68:69], v221 offset:46848
    ds_read_b64 v[66:67], v221 offset:31240
    ds_read_b64 v[70:71], v221 offset:46856
    ds_read_b64_tr_b16 v[72:73], v225 offset:0
    ds_read_b64_tr_b16 v[74:75], v222 offset:0
    ds_read_b64_tr_b16 v[76:77], v225 offset:32
    ds_read_b64_tr_b16 v[78:79], v222 offset:32
    ds_read_b64_tr_b16 v[80:81], v222 offset:0
    ds_read_b64_tr_b16 v[82:83], v222 offset:15616
    ds_read_b64_tr_b16 v[84:85], v222 offset:32
    ds_read_b64_tr_b16 v[86:87], v222 offset:15648
    ds_read_b64_tr_b16 v[88:89], v222 offset:15616
    ds_read_b64_tr_b16 v[90:91], v222 offset:31232
    ds_read_b64_tr_b16 v[92:93], v222 offset:15648
    ds_read_b64_tr_b16 v[94:95], v222 offset:31264
    ds_read_b64_tr_b16 v[96:97], v222 offset:31232
    ds_read_b64_tr_b16 v[98:99], v222 offset:46848
    ds_read_b64_tr_b16 v[100:101], v222 offset:31264
    ds_read_b64_tr_b16 v[102:103], v222 offset:46880
    s_waitcnt lgkmcnt(15)
    v_cndmask_b32 v24, v24, 0, s[72:73]
    v_cndmask_b32 v25, v25, 0, s[72:73]
    v_cndmask_b32 v26, v26, 0, s[70:71]
    v_cndmask_b32 v27, v27, 0, s[70:71]
    v_cndmask_b32 v28, v28, 0, s[72:73]
    v_cndmask_b32 v29, v29, 0, s[72:73]
    v_cndmask_b32 v30, v30, 0, s[70:71]
    v_cndmask_b32 v31, v31, 0, s[70:71]
    v_cndmask_b32 v32, v32, 0, s[72:73]
    v_cndmask_b32 v33, v33, 0, s[72:73]
    v_cndmask_b32 v34, v34, 0, s[70:71]
    v_cndmask_b32 v35, v35, 0, s[70:71]
    v_cndmask_b32 v36, v36, 0, s[72:73]
    v_cndmask_b32 v37, v37, 0, s[72:73]
    v_cndmask_b32 v38, v38, 0, s[70:71]
    v_cndmask_b32 v39, v39, 0, s[70:71]
    s_nop 1
    v_mfma_f32_16x16x32_bf16 v[104:107], v[40:43], v[24:27], 0
    v_mfma_f32_16x16x32_bf16 v[108:111], v[44:47], v[24:27], 0
    v_mfma_f32_16x16x32_bf16 v[112:115], v[48:51], v[28:31], 0
    v_mfma_f32_16x16x32_bf16 v[116:119], v[52:55], v[28:31], 0
    v_mfma_f32_16x16x32_bf16 v[120:123], v[56:59], v[32:35], 0
    v_mfma_f32_16x16x32_bf16 v[124:127], v[60:63], v[32:35], 0
    v_mfma_f32_16x16x32_bf16 v[128:131], v[64:67], v[36:39], 0
    v_mfma_f32_16x16x32_bf16 v[132:135], v[68:71], v[36:39], 0
    s_nop 7
    v_fma_f32 v104, v104, s75, v232
    v_fma_f32 v105, v105, s75, v233
    v_fma_f32 v106, v106, s75, v234
    v_fma_f32 v107, v107, s75, v235
    v_fma_f32 v108, v108, s75, v236
    v_fma_f32 v109, v109, s75, v237
    v_fma_f32 v110, v110, s75, v238
    v_fma_f32 v111, v111, s75, v239
    v_fma_f32 v112, v112, s75, v232
    v_fma_f32 v113, v113, s75, v233
    v_fma_f32 v114, v114, s75, v234
    v_fma_f32 v115, v115, s75, v235
    v_fma_f32 v116, v116, s75, v236
    v_fma_f32 v117, v117, s75, v237
    v_fma_f32 v118, v118, s75, v238
    v_fma_f32 v119, v119, s75, v239
    v_fma_f32 v120, v120, s75, v232
    v_fma_f32 v121, v121, s75, v233
    v_fma_f32 v122, v122, s75, v234
    v_fma_f32 v123, v123, s75, v235
    v_fma_f32 v124, v124, s75, v236
    v_fma_f32 v125, v125, s75, v237
    v_fma_f32 v126, v126, s75, v238
    v_fma_f32 v127, v127, s75, v239
    v_fma_f32 v128, v128, s75, v232
    v_fma_f32 v129, v129, s75, v233
    v_fma_f32 v130, v130, s75, v234
    v_fma_f32 v131, v131, s75, v235
    v_fma_f32 v132, v132, s75, v236
    v_fma_f32 v133, v133, s75, v237
    v_fma_f32 v134, v134, s75, v238
    v_fma_f32 v135, v135, s75, v239
    v_add_f32 v104, s74, v104
    v_add_f32 v105, s74, v105
    v_add_f32 v106, s74, v106
    v_add_f32 v107, s74, v107
    v_max3_f32 v144, v104, v105, v106
    v_max3_f32 v152, v107, v108, v109
    v_max3_f32 v144, v144, v110, v111
    v_max_f32 v144, v144, v152
    v_max3_f32 v145, v112, v113, v114
    v_max3_f32 v153, v115, v116, v117
    v_max3_f32 v145, v145, v118, v119
    v_max_f32 v145, v145, v153
    v_max3_f32 v146, v120, v121, v122
    v_max3_f32 v154, v123, v124, v125
    v_max3_f32 v146, v146, v126, v127
    v_max_f32 v146, v146, v154
    v_max3_f32 v147, v128, v129, v130
    v_max3_f32 v155, v131, v132, v133
    v_max3_f32 v147, v147, v134, v135
    v_max_f32 v147, v147, v155
    v_mov_b32 v152, v144
    v_mov_b32 v153, v145
    v_mov_b32 v154, v146
    v_mov_b32 v155, v147
    v_permlane16_swap_b32 v144, v152
    v_permlane16_swap_b32 v145, v153
    v_permlane16_swap_b32 v146, v154
    v_permlane16_swap_b32 v147, v155
    v_max_f32 v144, v144, v152
    v_max_f32 v145, v145, v153
    v_max_f32 v146, v146, v154
    v_max_f32 v147, v147, v155
    v_mov_b32 v152, v144
    v_mov_b32 v153, v145
    v_mov_b32 v154, v146
    v_mov_b32 v155, v147
    v_permlane32_swap_b32 v144, v152
    v_permlane32_swap_b32 v145, v153
    v_permlane32_swap_b32 v146, v154
    v_permlane32_swap_b32 v147, v155
    v_max_f32 v144, v144, v152
    v_max_f32 v145, v145, v153
    v_max_f32 v146, v146, v154
    v_max_f32 v147, v147, v155
    v_sub_f32 v104, v104, v144
    v_sub_f32 v105, v105, v144
    v_sub_f32 v106, v106, v144
    v_sub_f32 v107, v107, v144
    v_sub_f32 v108, v108, v144
    v_sub_f32 v109, v109, v144
    v_sub_f32 v110, v110, v144
    v_sub_f32 v111, v111, v144
    v_exp_f32 v104, v104
    v_exp_f32 v105, v105
    v_exp_f32 v106, v106
    v_exp_f32 v107, v107
    v_exp_f32 v108, v108
    v_exp_f32 v109, v109
    v_exp_f32 v110, v110
    v_exp_f32 v111, v111
    v_sub_f32 v112, v112, v145
    v_sub_f32 v113, v113, v145
    v_sub_f32 v114, v114, v145
    v_sub_f32 v115, v115, v145
    v_sub_f32 v116, v116, v145
    v_sub_f32 v117, v117, v145
    v_sub_f32 v118, v118, v145
    v_sub_f32 v119, v119, v145
    v_exp_f32 v112, v112
    v_exp_f32 v113, v113
    v_exp_f32 v114, v114
    v_exp_f32 v115, v115
    v_exp_f32 v116, v116
    v_exp_f32 v117, v117
    v_exp_f32 v118, v118
    v_exp_f32 v119, v119
    v_sub_f32 v120, v120, v146
    v_sub_f32 v121, v121, v146
    v_sub_f32 v122, v122, v146
    v_sub_f32 v123, v123, v146
    v_sub_f32 v124, v124, v146
    v_sub_f32 v125, v125, v146
    v_sub_f32 v126, v126, v146
    v_sub_f32 v127, v127, v146
    v_exp_f32 v120, v120
    v_exp_f32 v121, v121
    v_exp_f32 v122, v122
    v_exp_f32 v123, v123
    v_exp_f32 v124, v124
    v_exp_f32 v125, v125
    v_exp_f32 v126, v126
    v_exp_f32 v127, v127
    v_sub_f32 v128, v128, v147
    v_sub_f32 v129, v129, v147
    v_sub_f32 v130, v130, v147
    v_sub_f32 v131, v131, v147
    v_sub_f32 v132, v132, v147
    v_sub_f32 v133, v133, v147
    v_sub_f32 v134, v134, v147
    v_sub_f32 v135, v135, v147
    v_exp_f32 v128, v128
    v_exp_f32 v129, v129
    v_exp_f32 v130, v130
    v_exp_f32 v131, v131
    v_exp_f32 v132, v132
    v_exp_f32 v133, v133
    v_exp_f32 v134, v134
    v_exp_f32 v135, v135
    v_add_f32 v148, v104, v105
    v_add_f32 v152, v106, v107
    v_add_f32 v148, v148, v108
    v_add_f32 v152, v152, v109
    v_add_f32 v148, v148, v110
    v_add_f32 v152, v152, v111
    v_add_f32 v148, v148, v152
    v_add_f32 v149, v112, v113
    v_add_f32 v153, v114, v115
    v_add_f32 v149, v149, v116
    v_add_f32 v153, v153, v117
    v_add_f32 v149, v149, v118
    v_add_f32 v153, v153, v119
    v_add_f32 v149, v149, v153
    v_add_f32 v150, v120, v121
    v_add_f32 v154, v122, v123
    v_add_f32 v150, v150, v124
    v_add_f32 v154, v154, v125
    v_add_f32 v150, v150, v126
    v_add_f32 v154, v154, v127
    v_add_f32 v150, v150, v154
    v_add_f32 v151, v128, v129
    v_add_f32 v155, v130, v131
    v_add_f32 v151, v151, v132
    v_add_f32 v155, v155, v133
    v_add_f32 v151, v151, v134
    v_add_f32 v155, v155, v135
    v_add_f32 v151, v151, v155
    v_mov_b32 v152, v148
    v_mov_b32 v153, v149
    v_mov_b32 v154, v150
    v_mov_b32 v155, v151
    v_permlane16_swap_b32 v148, v152
    v_permlane16_swap_b32 v149, v153
    v_permlane16_swap_b32 v150, v154
    v_permlane16_swap_b32 v151, v155
    v_add_f32 v148, v148, v152
    v_add_f32 v149, v149, v153
    v_add_f32 v150, v150, v154
    v_add_f32 v151, v151, v155
    v_mov_b32 v152, v148
    v_mov_b32 v153, v149
    v_mov_b32 v154, v150
    v_mov_b32 v155, v151
    v_permlane32_swap_b32 v148, v152
    v_permlane32_swap_b32 v149, v153
    v_permlane32_swap_b32 v150, v154
    v_permlane32_swap_b32 v151, v155
    v_add_f32 v148, v148, v152
    v_add_f32 v149, v149, v153
    v_add_f32 v150, v150, v154
    v_add_f32 v151, v151, v155
    v_rcp_f32 v148, v148
    v_rcp_f32 v149, v149
    v_rcp_f32 v150, v150
    v_rcp_f32 v151, v151
    v_mul_f32 v104, v104, v148
    v_mul_f32 v105, v105, v148
    v_mul_f32 v106, v106, v148
    v_mul_f32 v107, v107, v148
    v_mul_f32 v108, v108, v148
    v_mul_f32 v109, v109, v148
    v_mul_f32 v110, v110, v148
    v_mul_f32 v111, v111, v148
    v_cvt_pk_bf16_f32 v24, v104, v105
    v_cvt_pk_bf16_f32 v25, v106, v107
    v_cvt_pk_bf16_f32 v26, v108, v109
    v_cvt_pk_bf16_f32 v27, v110, v111
    v_mul_f32 v112, v112, v149
    v_mul_f32 v113, v113, v149
    v_mul_f32 v114, v114, v149
    v_mul_f32 v115, v115, v149
    v_mul_f32 v116, v116, v149
    v_mul_f32 v117, v117, v149
    v_mul_f32 v118, v118, v149
    v_mul_f32 v119, v119, v149
    v_cvt_pk_bf16_f32 v28, v112, v113
    v_cvt_pk_bf16_f32 v29, v114, v115
    v_cvt_pk_bf16_f32 v30, v116, v117
    v_cvt_pk_bf16_f32 v31, v118, v119
    v_mul_f32 v120, v120, v150
    v_mul_f32 v121, v121, v150
    v_mul_f32 v122, v122, v150
    v_mul_f32 v123, v123, v150
    v_mul_f32 v124, v124, v150
    v_mul_f32 v125, v125, v150
    v_mul_f32 v126, v126, v150
    v_mul_f32 v127, v127, v150
    v_cvt_pk_bf16_f32 v32, v120, v121
    v_cvt_pk_bf16_f32 v33, v122, v123
    v_cvt_pk_bf16_f32 v34, v124, v125
    v_cvt_pk_bf16_f32 v35, v126, v127
    v_mul_f32 v128, v128, v151
    v_mul_f32 v129, v129, v151
    v_mul_f32 v130, v130, v151
    v_mul_f32 v131, v131, v151
    v_mul_f32 v132, v132, v151
    v_mul_f32 v133, v133, v151
    v_mul_f32 v134, v134, v151
    v_mul_f32 v135, v135, v151
    v_cvt_pk_bf16_f32 v36, v128, v129
    v_cvt_pk_bf16_f32 v37, v130, v131
    v_cvt_pk_bf16_f32 v38, v132, v133
    v_cvt_pk_bf16_f32 v39, v134, v135
    s_waitcnt lgkmcnt(0)
    v_mfma_f32_16x16x32_bf16 v[104:107], v[72:75], v[24:27], 0
    v_mfma_f32_16x16x32_bf16 v[108:111], v[76:79], v[24:27], 0
    v_mfma_f32_16x16x32_bf16 v[112:115], v[80:83], v[28:31], 0
    v_mfma_f32_16x16x32_bf16 v[116:119], v[84:87], v[28:31], 0
    v_mfma_f32_16x16x32_bf16 v[120:123], v[88:91], v[32:35], 0
    v_mfma_f32_16x16x32_bf16 v[124:127], v[92:95], v[32:35], 0
    v_mfma_f32_16x16x32_bf16 v[128:131], v[96:99], v[36:39], 0
    v_mfma_f32_16x16x32_bf16 v[132:135], v[100:103], v[36:39], 0
    s_nop 7
    v_cvt_pk_bf16_f32 v104, v104, v105
    v_cvt_pk_bf16_f32 v105, v106, v107
    v_cvt_pk_bf16_f32 v108, v108, v109
    v_cvt_pk_bf16_f32 v109, v110, v111
    ds_write_b64 v223, v[104:105] offset:0
    ds_write_b64 v226, v[108:109] offset:32
    v_cvt_pk_bf16_f32 v112, v112, v113
    v_cvt_pk_bf16_f32 v113, v114, v115
    v_cvt_pk_bf16_f32 v116, v116, v117
    v_cvt_pk_bf16_f32 v117, v118, v119
    ds_write_b64 v223, v[112:113] offset:5632
    ds_write_b64 v226, v[116:117] offset:5664
    v_cvt_pk_bf16_f32 v120, v120, v121
    v_cvt_pk_bf16_f32 v121, v122, v123
    v_cvt_pk_bf16_f32 v124, v124, v125
    v_cvt_pk_bf16_f32 v125, v126, v127
    ds_write_b64 v223, v[120:121] offset:11264
    ds_write_b64 v226, v[124:125] offset:11296
    v_cvt_pk_bf16_f32 v128, v128, v129
    v_cvt_pk_bf16_f32 v129, v130, v131
    v_cvt_pk_bf16_f32 v132, v132, v133
    v_cvt_pk_bf16_f32 v133, v134, v135
    ds_write_b64 v223, v[128:129] offset:16896
    ds_write_b64 v226, v[132:133] offset:16928
    s_waitcnt lgkmcnt(0)
    s_barrier
    s_movk_i32 s51, 4352
    v_add_u32 v4, 0, v0
    v_mul_u32_u24 v5, 6554, v4
    v_lshrrev_b32 v5, 16, v5
    v_mul_u32_u24 v6, 10, v5
    v_sub_u32 v6, v4, v6
    v_mul_u32_u24 v7, 176, v5
    v_lshl_add_u32 v7, v6, 4, v7
    v_add_u32 v7, 73728, v7
    ds_read_b128 v[24:27], v7
    v_add_u32 v5, s40, v5
    v_mul_lo_u32 v5, v5, s51
    v_lshl_add_u32 v36, v6, 4, v5
    v_add_u32 v4, 512, v0
    v_mul_u32_u24 v5, 6554, v4
    v_lshrrev_b32 v5, 16, v5
    v_mul_u32_u24 v6, 10, v5
    v_sub_u32 v6, v4, v6
    v_mul_u32_u24 v7, 176, v5
    v_lshl_add_u32 v7, v6, 4, v7
    v_add_u32 v7, 73728, v7
    ds_read_b128 v[28:31], v7
    v_add_u32 v5, s40, v5
    v_mul_lo_u32 v5, v5, s51
    v_lshl_add_u32 v37, v6, 4, v5
    v_add_u32 v4, 1024, v0
    v_mul_u32_u24 v5, 6554, v4
    v_lshrrev_b32 v5, 16, v5
    v_mul_u32_u24 v6, 10, v5
    v_sub_u32 v6, v4, v6
    v_mul_u32_u24 v7, 176, v5
    v_lshl_add_u32 v7, v6, 4, v7
    v_add_u32 v7, 73728, v7
    ds_read_b128 v[32:35], v7
    v_add_u32 v5, s40, v5
    v_mul_lo_u32 v5, v5, s51
    v_lshl_add_u32 v38, v6, 4, v5
    v_mov_b32 v8, 2146435072
    v_cmp_gt_u32 vcc, 1280, v4
    s_nop 1
    v_cndmask_b32 v38, v8, v38, vcc
    s_waitcnt lgkmcnt(2)
    buffer_store_dwordx4 v[24:27], v36, s[20:23], s42 offen sc1
    s_waitcnt lgkmcnt(1)
    buffer_store_dwordx4 v[28:31], v37, s[20:23], s42 offen sc1
    s_waitcnt lgkmcnt(0)
    buffer_store_dwordx4 v[32:35], v38, s[20:23], s42 offen sc1
    s_barrier
    s_cmp_lt_u32 s39, 4
    s_cbranch_scc1 P2_23
    s_cmp_eq_u32 s39, 7
    s_cbranch_scc1 W7_24
    s_waitcnt vmcnt(0)
    s_barrier
    s_branch K1_END
W7_24:
    s_load_dwordx4 s[48:51], s[0:1], 72
    s_waitcnt lgkmcnt(0)
    s_mov_b32 s52, s48
    s_and_b32 s53, s49, 0xffff
    s_mov_b32 s54, 256
    s_mov_b32 s55, 0x00020000
    v_mov_b32 v4, 0
    s_mov_b64 exec, 1
    s_mov_b32 s58, 200000
    s_movk_i32 s59, 256
NI_26:
    buffer_load_dword v5, v4, s[52:55], 0 offen sc1
    s_waitcnt vmcnt(0)
    v_cmp_gt_u32 vcc, s59, v5
    s_nop 4
    s_cbranch_vccz ND_27
    s_sleep 8
    s_sub_u32 s58, s58, 1
    s_cmp_lg_u32 s58, 0
    s_cbranch_scc1 NI_26
ND_27:
    s_mov_b64 exec, -1
    s_add_u32 s50, s50, 16777216
    s_addc_u32 s51, s51, 0
    s_mov_b32 s52, s50
    s_and_b32 s53, s51, 0xffff
    s_mov_b32 s54, 32768
    s_mov_b32 s55, 0x00020000
    v_and_b32 v4, 31, v1
    v_mul_u32_u24 v5, 205, v4
    v_lshrrev_b32 v5, 11, v5
    v_mul_u32_u24 v6, 10, v5
    v_sub_u32 v6, v4, v6
    s_lshl_b32 s46, s37, 2
    s_mul_i32 s47, s46, 171
    s_lshr_b32 s47, s47, 9
    s_add_u32 s46, s46, 3
    s_mul_i32 s46, s46, 171
    s_lshr_b32 s46, s46, 9
    s_min_u32 s46, s46, 13
    v_mul_u32_u24 v7, 171, v6
    v_lshrrev_b32 v7, 9, v7
    v_mul_u32_u24 v8, 61, v7
    v_add_u32 v8, v8, v6
    v_subrev_u32 v9, 6, v6
    v_lshrrev_b32 v10, 1, v9
    v_and_b32 v9, 1, v9
    v_lshl_add_u32 v9, v10, 6, v9
    v_add_u32 v9, 3, v9
    v_cmp_gt_u32 s[56:57], 6, v6
    s_nop 1
    v_cndmask_b32 v11, v9, v8, s[56:57]
    v_add_u32 v7, s47, v5
    v_mul_u32_u24 v8, 5, v7
    v_add_u32 v8, v8, v11
    v_lshl_add_u32 v9, v7, 1, v11
    v_add_u32 v9, 33, v9
    v_cmp_gt_u32 s[48:49], 12, v7
    s_nop 1
    v_cndmask_b32 v8, v9, v8, s[48:49]
    s_orn2_b64 s[48:49], s[48:49], s[56:57]
    v_cmp_ge_u32 vcc, s46, v7
    s_and_b64 s[48:49], s[48:49], vcc
    v_cmp_gt_u32 vcc, 30, v4
    s_and_b64 s[48:49], s[48:49], vcc
    v_add_u32 v8, 128, v8
    s_lshl_b32 s46, s37, 1
    s_sub_u32 s46, s46, 18
    v_add_u32 v7, s46, v5
    v_mul_u32_u24 v9, 3, v7
    v_add_u32 v9, v9, v11
    v_mul_u32_u24 v10, 5, v7
    v_add_u32 v10, v10, v11
    v_subrev_u32 v10, 6, v10
    v_cmp_gt_u32 s[50:51], 3, v7
    s_nop 1
    v_cndmask_b32 v9, v10, v9, s[50:51]
    s_orn2_b64 s[50:51], s[56:57], s[50:51]
    v_cmp_gt_u32 vcc, 2, v5
    s_and_b64 s[50:51], s[50:51], vcc
    s_cmp_ge_u32 s37, 9
    s_cselect_b64 s[50:51], s[50:51], 0
    s_mov_b32 s49, s51
    v_cmp_gt_u32 vcc, 32, v1
    s_nop 1
    v_cndmask_b32 v8, v9, v8, vcc
    v_lshlrev_b32 v8, 7, v8
    v_mov_b32 v5, 1
    s_waitcnt vmcnt(0)
    s_barrier
    s_mov_b64 exec, s[48:49]
    buffer_atomic_add v5, v8, s[52:55], 0 offen offset:4
    s_mov_b64 exec, -1
    s_branch K1_END
P2_23:
    s_load_dwordx2 s[4:5], s[0:1], 0
    s_load_dwordx2 s[6:7], s[0:1], 16
    s_load_dwordx2 s[28:29], s[0:1], 48
    s_load_dwordx2 s[30:31], s[0:1], 56
    s_load_dwordx4 s[32:35], s[0:1], 64
    s_load_dwordx2 s[60:61], s[0:1], 80
    s_and_b32 s36, s2, 7
    s_lshl_b32 s36, s36, 4
    s_lshr_b32 s46, s2, 4
    s_add_u32 s36, s36, s46
    s_and_b32 s62, s36, 63
    s_lshr_b32 s63, s36, 6
    s_mul_i32 s46, s62, 171
    s_lshr_b32 s46, s46, 9
    s_mul_i32 s47, s46, 3
    s_sub_u32 s47, s62, s47
    s_sub_u32 s48, s62, 9
    s_mul_i32 s49, s48, 205
    s_lshr_b32 s49, s49, 10
    s_mul_i32 s50, s49, 5
    s_sub_u32 s48, s48, s50
    s_add_u32 s49, s49, 3
    s_cmp_lt_u32 s62, 9
    s_cselect_b32 s46, s46, s49
    s_cselect_b32 s47, s47, s48
    s_lshl_b32 s40, s46, 6
    s_add_u32 s40, s40, 1152
    s_mul_i32 s48, s63, 3
    s_add_u32 s48, s48, s47
    s_lshl_b32 s49, s63, 1
    s_add_u32 s49, s49, s47
    s_add_u32 s49, s49, 3
    s_cmp_lt_u32 s47, 3
    s_cselect_b32 s47, s48, s49
    s_lshl_b32 s42, s47, 7
    s_lshr_b32 s56, s40, 7
    s_add_u32 s57, s40, 63
    s_lshr_b32 s57, s57, 7
    s_sub_u32 s59, s57, s56
    s_lshl_b32 s59, s59, 3
    s_add_u32 s59, s59, 8
    s_add_u32 s56, s36, 0
    s_lshl_b32 s56, s56, 7
    s_and_b32 s43, s39, 1
    s_lshr_b32 s44, s39, 1
    s_lshl_b32 s45, s39, 3
    v_lshrrev_b32 v4, 3, v1
    v_add_u32 v4, s45, v4
    v_and_b32 v5, 7, v1
    v_and_b32 v6, 7, v4
    v_xor_b32 v5, v5, v6
    v_lshlrev_b32 v5, 4, v5
    s_movk_i32 s41, 4352
    v_add_u32 v6, 0, v4
    v_add_u32 v6, s40, v6
    v_mul_lo_u32 v6, v6, s41
    v_add_u32 v8, v6, v5
    v_add_u32 v6, 32, v4
    v_add_u32 v6, s40, v6
    v_mul_lo_u32 v6, v6, s41
    v_add_u32 v9, v6, v5
    v_add_u32 v6, 0, v4
    v_bfe_u32 v5, v6, 1, 2
    v_bfe_u32 v7, v1, 1, 2
    v_xor_b32 v5, v5, v7
    v_and_b32 v7, 1, v1
    v_lshl_or_b32 v5, v5, 1, v7
    v_and_b32 v10, 0xfffffff3, v6
    v_and_b32 v7, 4, v6
    v_lshl_or_b32 v10, v7, 1, v10
    v_and_b32 v7, 8, v6
    v_lshrrev_b32 v7, 1, v7
    v_or_b32 v10, v10, v7
    v_mul_u32_u24 v10, 1280, v10
    v_lshl_add_u32 v10, v5, 4, v10
    v_add_u32 v10, s42, v10
    v_add_u32 v6, 32, v4
    v_bfe_u32 v5, v6, 1, 2
    v_bfe_u32 v7, v1, 1, 2
    v_xor_b32 v5, v5, v7
    v_and_b32 v7, 1, v1
    v_lshl_or_b32 v5, v5, 1, v7
    v_and_b32 v11, 0xfffffff3, v6
    v_and_b32 v7, 4, v6
    v_lshl_or_b32 v11, v7, 1, v11
    v_and_b32 v7, 8, v6
    v_lshrrev_b32 v7, 1, v7
    v_or_b32 v11, v11, v7
    v_mul_u32_u24 v11, 1280, v11
    v_lshl_add_u32 v11, v5, 4, v11
    v_add_u32 v11, s42, v11
    s_mul_i32 s46, s43, 4096
    v_and_b32 v4, 7, v2
    v_lshl_add_u32 v6, v2, 7, s46
    v_add_u32 v5, 0, v3
    v_xor_b32 v5, v5, v4
    v_lshl_add_u32 v12, v5, 4, v6
    v_add_u32 v5, 4, v3
    v_xor_b32 v5, v5, v4
    v_lshl_add_u32 v13, v5, 4, v6
    v_lshrrev_b32 v4, 1, v3
    v_lshlrev_b32 v4, 4, v4
    v_and_b32 v5, 1, v3
    v_lshl_add_u32 v4, v5, 2, v4
    v_bfe_u32 v5, v1, 2, 2
    v_add_u32 v4, v4, v5
    v_bfe_u32 v5, v4, 1, 2
    v_lshlrev_b32 v4, 7, v4
    v_and_b32 v6, 3, v1
    v_lshl_add_u32 v4, v6, 3, v4
    v_add_u32 v4, 8192, v4
    s_lshl_b32 s46, s44, 1
    s_add_u32 s47, s46, 0
    v_xor_b32 v6, s47, v5
    v_lshl_add_u32 v14, v6, 5, v4
    s_add_u32 s47, s46, 1
    v_xor_b32 v6, s47, v5
    v_lshl_add_u32 v15, v6, 5, v4
    s_lshl_b32 s46, s44, 6
    s_add_u32 s46, s46, s42
    v_lshl_add_u32 v22, v3, 3, s46
    s_mul_i32 s47, s43, 32
    s_add_u32 s47, s47, s40
    v_add_u32 v4, s47, v2
    v_mul_u32_u24 v4, 1280, v4
    v_add_u32 v20, v4, v22
    v_add_u32 v4, s47, v2
    v_add_u32 v4, 16, v4
    v_mul_u32_u24 v4, 1280, v4
    v_add_u32 v21, v4, v22
    v_mov_b32 v36, 0
    v_mov_b32 v37, 0
    v_mov_b32 v38, 0
    v_mov_b32 v39, 0
    v_mov_b32 v40, 0
    v_mov_b32 v41, 0
    v_mov_b32 v42, 0
    v_mov_b32 v43, 0
    v_mov_b32 v44, 0
    v_mov_b32 v45, 0
    v_mov_b32 v46, 0
    v_mov_b32 v47, 0
    v_mov_b32 v48, 0
    v_mov_b32 v49, 0
    v_mov_b32 v50, 0
    v_mov_b32 v51, 0
    s_lshl_b32 s45, s39, 10
    s_waitcnt lgkmcnt(0)
    s_mov_b32 s8, s60
    s_and_b32 s9, s61, 0xffff
    s_mov_b32 s10, 8912896
    s_mov_b32 s11, 0x00020000
    s_mov_b32 s12, s6
    s_and_b32 s13, s7, 0xffff
    s_mov_b32 s14, 819200
    s_mov_b32 s15, 0x00020000
    s_mov_b32 s48, s28
    s_and_b32 s49, s29, 0xffff
    s_mov_b32 s50, 1966080
    s_mov_b32 s51, 0x00020000
    s_mov_b32 s16, s4
    s_and_b32 s17, s5, 0xffff
    s_mov_b32 s18, 2621440
    s_mov_b32 s19, 0x00020000
    s_mov_b32 s20, s32
    s_and_b32 s21, s33, 0xffff
    s_mov_b32 s22, 2621440
    s_mov_b32 s23, 0x00020000
    s_mov_b32 s24, s30
    s_and_b32 s25, s31, 0xffff
    s_mov_b32 s26, 1280
    s_mov_b32 s27, 0x00020000
    s_add_u32 s60, s60, 16777216
    s_addc_u32 s61, s61, 0
    s_mov_b32 s52, s60
    s_and_b32 s53, s61, 0xffff
    s_mov_b32 s54, 32768
    s_mov_b32 s55, 0x00020000
    s_mov_b32 s46, 0
    s_add_u32 m0, s45, 8192
    s_nop 0
    buffer_load_dwordx4 v10, s[48:51], s46 offen lds
    s_add_u32 m0, s45, 12288
    s_nop 0
    buffer_load_dwordx4 v11, s[48:51], s46 offen lds
    s_mov_b32 s46, 81920
    s_add_u32 m0, s45, 24576
    s_nop 0
    buffer_load_dwordx4 v10, s[48:51], s46 offen lds
    s_add_u32 m0, s45, 28672
    s_nop 0
    buffer_load_dwordx4 v11, s[48:51], s46 offen lds
    s_mov_b32 s46, 163840
    s_add_u32 m0, s45, 40960
    s_nop 0
    buffer_load_dwordx4 v10, s[48:51], s46 offen lds
    s_add_u32 m0, s45, 45056
    s_nop 0
    buffer_load_dwordx4 v11, s[48:51], s46 offen lds
    s_mov_b32 s46, 245760
    s_add_u32 m0, s45, 57344
    s_nop 0
    buffer_load_dwordx4 v10, s[48:51], s46 offen lds
    s_add_u32 m0, s45, 61440
    s_nop 0
    buffer_load_dwordx4 v11, s[48:51], s46 offen lds
    buffer_load_dwordx2 v[24:25], v20, s[16:19], 0 offen offset:0
    buffer_load_dwordx2 v[26:27], v20, s[16:19], 0 offen offset:32
    buffer_load_dwordx2 v[28:29], v21, s[16:19], 0 offen offset:0
    buffer_load_dwordx2 v[30:31], v21, s[16:19], 0 offen offset:32
    buffer_load_dwordx2 v[32:33], v22, s[24:27], 0 offen offset:0
    buffer_load_dwordx2 v[34:35], v22, s[24:27], 0 offen offset:32
    s_waitcnt vmcnt(14)
    s_barrier
    s_cmp_lg_u32 s39, 0
    s_cbranch_scc1 PS_30
    v_mov_b32 v4, s56
    s_mov_b64 exec, 1
    s_mov_b32 s58, 200000
PL_28:
    buffer_load_dword v5, v4, s[52:55], 0 offen offset:0 sc1
    s_waitcnt vmcnt(0)
    v_cmp_gt_u32 vcc, s59, v5
    s_nop 4
    s_cbranch_vccz PD_29
    s_sleep 8
    s_sub_u32 s58, s58, 1
    s_cmp_lg_u32 s58, 0
    s_cbranch_scc1 PL_28
PD_29:
    s_mov_b64 exec, -1
PS_30:
    s_barrier
    s_movk_i32 s46, 1280
    s_add_u32 m0, s45, 0
    s_nop 0
    buffer_load_dwordx4 v8, s[8:11], s46 offen sc1 lds
    s_add_u32 m0, s45, 4096
    s_nop 0
    buffer_load_dwordx4 v9, s[8:11], s46 offen sc1 lds
    s_movk_i32 s46, 1408
    s_add_u32 m0, s45, 16384
    s_nop 0
    buffer_load_dwordx4 v8, s[8:11], s46 offen sc1 lds
    s_add_u32 m0, s45, 20480
    s_nop 0
    buffer_load_dwordx4 v9, s[8:11], s46 offen sc1 lds
    s_movk_i32 s46, 1536
    s_add_u32 m0, s45, 32768
    s_nop 0
    buffer_load_dwordx4 v8, s[8:11], s46 offen sc1 lds
    s_add_u32 m0, s45, 36864
    s_nop 0
    buffer_load_dwordx4 v9, s[8:11], s46 offen sc1 lds
    s_movk_i32 s46, 1664
    s_add_u32 m0, s45, 49152
    s_nop 0
    buffer_load_dwordx4 v8, s[8:11], s46 offen sc1 lds
    s_add_u32 m0, s45, 53248
    s_nop 0
    buffer_load_dwordx4 v9, s[8:11], s46 offen sc1 lds
    s_waitcnt vmcnt(6)
    s_barrier
    v_add_u32 v16, 0, v12
    v_add_u32 v18, 0, v14
    v_add_u32 v17, 0, v13
    v_add_u32 v19, 0, v15
    ds_read_b64_tr_b16 v[84:85], v18 offset:0
    ds_read_b64_tr_b16 v[86:87], v18 offset:1024
    ds_read_b64_tr_b16 v[88:89], v19 offset:0
    ds_read_b64_tr_b16 v[90:91], v19 offset:1024
    ds_read_b128 v[52:55], v16 offset:0
    ds_read_b128 v[56:59], v16 offset:2048
    ds_read_b64_tr_b16 v[92:93], v18 offset:4096
    ds_read_b64_tr_b16 v[94:95], v18 offset:5120
    ds_read_b64_tr_b16 v[96:97], v19 offset:4096
    ds_read_b64_tr_b16 v[98:99], v19 offset:5120
    ds_read_b128 v[60:63], v17 offset:0
    ds_read_b128 v[64:67], v17 offset:2048
    s_waitcnt vmcnt(4) lgkmcnt(0)
    s_barrier
    v_mfma_f32_16x16x32_bf16 v[36:39], v[84:87], v[52:55], v[36:39]
    v_add_u32 v16, 16384, v12
    v_add_u32 v18, 16384, v14
    v_add_u32 v17, 16384, v13
    v_add_u32 v19, 16384, v15
    ds_read_b64_tr_b16 v[100:101], v18 offset:0
    ds_read_b64_tr_b16 v[102:103], v18 offset:1024
    ds_read_b64_tr_b16 v[104:105], v19 offset:0
    ds_read_b64_tr_b16 v[106:107], v19 offset:1024
    v_mfma_f32_16x16x32_bf16 v[40:43], v[84:87], v[56:59], v[40:43]
    ds_read_b128 v[68:71], v16 offset:0
    ds_read_b128 v[72:75], v16 offset:2048
    ds_read_b64_tr_b16 v[108:109], v18 offset:4096
    ds_read_b64_tr_b16 v[110:111], v18 offset:5120
    ds_read_b64_tr_b16 v[112:113], v19 offset:4096
    ds_read_b64_tr_b16 v[114:115], v19 offset:5120
    ds_read_b128 v[76:79], v17 offset:0
    v_mfma_f32_16x16x32_bf16 v[44:47], v[88:91], v[52:55], v[44:47]
    ds_read_b128 v[80:83], v17 offset:2048
    s_movk_i32 s46, 1792
    s_add_u32 m0, s45, 65536
    s_nop 0
    buffer_load_dwordx4 v8, s[8:11], s46 offen sc1 lds
    s_add_u32 m0, s45, 69632
    s_nop 0
    v_mfma_f32_16x16x32_bf16 v[48:51], v[88:91], v[56:59], v[48:51]
    buffer_load_dwordx4 v9, s[8:11], s46 offen sc1 lds
    s_mov_b32 s46, 327680
    s_add_u32 m0, s45, 73728
    s_nop 0
    buffer_load_dwordx4 v10, s[48:51], s46 offen lds
    s_add_u32 m0, s45, 77824
    s_nop 0
    v_mfma_f32_16x16x32_bf16 v[36:39], v[92:95], v[60:63], v[36:39]
    buffer_load_dwordx4 v11, s[48:51], s46 offen lds
    s_movk_i32 s46, 1920
    s_add_u32 m0, s45, 81920
    s_nop 0
    buffer_load_dwordx4 v8, s[8:11], s46 offen sc1 lds
    s_add_u32 m0, s45, 86016
    s_nop 0
    buffer_load_dwordx4 v9, s[8:11], s46 offen sc1 lds
    v_mfma_f32_16x16x32_bf16 v[40:43], v[92:95], v[64:67], v[40:43]
    s_mov_b32 s46, 409600
    s_add_u32 m0, s45, 90112
    s_nop 0
    buffer_load_dwordx4 v10, s[48:51], s46 offen lds
    s_add_u32 m0, s45, 94208
    s_nop 0
    buffer_load_dwordx4 v11, s[48:51], s46 offen lds
    v_mfma_f32_16x16x32_bf16 v[44:47], v[96:99], v[60:63], v[44:47]
    s_movk_i32 s46, 2048
    s_add_u32 m0, s45, 98304
    s_nop 0
    buffer_load_dwordx4 v8, s[8:11], s46 offen sc1 lds
    s_add_u32 m0, s45, 102400
    s_nop 0
    buffer_load_dwordx4 v9, s[8:11], s46 offen sc1 lds
    v_mfma_f32_16x16x32_bf16 v[48:51], v[96:99], v[64:67], v[48:51]
    s_mov_b32 s46, 491520
    s_add_u32 m0, s45, 106496
    s_nop 0
    buffer_load_dwordx4 v10, s[48:51], s46 offen lds
    s_add_u32 m0, s45, 110592
    s_nop 0
    buffer_load_dwordx4 v11, s[48:51], s46 offen lds
    s_waitcnt vmcnt(14) lgkmcnt(0)
    s_barrier
    v_mfma_f32_16x16x32_bf16 v[36:39], v[100:103], v[68:71], v[36:39]
    v_add_u32 v16, 32768, v12
    v_add_u32 v18, 32768, v14
    v_add_u32 v17, 32768, v13
    v_add_u32 v19, 32768, v15
    ds_read_b64_tr_b16 v[84:85], v18 offset:0
    ds_read_b64_tr_b16 v[86:87], v18 offset:1024
    ds_read_b64_tr_b16 v[88:89], v19 offset:0
    ds_read_b64_tr_b16 v[90:91], v19 offset:1024
    v_mfma_f32_16x16x32_bf16 v[40:43], v[100:103], v[72:75], v[40:43]
    ds_read_b128 v[52:55], v16 offset:0
    ds_read_b128 v[56:59], v16 offset:2048
    ds_read_b64_tr_b16 v[92:93], v18 offset:4096
    ds_read_b64_tr_b16 v[94:95], v18 offset:5120
    ds_read_b64_tr_b16 v[96:97], v19 offset:4096
    ds_read_b64_tr_b16 v[98:99], v19 offset:5120
    ds_read_b128 v[60:63], v17 offset:0
    v_mfma_f32_16x16x32_bf16 v[44:47], v[104:107], v[68:71], v[44:47]
    ds_read_b128 v[64:67], v17 offset:2048
    s_movk_i32 s46, 2176
    s_add_u32 m0, s45, 114688
    s_nop 0
    buffer_load_dwordx4 v8, s[8:11], s46 offen sc1 lds
    s_add_u32 m0, s45, 118784
    s_nop 0
    v_mfma_f32_16x16x32_bf16 v[48:51], v[104:107], v[72:75], v[48:51]
    buffer_load_dwordx4 v9, s[8:11], s46 offen sc1 lds
    s_mov_b32 s46, 573440
    s_add_u32 m0, s45, 122880
    s_nop 0
    buffer_load_dwordx4 v10, s[48:51], s46 offen lds
    s_add_u32 m0, s45, 126976
    s_nop 0
    v_mfma_f32_16x16x32_bf16 v[36:39], v[108:111], v[76:79], v[36:39]
    buffer_load_dwordx4 v11, s[48:51], s46 offen lds
    s_movk_i32 s46, 2304
    s_add_u32 m0, s45, 131072
    s_nop 0
    buffer_load_dwordx4 v8, s[8:11], s46 offen sc1 lds
    s_add_u32 m0, s45, 135168
    s_nop 0
    buffer_load_dwordx4 v9, s[8:11], s46 offen sc1 lds
    v_mfma_f32_16x16x32_bf16 v[40:43], v[108:111], v[80:83], v[40:43]
    s_mov_b32 s46, 655360
    s_add_u32 m0, s45, 139264
    s_nop 0
    buffer_load_dwordx4 v10, s[48:51], s46 offen lds
    s_add_u32 m0, s45, 143360
    s_nop 0
    buffer_load_dwordx4 v11, s[48:51], s46 offen lds
    v_mfma_f32_16x16x32_bf16 v[44:47], v[112:115], v[76:79], v[44:47]
    s_movk_i32 s46, 2432
    s_add_u32 m0, s45, 0
    s_nop 0
    buffer_load_dwordx4 v8, s[8:11], s46 offen sc1 lds
    s_add_u32 m0, s45, 4096
    s_nop 0
    buffer_load_dwordx4 v9, s[8:11], s46 offen sc1 lds
    v_mfma_f32_16x16x32_bf16 v[48:51], v[112:115], v[80:83], v[48:51]
    s_mov_b32 s46, 737280
    s_add_u32 m0, s45, 8192
    s_nop 0
    buffer_load_dwordx4 v10, s[48:51], s46 offen lds
    s_add_u32 m0, s45, 12288
    s_nop 0
    buffer_load_dwordx4 v11, s[48:51], s46 offen lds
    s_waitcnt vmcnt(24) lgkmcnt(0)
    s_barrier
    v_mfma_f32_16x16x32_bf16 v[36:39], v[84:87], v[52:55], v[36:39]
    v_add_u32 v16, 49152, v12
    v_add_u32 v18, 49152, v14
    v_add_u32 v17, 49152, v13
    v_add_u32 v19, 49152, v15
    v_mfma_f32_16x16x32_bf16 v[40:43], v[84:87], v[56:59], v[40:43]
    ds_read_b64_tr_b16 v[100:101], v18 offset:0
    ds_read_b64_tr_b16 v[102:103], v18 offset:1024
    ds_read_b64_tr_b16 v[104:105], v19 offset:0
    ds_read_b64_tr_b16 v[106:107], v19 offset:1024
    v_mfma_f32_16x16x32_bf16 v[44:47], v[88:91], v[52:55], v[44:47]
    ds_read_b128 v[68:71], v16 offset:0
    ds_read_b128 v[72:75], v16 offset:2048
    ds_read_b64_tr_b16 v[108:109], v18 offset:4096
    ds_read_b64_tr_b16 v[110:111], v18 offset:5120
    v_mfma_f32_16x16x32_bf16 v[48:51], v[88:91], v[56:59], v[48:51]
    ds_read_b64_tr_b16 v[112:113], v19 offset:4096
    ds_read_b64_tr_b16 v[114:115], v19 offset:5120
    ds_read_b128 v[76:79], v17 offset:0
    v_mfma_f32_16x16x32_bf16 v[36:39], v[92:95], v[60:63], v[36:39]
    ds_read_b128 v[80:83], v17 offset:2048
    s_movk_i32 s46, 2560
    s_add_u32 m0, s45, 16384
    s_nop 0
    v_mfma_f32_16x16x32_bf16 v[40:43], v[92:95], v[64:67], v[40:43]
    buffer_load_dwordx4 v8, s[8:11], s46 offen sc1 lds
    s_add_u32 m0, s45, 20480
    s_nop 0
    buffer_load_dwordx4 v9, s[8:11], s46 offen sc1 lds
    v_mfma_f32_16x16x32_bf16 v[44:47], v[96:99], v[60:63], v[44:47]
    s_mov_b32 s46, 819200
    s_add_u32 m0, s45, 24576
    s_nop 0
    buffer_load_dwordx4 v10, s[48:51], s46 offen lds
    v_mfma_f32_16x16x32_bf16 v[48:51], v[96:99], v[64:67], v[48:51]
    s_add_u32 m0, s45, 28672
    s_nop 0
    buffer_load_dwordx4 v11, s[48:51], s46 offen lds
    s_waitcnt vmcnt(24) lgkmcnt(0)
    s_barrier
    v_mfma_f32_16x16x32_bf16 v[36:39], v[100:103], v[68:71], v[36:39]
    v_add_u32 v16, 65536, v12
    v_add_u32 v18, 65536, v14
    v_add_u32 v17, 65536, v13
    v_add_u32 v19, 65536, v15
    v_mfma_f32_16x16x32_bf16 v[40:43], v[100:103], v[72:75], v[40:43]
    ds_read_b64_tr_b16 v[84:85], v18 offset:0
    ds_read_b64_tr_b16 v[86:87], v18 offset:1024
    ds_read_b64_tr_b16 v[88:89], v19 offset:0
    ds_read_b64_tr_b16 v[90:91], v19 offset:1024
    v_mfma_f32_16x16x32_bf16 v[44:47], v[104:107], v[68:71], v[44:47]
    ds_read_b128 v[52:55], v16 offset:0
    ds_read_b128 v[56:59], v16 offset:2048
    ds_read_b64_tr_b16 v[92:93], v18 offset:4096
    ds_read_b64_tr_b16 v[94:95], v18 offset:5120
    v_mfma_f32_16x16x32_bf16 v[48:51], v[104:107], v[72:75], v[48:51]
    ds_read_b64_tr_b16 v[96:97], v19 offset:4096
    ds_read_b64_tr_b16 v[98:99], v19 offset:5120
    ds_read_b128 v[60:63], v17 offset:0
    v_mfma_f32_16x16x32_bf16 v[36:39], v[108:111], v[76:79], v[36:39]
    ds_read_b128 v[64:67], v17 offset:2048
    s_movk_i32 s46, 2688
    s_add_u32 m0, s45, 32768
    s_nop 0
    v_mfma_f32_16x16x32_bf16 v[40:43], v[108:111], v[80:83], v[40:43]
    buffer_load_dwordx4 v8, s[8:11], s46 offen sc1 lds
    s_add_u32 m0, s45, 36864
    s_nop 0
    buffer_load_dwordx4 v9, s[8:11], s46 offen sc1 lds
    v_mfma_f32_16x16x32_bf16 v[44:47], v[112:115], v[76:79], v[44:47]
    s_mov_b32 s46, 901120
    s_add_u32 m0, s45, 40960
    s_nop 0
    buffer_load_dwordx4 v10, s[48:51], s46 offen lds
    v_mfma_f32_16x16x32_bf16 v[48:51], v[112:115], v[80:83], v[48:51]
    s_add_u32 m0, s45, 45056
    s_nop 0
    buffer_load_dwordx4 v11, s[48:51], s46 offen lds
    s_waitcnt vmcnt(24) lgkmcnt(0)
    s_barrier
    v_mfma_f32_16x16x32_bf16 v[36:39], v[84:87], v[52:55], v[36:39]
    v_add_u32 v16, 81920, v12
    v_add_u32 v18, 81920, v14
    v_add_u32 v17, 81920, v13
    v_add_u32 v19, 81920, v15
    v_mfma_f32_16x16x32_bf16 v[40:43], v[84:87], v[56:59], v[40:43]
    ds_read_b64_tr_b16 v[100:101], v18 offset:0
    ds_read_b64_tr_b16 v[102:103], v18 offset:1024
    ds_read_b64_tr_b16 v[104:105], v19 offset:0
    ds_read_b64_tr_b16 v[106:107], v19 offset:1024
    v_mfma_f32_16x16x32_bf16 v[44:47], v[88:91], v[52:55], v[44:47]
    ds_read_b128 v[68:71], v16 offset:0
    ds_read_b128 v[72:75], v16 offset:2048
    ds_read_b64_tr_b16 v[108:109], v18 offset:4096
    ds_read_b64_tr_b16 v[110:111], v18 offset:5120
    v_mfma_f32_16x16x32_bf16 v[48:51], v[88:91], v[56:59], v[48:51]
    ds_read_b64_tr_b16 v[112:113], v19 offset:4096
    ds_read_b64_tr_b16 v[114:115], v19 offset:5120
    ds_read_b128 v[76:79], v17 offset:0
    v_mfma_f32_16x16x32_bf16 v[36:39], v[92:95], v[60:63], v[36:39]
    ds_read_b128 v[80:83], v17 offset:2048
    s_movk_i32 s46, 2816
    s_add_u32 m0, s45, 49152
    s_nop 0
    v_mfma_f32_16x16x32_bf16 v[40:43], v[92:95], v[64:67], v[40:43]
    buffer_load_dwordx4 v8, s[8:11], s46 offen sc1 lds
    s_add_u32 m0, s45, 53248
    s_nop 0
    buffer_load_dwordx4 v9, s[8:11], s46 offen sc1 lds
    v_mfma_f32_16x16x32_bf16 v[44:47], v[96:99], v[60:63], v[44:47]
    s_mov_b32 s46, 983040
    s_add_u32 m0, s45, 57344
    s_nop 0
    buffer_load_dwordx4 v10, s[48:51], s46 offen lds
    v_mfma_f32_16x16x32_bf16 v[48:51], v[96:99], v[64:67], v[48:51]
    s_add_u32 m0, s45, 61440
    s_nop 0
    buffer_load_dwordx4 v11, s[48:51], s46 offen lds
    s_waitcnt vmcnt(24) lgkmcnt(0)
    s_barrier
    v_mfma_f32_16x16x32_bf16 v[36:39], v[100:103], v[68:71], v[36:39]
    v_add_u32 v16, 98304, v12
    v_add_u32 v18, 98304, v14
    v_add_u32 v17, 98304, v13
    v_add_u32 v19, 98304, v15
    v_mfma_f32_16x16x32_bf16 v[40:43], v[100:103], v[72:75], v[40:43]
    ds_read_b64_tr_b16 v[84:85], v18 offset:0
    ds_read_b64_tr_b16 v[86:87], v18 offset:1024
    ds_read_b64_tr_b16 v[88:89], v19 offset:0
    ds_read_b64_tr_b16 v[90:91], v19 offset:1024
    v_mfma_f32_16x16x32_bf16 v[44:47], v[104:107], v[68:71], v[44:47]
    ds_read_b128 v[52:55], v16 offset:0
    ds_read_b128 v[56:59], v16 offset:2048
    ds_read_b64_tr_b16 v[92:93], v18 offset:4096
    ds_read_b64_tr_b16 v[94:95], v18 offset:5120
    v_mfma_f32_16x16x32_bf16 v[48:51], v[104:107], v[72:75], v[48:51]
    ds_read_b64_tr_b16 v[96:97], v19 offset:4096
    ds_read_b64_tr_b16 v[98:99], v19 offset:5120
    ds_read_b128 v[60:63], v17 offset:0
    v_mfma_f32_16x16x32_bf16 v[36:39], v[108:111], v[76:79], v[36:39]
    ds_read_b128 v[64:67], v17 offset:2048
    s_movk_i32 s46, 2944
    s_add_u32 m0, s45, 65536
    s_nop 0
    v_mfma_f32_16x16x32_bf16 v[40:43], v[108:111], v[80:83], v[40:43]
    buffer_load_dwordx4 v8, s[8:11], s46 offen sc1 lds
    s_add_u32 m0, s45, 69632
    s_nop 0
    buffer_load_dwordx4 v9, s[8:11], s46 offen sc1 lds
    v_mfma_f32_16x16x32_bf16 v[44:47], v[112:115], v[76:79], v[44:47]
    s_mov_b32 s46, 1064960
    s_add_u32 m0, s45, 73728
    s_nop 0
    buffer_load_dwordx4 v10, s[48:51], s46 offen lds
    v_mfma_f32_16x16x32_bf16 v[48:51], v[112:115], v[80:83], v[48:51]
    s_add_u32 m0, s45, 77824
    s_nop 0
    buffer_load_dwordx4 v11, s[48:51], s46 offen lds
    s_waitcnt vmcnt(24) lgkmcnt(0)
    s_barrier
    v_mfma_f32_16x16x32_bf16 v[36:39], v[84:87], v[52:55], v[36:39]
    v_add_u32 v16, 114688, v12
    v_add_u32 v18, 114688, v14
    v_add_u32 v17, 114688, v13
    v_add_u32 v19, 114688, v15
    v_mfma_f32_16x16x32_bf16 v[40:43], v[84:87], v[56:59], v[40:43]
    ds_read_b64_tr_b16 v[100:101], v18 offset:0
    ds_read_b64_tr_b16 v[102:103], v18 offset:1024
    ds_read_b64_tr_b16 v[104:105], v19 offset:0
    ds_read_b64_tr_b16 v[106:107], v19 offset:1024
    v_mfma_f32_16x16x32_bf16 v[44:47], v[88:91], v[52:55], v[44:47]
    ds_read_b128 v[68:71], v16 offset:0
    ds_read_b128 v[72:75], v16 offset:2048
    ds_read_b64_tr_b16 v[108:109], v18 offset:4096
    ds_read_b64_tr_b16 v[110:111], v18 offset:5120
    v_mfma_f32_16x16x32_bf16 v[48:51], v[88:91], v[56:59], v[48:51]
    ds_read_b64_tr_b16 v[112:113], v19 offset:4096
    ds_read_b64_tr_b16 v[114:115], v19 offset:5120
    ds_read_b128 v[76:79], v17 offset:0
    v_mfma_f32_16x16x32_bf16 v[36:39], v[92:95], v[60:63], v[36:39]
    ds_read_b128 v[80:83], v17 offset:2048
    s_movk_i32 s46, 3072
    s_add_u32 m0, s45, 81920
    s_nop 0
    v_mfma_f32_16x16x32_bf16 v[40:43], v[92:95], v[64:67], v[40:43]
    buffer_load_dwordx4 v8, s[8:11], s46 offen sc1 lds
    s_add_u32 m0, s45, 86016
    s_nop 0
    buffer_load_dwordx4 v9, s[8:11], s46 offen sc1 lds
    v_mfma_f32_16x16x32_bf16 v[44:47], v[96:99], v[60:63], v[44:47]
    s_mov_b32 s46, 1146880
    s_add_u32 m0, s45, 90112
    s_nop 0
    buffer_load_dwordx4 v10, s[48:51], s46 offen lds
    v_mfma_f32_16x16x32_bf16 v[48:51], v[96:99], v[64:67], v[48:51]
    s_add_u32 m0, s45, 94208
    s_nop 0
    buffer_load_dwordx4 v11, s[48:51], s46 offen lds
    s_waitcnt vmcnt(24) lgkmcnt(0)
    s_barrier
    v_mfma_f32_16x16x32_bf16 v[36:39], v[100:103], v[68:71], v[36:39]
    v_add_u32 v16, 131072, v12
    v_add_u32 v18, 131072, v14
    v_add_u32 v17, 131072, v13
    v_add_u32 v19, 131072, v15
    v_mfma_f32_16x16x32_bf16 v[40:43], v[100:103], v[72:75], v[40:43]
    ds_read_b64_tr_b16 v[84:85], v18 offset:0
    ds_read_b64_tr_b16 v[86:87], v18 offset:1024
    ds_read_b64_tr_b16 v[88:89], v19 offset:0
    ds_read_b64_tr_b16 v[90:91], v19 offset:1024
    v_mfma_f32_16x16x32_bf16 v[44:47], v[104:107], v[68:71], v[44:47]
    ds_read_b128 v[52:55], v16 offset:0
    ds_read_b128 v[56:59], v16 offset:2048
    ds_read_b64_tr_b16 v[92:93], v18 offset:4096
    ds_read_b64_tr_b16 v[94:95], v18 offset:5120
    v_mfma_f32_16x16x32_bf16 v[48:51], v[104:107], v[72:75], v[48:51]
    ds_read_b64_tr_b16 v[96:97], v19 offset:4096
    ds_read_b64_tr_b16 v[98:99], v19 offset:5120
    ds_read_b128 v[60:63], v17 offset:0
    v_mfma_f32_16x16x32_bf16 v[36:39], v[108:111], v[76:79], v[36:39]
    ds_read_b128 v[64:67], v17 offset:2048
    s_movk_i32 s46, 3200
    s_add_u32 m0, s45, 98304
    s_nop 0
    v_mfma_f32_16x16x32_bf16 v[40:43], v[108:111], v[80:83], v[40:43]
    buffer_load_dwordx4 v8, s[8:11], s46 offen sc1 lds
    s_add_u32 m0, s45, 102400
    s_nop 0
    buffer_load_dwordx4 v9, s[8:11], s46 offen sc1 lds
    v_mfma_f32_16x16x32_bf16 v[44:47], v[112:115], v[76:79], v[44:47]
    s_mov_b32 s46, 1228800
    s_add_u32 m0, s45, 106496
    s_nop 0
    buffer_load_dwordx4 v10, s[48:51], s46 offen lds
    v_mfma_f32_16x16x32_bf16 v[48:51], v[112:115], v[80:83], v[48:51]
    s_add_u32 m0, s45, 110592
    s_nop 0
    buffer_load_dwordx4 v11, s[48:51], s46 offen lds
    s_waitcnt vmcnt(24) lgkmcnt(0)
    s_barrier
    v_mfma_f32_16x16x32_bf16 v[36:39], v[84:87], v[52:55], v[36:39]
    v_add_u32 v16, 0, v12
    v_add_u32 v18, 0, v14
    v_add_u32 v17, 0, v13
    v_add_u32 v19, 0, v15
    v_mfma_f32_16x16x32_bf16 v[40:43], v[84:87], v[56:59], v[40:43]
    ds_read_b64_tr_b16 v[100:101], v18 offset:0
    ds_read_b64_tr_b16 v[102:103], v18 offset:1024
    ds_read_b64_tr_b16 v[104:105], v19 offset:0
    ds_read_b64_tr_b16 v[106:107], v19 offset:1024
    v_mfma_f32_16x16x32_bf16 v[44:47], v[88:91], v[52:55], v[44:47]
    ds_read_b128 v[68:71], v16 offset:0
    ds_read_b128 v[72:75], v16 offset:2048
    ds_read_b64_tr_b16 v[108:109], v18 offset:4096
    ds_read_b64_tr_b16 v[110:111], v18 offset:5120
    v_mfma_f32_16x16x32_bf16 v[48:51], v[88:91], v[56:59], v[48:51]
    ds_read_b64_tr_b16 v[112:113], v19 offset:4096
    ds_read_b64_tr_b16 v[114:115], v19 offset:5120
    ds_read_b128 v[76:79], v17 offset:0
    v_mfma_f32_16x16x32_bf16 v[36:39], v[92:95], v[60:63], v[36:39]
    ds_read_b128 v[80:83], v17 offset:2048
    s_movk_i32 s46, 3328
    s_add_u32 m0, s45, 114688
    s_nop 0
    v_mfma_f32_16x16x32_bf16 v[40:43], v[92:95], v[64:67], v[40:43]
    buffer_load_dwordx4 v8, s[8:11], s46 offen sc1 lds
    s_add_u32 m0, s45, 118784
    s_nop 0
    buffer_load_dwordx4 v9, s[8:11], s46 offen sc1 lds
    v_mfma_f32_16x16x32_bf16 v[44:47], v[96:99], v[60:63], v[44:47]
    s_mov_b32 s46, 1310720
    s_add_u32 m0, s45, 122880
    s_nop 0
    buffer_load_dwordx4 v10, s[48:51], s46 offen lds
    v_mfma_f32_16x16x32_bf16 v[48:51], v[96:99], v[64:67], v[48:51]
    s_add_u32 m0, s45, 126976
    s_nop 0
    buffer_load_dwordx4 v11, s[48:51], s46 offen lds
    s_waitcnt vmcnt(24) lgkmcnt(0)
    s_barrier
    v_mfma_f32_16x16x32_bf16 v[36:39], v[100:103], v[68:71], v[36:39]
    v_add_u32 v16, 16384, v12
    v_add_u32 v18, 16384, v14
    v_add_u32 v17, 16384, v13
    v_add_u32 v19, 16384, v15
    v_mfma_f32_16x16x32_bf16 v[40:43], v[100:103], v[72:75], v[40:43]
    ds_read_b64_tr_b16 v[84:85], v18 offset:0
    ds_read_b64_tr_b16 v[86:87], v18 offset:1024
    ds_read_b64_tr_b16 v[88:89], v19 offset:0
    ds_read_b64_tr_b16 v[90:91], v19 offset:1024
    v_mfma_f32_16x16x32_bf16 v[44:47], v[104:107], v[68:71], v[44:47]
    ds_read_b128 v[52:55], v16 offset:0
    ds_read_b128 v[56:59], v16 offset:2048
    ds_read_b64_tr_b16 v[92:93], v18 offset:4096
    ds_read_b64_tr_b16 v[94:95], v18 offset:5120
    v_mfma_f32_16x16x32_bf16 v[48:51], v[104:107], v[72:75], v[48:51]
    ds_read_b64_tr_b16 v[96:97], v19 offset:4096
    ds_read_b64_tr_b16 v[98:99], v19 offset:5120
    ds_read_b128 v[60:63], v17 offset:0
    v_mfma_f32_16x16x32_bf16 v[36:39], v[108:111], v[76:79], v[36:39]
    ds_read_b128 v[64:67], v17 offset:2048
    s_movk_i32 s46, 3456
    s_add_u32 m0, s45, 131072
    s_nop 0
    v_mfma_f32_16x16x32_bf16 v[40:43], v[108:111], v[80:83], v[40:43]
    buffer_load_dwordx4 v8, s[8:11], s46 offen sc1 lds
    s_add_u32 m0, s45, 135168
    s_nop 0
    buffer_load_dwordx4 v9, s[8:11], s46 offen sc1 lds
    v_mfma_f32_16x16x32_bf16 v[44:47], v[112:115], v[76:79], v[44:47]
    s_mov_b32 s46, 1392640
    s_add_u32 m0, s45, 139264
    s_nop 0
    buffer_load_dwordx4 v10, s[48:51], s46 offen lds
    v_mfma_f32_16x16x32_bf16 v[48:51], v[112:115], v[80:83], v[48:51]
    s_add_u32 m0, s45, 143360
    s_nop 0
    buffer_load_dwordx4 v11, s[48:51], s46 offen lds
    s_waitcnt vmcnt(24) lgkmcnt(0)
    s_barrier
    v_mfma_f32_16x16x32_bf16 v[36:39], v[84:87], v[52:55], v[36:39]
    v_add_u32 v16, 32768, v12
    v_add_u32 v18, 32768, v14
    v_add_u32 v17, 32768, v13
    v_add_u32 v19, 32768, v15
    v_mfma_f32_16x16x32_bf16 v[40:43], v[84:87], v[56:59], v[40:43]
    ds_read_b64_tr_b16 v[100:101], v18 offset:0
    ds_read_b64_tr_b16 v[102:103], v18 offset:1024
    ds_read_b64_tr_b16 v[104:105], v19 offset:0
    ds_read_b64_tr_b16 v[106:107], v19 offset:1024
    v_mfma_f32_16x16x32_bf16 v[44:47], v[88:91], v[52:55], v[44:47]
    ds_read_b128 v[68:71], v16 offset:0
    ds_read_b128 v[72:75], v16 offset:2048
    ds_read_b64_tr_b16 v[108:109], v18 offset:4096
    ds_read_b64_tr_b16 v[110:111], v18 offset:5120
    v_mfma_f32_16x16x32_bf16 v[48:51], v[88:91], v[56:59], v[48:51]
    ds_read_b64_tr_b16 v[112:113], v19 offset:4096
    ds_read_b64_tr_b16 v[114:115], v19 offset:5120
    ds_read_b128 v[76:79], v17 offset:0
    v_mfma_f32_16x16x32_bf16 v[36:39], v[92:95], v[60:63], v[36:39]
    ds_read_b128 v[80:83], v17 offset:2048
    s_movk_i32 s46, 3584
    s_add_u32 m0, s45, 0
    s_nop 0
    v_mfma_f32_16x16x32_bf16 v[40:43], v[92:95], v[64:67], v[40:43]
    buffer_load_dwordx4 v8, s[8:11], s46 offen sc1 lds
    s_add_u32 m0, s45, 4096
    s_nop 0
    buffer_load_dwordx4 v9, s[8:11], s46 offen sc1 lds
    v_mfma_f32_16x16x32_bf16 v[44:47], v[96:99], v[60:63], v[44:47]
    s_mov_b32 s46, 1474560
    s_add_u32 m0, s45, 8192
    s_nop 0
    buffer_load_dwordx4 v10, s[48:51], s46 offen lds
    v_mfma_f32_16x16x32_bf16 v[48:51], v[96:99], v[64:67], v[48:51]
    s_add_u32 m0, s45, 12288
    s_nop 0
    buffer_load_dwordx4 v11, s[48:51], s46 offen lds
    s_waitcnt vmcnt(24) lgkmcnt(0)
    s_barrier
    v_mfma_f32_16x16x32_bf16 v[36:39], v[100:103], v[68:71], v[36:39]
    v_add_u32 v16, 49152, v12
    v_add_u32 v18, 49152, v14
    v_add_u32 v17, 49152, v13
    v_add_u32 v19, 49152, v15
    v_mfma_f32_16x16x32_bf16 v[40:43], v[100:103], v[72:75], v[40:43]
    ds_read_b64_tr_b16 v[84:85], v18 offset:0
    ds_read_b64_tr_b16 v[86:87], v18 offset:1024
    ds_read_b64_tr_b16 v[88:89], v19 offset:0
    ds_read_b64_tr_b16 v[90:91], v19 offset:1024
    v_mfma_f32_16x16x32_bf16 v[44:47], v[104:107], v[68:71], v[44:47]
    ds_read_b128 v[52:55], v16 offset:0
    ds_read_b128 v[56:59], v16 offset:2048
    ds_read_b64_tr_b16 v[92:93], v18 offset:4096
    ds_read_b64_tr_b16 v[94:95], v18 offset:5120
    v_mfma_f32_16x16x32_bf16 v[48:51], v[104:107], v[72:75], v[48:51]
    ds_read_b64_tr_b16 v[96:97], v19 offset:4096
    ds_read_b64_tr_b16 v[98:99], v19 offset:5120
    ds_read_b128 v[60:63], v17 offset:0
    v_mfma_f32_16x16x32_bf16 v[36:39], v[108:111], v[76:79], v[36:39]
    ds_read_b128 v[64:67], v17 offset:2048
    s_movk_i32 s46, 3712
    s_add_u32 m0, s45, 16384
    s_nop 0
    v_mfma_f32_16x16x32_bf16 v[40:43], v[108:111], v[80:83], v[40:43]
    buffer_load_dwordx4 v8, s[8:11], s46 offen sc1 lds
    s_add_u32 m0, s45, 20480
    s_nop 0
    buffer_load_dwordx4 v9, s[8:11], s46 offen sc1 lds
    v_mfma_f32_16x16x32_bf16 v[44:47], v[112:115], v[76:79], v[44:47]
    s_mov_b32 s46, 1556480
    s_add_u32 m0, s45, 24576
    s_nop 0
    buffer_load_dwordx4 v10, s[48:51], s46 offen lds
    v_mfma_f32_16x16x32_bf16 v[48:51], v[112:115], v[80:83], v[48:51]
    s_add_u32 m0, s45, 28672
    s_nop 0
    buffer_load_dwordx4 v11, s[48:51], s46 offen lds
    s_waitcnt vmcnt(24) lgkmcnt(0)
    s_barrier
    v_mfma_f32_16x16x32_bf16 v[36:39], v[84:87], v[52:55], v[36:39]
    v_add_u32 v16, 65536, v12
    v_add_u32 v18, 65536, v14
    v_add_u32 v17, 65536, v13
    v_add_u32 v19, 65536, v15
    v_mfma_f32_16x16x32_bf16 v[40:43], v[84:87], v[56:59], v[40:43]
    ds_read_b64_tr_b16 v[100:101], v18 offset:0
    ds_read_b64_tr_b16 v[102:103], v18 offset:1024
    ds_read_b64_tr_b16 v[104:105], v19 offset:0
    ds_read_b64_tr_b16 v[106:107], v19 offset:1024
    v_mfma_f32_16x16x32_bf16 v[44:47], v[88:91], v[52:55], v[44:47]
    ds_read_b128 v[68:71], v16 offset:0
    ds_read_b128 v[72:75], v16 offset:2048
    ds_read_b64_tr_b16 v[108:109], v18 offset:4096
    ds_read_b64_tr_b16 v[110:111], v18 offset:5120
    v_mfma_f32_16x16x32_bf16 v[48:51], v[88:91], v[56:59], v[48:51]
    ds_read_b64_tr_b16 v[112:113], v19 offset:4096
    ds_read_b64_tr_b16 v[114:115], v19 offset:5120
    ds_read_b128 v[76:79], v17 offset:0
    v_mfma_f32_16x16x32_bf16 v[36:39], v[92:95], v[60:63], v[36:39]
    ds_read_b128 v[80:83], v17 offset:2048
    s_movk_i32 s46, 3840
    s_add_u32 m0, s45, 32768
    s_nop 0
    v_mfma_f32_16x16x32_bf16 v[40:43], v[92:95], v[64:67], v[40:43]
    buffer_load_dwordx4 v8, s[8:11], s46 offen sc1 lds
    s_add_u32 m0, s45, 36864
    s_nop 0
    buffer_load_dwordx4 v9, s[8:11], s46 offen sc1 lds
    v_mfma_f32_16x16x32_bf16 v[44:47], v[96:99], v[60:63], v[44:47]
    s_mov_b32 s46, 1638400
    s_add_u32 m0, s45, 40960
    s_nop 0
    buffer_load_dwordx4 v10, s[48:51], s46 offen lds
    v_mfma_f32_16x16x32_bf16 v[48:51], v[96:99], v[64:67], v[48:51]
    s_add_u32 m0, s45, 45056
    s_nop 0
    buffer_load_dwordx4 v11, s[48:51], s46 offen lds
    s_waitcnt vmcnt(24) lgkmcnt(0)
    s_barrier
    v_mfma_f32_16x16x32_bf16 v[36:39], v[100:103], v[68:71], v[36:39]
    v_add_u32 v16, 81920, v12
    v_add_u32 v18, 81920, v14
    v_add_u32 v17, 81920, v13
    v_add_u32 v19, 81920, v15
    v_mfma_f32_16x16x32_bf16 v[40:43], v[100:103], v[72:75], v[40:43]
    ds_read_b64_tr_b16 v[84:85], v18 offset:0
    ds_read_b64_tr_b16 v[86:87], v18 offset:1024
    ds_read_b64_tr_b16 v[88:89], v19 offset:0
    ds_read_b64_tr_b16 v[90:91], v19 offset:1024
    v_mfma_f32_16x16x32_bf16 v[44:47], v[104:107], v[68:71], v[44:47]
    ds_read_b128 v[52:55], v16 offset:0
    ds_read_b128 v[56:59], v16 offset:2048
    ds_read_b64_tr_b16 v[92:93], v18 offset:4096
    ds_read_b64_tr_b16 v[94:95], v18 offset:5120
    v_mfma_f32_16x16x32_bf16 v[48:51], v[104:107], v[72:75], v[48:51]
    ds_read_b64_tr_b16 v[96:97], v19 offset:4096
    ds_read_b64_tr_b16 v[98:99], v19 offset:5120
    ds_read_b128 v[60:63], v17 offset:0
    v_mfma_f32_16x16x32_bf16 v[36:39], v[108:111], v[76:79], v[36:39]
    ds_read_b128 v[64:67], v17 offset:2048
    s_movk_i32 s46, 3968
    s_add_u32 m0, s45, 49152
    s_nop 0
    v_mfma_f32_16x16x32_bf16 v[40:43], v[108:111], v[80:83], v[40:43]
    buffer_load_dwordx4 v8, s[8:11], s46 offen sc1 lds
    s_add_u32 m0, s45, 53248
    s_nop 0
    buffer_load_dwordx4 v9, s[8:11], s46 offen sc1 lds
    v_mfma_f32_16x16x32_bf16 v[44:47], v[112:115], v[76:79], v[44:47]
    s_mov_b32 s46, 1720320
    s_add_u32 m0, s45, 57344
    s_nop 0
    buffer_load_dwordx4 v10, s[48:51], s46 offen lds
    v_mfma_f32_16x16x32_bf16 v[48:51], v[112:115], v[80:83], v[48:51]
    s_add_u32 m0, s45, 61440
    s_nop 0
    buffer_load_dwordx4 v11, s[48:51], s46 offen lds
    s_waitcnt vmcnt(24) lgkmcnt(0)
    s_barrier
    v_mfma_f32_16x16x32_bf16 v[36:39], v[84:87], v[52:55], v[36:39]
    v_add_u32 v16, 98304, v12
    v_add_u32 v18, 98304, v14
    v_add_u32 v17, 98304, v13
    v_add_u32 v19, 98304, v15
    v_mfma_f32_16x16x32_bf16 v[40:43], v[84:87], v[56:59], v[40:43]
    ds_read_b64_tr_b16 v[100:101], v18 offset:0
    ds_read_b64_tr_b16 v[102:103], v18 offset:1024
    ds_read_b64_tr_b16 v[104:105], v19 offset:0
    ds_read_b64_tr_b16 v[106:107], v19 offset:1024
    v_mfma_f32_16x16x32_bf16 v[44:47], v[88:91], v[52:55], v[44:47]
    ds_read_b128 v[68:71], v16 offset:0
    ds_read_b128 v[72:75], v16 offset:2048
    ds_read_b64_tr_b16 v[108:109], v18 offset:4096
    ds_read_b64_tr_b16 v[110:111], v18 offset:5120
    v_mfma_f32_16x16x32_bf16 v[48:51], v[88:91], v[56:59], v[48:51]
    ds_read_b64_tr_b16 v[112:113], v19 offset:4096
    ds_read_b64_tr_b16 v[114:115], v19 offset:5120
    ds_read_b128 v[76:79], v17 offset:0
    v_mfma_f32_16x16x32_bf16 v[36:39], v[92:95], v[60:63], v[36:39]
    ds_read_b128 v[80:83], v17 offset:2048
    s_movk_i32 s46, 4096
    s_add_u32 m0, s45, 65536
    s_nop 0
    v_mfma_f32_16x16x32_bf16 v[40:43], v[92:95], v[64:67], v[40:43]
    buffer_load_dwordx4 v8, s[8:11], s46 offen sc1 lds
    s_add_u32 m0, s45, 69632
    s_nop 0
    buffer_load_dwordx4 v9, s[8:11], s46 offen sc1 lds
    v_mfma_f32_16x16x32_bf16 v[44:47], v[96:99], v[60:63], v[44:47]
    s_mov_b32 s46, 1802240
    s_add_u32 m0, s45, 73728
    s_nop 0
    buffer_load_dwordx4 v10, s[48:51], s46 offen lds
    v_mfma_f32_16x16x32_bf16 v[48:51], v[96:99], v[64:67], v[48:51]
    s_add_u32 m0, s45, 77824
    s_nop 0
    buffer_load_dwordx4 v11, s[48:51], s46 offen lds
    s_waitcnt vmcnt(24) lgkmcnt(0)
    s_barrier
    v_mfma_f32_16x16x32_bf16 v[36:39], v[100:103], v[68:71], v[36:39]
    v_add_u32 v16, 114688, v12
    v_add_u32 v18, 114688, v14
    v_add_u32 v17, 114688, v13
    v_add_u32 v19, 114688, v15
    v_mfma_f32_16x16x32_bf16 v[40:43], v[100:103], v[72:75], v[40:43]
    ds_read_b64_tr_b16 v[84:85], v18 offset:0
    ds_read_b64_tr_b16 v[86:87], v18 offset:1024
    ds_read_b64_tr_b16 v[88:89], v19 offset:0
    ds_read_b64_tr_b16 v[90:91], v19 offset:1024
    v_mfma_f32_16x16x32_bf16 v[44:47], v[104:107], v[68:71], v[44:47]
    ds_read_b128 v[52:55], v16 offset:0
    ds_read_b128 v[56:59], v16 offset:2048
    ds_read_b64_tr_b16 v[92:93], v18 offset:4096
    ds_read_b64_tr_b16 v[94:95], v18 offset:5120
    v_mfma_f32_16x16x32_bf16 v[48:51], v[104:107], v[72:75], v[48:51]
    ds_read_b64_tr_b16 v[96:97], v19 offset:4096
    ds_read_b64_tr_b16 v[98:99], v19 offset:5120
    ds_read_b128 v[60:63], v17 offset:0
    v_mfma_f32_16x16x32_bf16 v[36:39], v[108:111], v[76:79], v[36:39]
    ds_read_b128 v[64:67], v17 offset:2048
    s_movk_i32 s46, 4224
    s_add_u32 m0, s45, 81920
    s_nop 0
    v_mfma_f32_16x16x32_bf16 v[40:43], v[108:111], v[80:83], v[40:43]
    buffer_load_dwordx4 v8, s[8:11], s46 offen sc1 lds
    s_add_u32 m0, s45, 86016
    s_nop 0
    buffer_load_dwordx4 v9, s[8:11], s46 offen sc1 lds
    v_mfma_f32_16x16x32_bf16 v[44:47], v[112:115], v[76:79], v[44:47]
    s_mov_b32 s46, 1884160
    s_add_u32 m0, s45, 90112
    s_nop 0
    buffer_load_dwordx4 v10, s[48:51], s46 offen lds
    v_mfma_f32_16x16x32_bf16 v[48:51], v[112:115], v[80:83], v[48:51]
    s_add_u32 m0, s45, 94208
    s_nop 0
    buffer_load_dwordx4 v11, s[48:51], s46 offen lds
    s_waitcnt vmcnt(24) lgkmcnt(0)
    s_cmp_lg_u32 s39, 0
    s_cbranch_scc1 PS_33
    v_mov_b32 v4, s56
    s_mov_b64 exec, 1
    s_mov_b32 s58, 200000
PL_31:
    buffer_load_dword v5, v4, s[52:55], 0 offen offset:4 sc1
    s_waitcnt vmcnt(0)
    v_cmp_gt_u32 vcc, s59, v5
    s_nop 4
    s_cbranch_vccz PD_32
    s_sleep 8
    s_sub_u32 s58, s58, 1
    s_cmp_lg_u32 s58, 0
    s_cbranch_scc1 PL_31
PD_32:
    s_mov_b64 exec, -1
PS_33:
    s_barrier
    v_mfma_f32_16x16x32_bf16 v[36:39], v[84:87], v[52:55], v[36:39]
    v_add_u32 v16, 131072, v12
    v_add_u32 v18, 131072, v14
    v_add_u32 v17, 131072, v13
    v_add_u32 v19, 131072, v15
    v_mfma_f32_16x16x32_bf16 v[40:43], v[84:87], v[56:59], v[40:43]
    ds_read_b64_tr_b16 v[100:101], v18 offset:0
    ds_read_b64_tr_b16 v[102:103], v18 offset:1024
    ds_read_b64_tr_b16 v[104:105], v19 offset:0
    ds_read_b64_tr_b16 v[106:107], v19 offset:1024
    v_mfma_f32_16x16x32_bf16 v[44:47], v[88:91], v[52:55], v[44:47]
    ds_read_b128 v[68:71], v16 offset:0
    ds_read_b128 v[72:75], v16 offset:2048
    ds_read_b64_tr_b16 v[108:109], v18 offset:4096
    ds_read_b64_tr_b16 v[110:111], v18 offset:5120
    v_mfma_f32_16x16x32_bf16 v[48:51], v[88:91], v[56:59], v[48:51]
    ds_read_b64_tr_b16 v[112:113], v19 offset:4096
    ds_read_b64_tr_b16 v[114:115], v19 offset:5120
    ds_read_b128 v[76:79], v17 offset:0
    v_mfma_f32_16x16x32_bf16 v[36:39], v[92:95], v[60:63], v[36:39]
    ds_read_b128 v[80:83], v17 offset:2048
    s_movk_i32 s46, 0
    s_add_u32 m0, s45, 98304
    s_nop 0
    v_mfma_f32_16x16x32_bf16 v[40:43], v[92:95], v[64:67], v[40:43]
    buffer_load_dwordx4 v8, s[8:11], s46 offen sc1 lds
    s_add_u32 m0, s45, 102400
    s_nop 0
    buffer_load_dwordx4 v9, s[8:11], s46 offen sc1 lds
    v_mfma_f32_16x16x32_bf16 v[44:47], v[96:99], v[60:63], v[44:47]
    s_mov_b32 s46, 0
    s_add_u32 m0, s45, 106496
    s_nop 0
    buffer_load_dwordx4 v10, s[12:15], s46 offen lds
    v_mfma_f32_16x16x32_bf16 v[48:51], v[96:99], v[64:67], v[48:51]
    s_add_u32 m0, s45, 110592
    s_nop 0
    buffer_load_dwordx4 v11, s[12:15], s46 offen lds
    s_waitcnt vmcnt(24) lgkmcnt(0)
    s_barrier
    v_mfma_f32_16x16x32_bf16 v[36:39], v[100:103], v[68:71], v[36:39]
    v_add_u32 v16, 0, v12
    v_add_u32 v18, 0, v14
    v_add_u32 v17, 0, v13
    v_add_u32 v19, 0, v15
    v_mfma_f32_16x16x32_bf16 v[40:43], v[100:103], v[72:75], v[40:43]
    ds_read_b64_tr_b16 v[84:85], v18 offset:0
    ds_read_b64_tr_b16 v[86:87], v18 offset:1024
    ds_read_b64_tr_b16 v[88:89], v19 offset:0
    ds_read_b64_tr_b16 v[90:91], v19 offset:1024
    v_mfma_f32_16x16x32_bf16 v[44:47], v[104:107], v[68:71], v[44:47]
    ds_read_b128 v[52:55], v16 offset:0
    ds_read_b128 v[56:59], v16 offset:2048
    ds_read_b64_tr_b16 v[92:93], v18 offset:4096
    ds_read_b64_tr_b16 v[94:95], v18 offset:5120
    v_mfma_f32_16x16x32_bf16 v[48:51], v[104:107], v[72:75], v[48:51]
    ds_read_b64_tr_b16 v[96:97], v19 offset:4096
    ds_read_b64_tr_b16 v[98:99], v19 offset:5120
    ds_read_b128 v[60:63], v17 offset:0
    v_mfma_f32_16x16x32_bf16 v[36:39], v[108:111], v[76:79], v[36:39]
    ds_read_b128 v[64:67], v17 offset:2048
    s_movk_i32 s46, 128
    s_add_u32 m0, s45, 114688
    s_nop 0
    v_mfma_f32_16x16x32_bf16 v[40:43], v[108:111], v[80:83], v[40:43]
    buffer_load_dwordx4 v8, s[8:11], s46 offen sc1 lds
    s_add_u32 m0, s45, 118784
    s_nop 0
    buffer_load_dwordx4 v9, s[8:11], s46 offen sc1 lds
    v_mfma_f32_16x16x32_bf16 v[44:47], v[112:115], v[76:79], v[44:47]
    s_mov_b32 s46, 81920
    s_add_u32 m0, s45, 122880
    s_nop 0
    buffer_load_dwordx4 v10, s[12:15], s46 offen lds
    v_mfma_f32_16x16x32_bf16 v[48:51], v[112:115], v[80:83], v[48:51]
    s_add_u32 m0, s45, 126976
    s_nop 0
    buffer_load_dwordx4 v11, s[12:15], s46 offen lds
    s_waitcnt vmcnt(24) lgkmcnt(0)
    s_barrier
    v_mfma_f32_16x16x32_bf16 v[36:39], v[84:87], v[52:55], v[36:39]
    v_add_u32 v16, 16384, v12
    v_add_u32 v18, 16384, v14
    v_add_u32 v17, 16384, v13
    v_add_u32 v19, 16384, v15
    v_mfma_f32_16x16x32_bf16 v[40:43], v[84:87], v[56:59], v[40:43]
    ds_read_b64_tr_b16 v[100:101], v18 offset:0
    ds_read_b64_tr_b16 v[102:103], v18 offset:1024
    ds_read_b64_tr_b16 v[104:105], v19 offset:0
    ds_read_b64_tr_b16 v[106:107], v19 offset:1024
    v_mfma_f32_16x16x32_bf16 v[44:47], v[88:91], v[52:55], v[44:47]
    ds_read_b128 v[68:71], v16 offset:0
    ds_read_b128 v[72:75], v16 offset:2048
    ds_read_b64_tr_b16 v[108:109], v18 offset:4096
    ds_read_b64_tr_b16 v[110:111], v18 offset:5120
    v_mfma_f32_16x16x32_bf16 v[48:51], v[88:91], v[56:59], v[48:51]
    ds_read_b64_tr_b16 v[112:113], v19 offset:4096
    ds_read_b64_tr_b16 v[114:115], v19 offset:5120
    ds_read_b128 v[76:79], v17 offset:0
    v_mfma_f32_16x16x32_bf16 v[36:39], v[92:95], v[60:63], v[36:39]
    ds_read_b128 v[80:83], v17 offset:2048
    s_movk_i32 s46, 256
    s_add_u32 m0, s45, 131072
    s_nop 0
    v_mfma_f32_16x16x32_bf16 v[40:43], v[92:95], v[64:67], v[40:43]
    buffer_load_dwordx4 v8, s[8:11], s46 offen sc1 lds
    s_add_u32 m0, s45, 135168
    s_nop 0
    buffer_load_dwordx4 v9, s[8:11], s46 offen sc1 lds
    v_mfma_f32_16x16x32_bf16 v[44:47], v[96:99], v[60:63], v[44:47]
    s_mov_b32 s46, 163840
    s_add_u32 m0, s45, 139264
    s_nop 0
    buffer_load_dwordx4 v10, s[12:15], s46 offen lds
    v_mfma_f32_16x16x32_bf16 v[48:51], v[96:99], v[64:67], v[48:51]
    s_add_u32 m0, s45, 143360
    s_nop 0
    buffer_load_dwordx4 v11, s[12:15], s46 offen lds
    s_waitcnt vmcnt(24) lgkmcnt(0)
    s_barrier
    v_mfma_f32_16x16x32_bf16 v[36:39], v[100:103], v[68:71], v[36:39]
    v_add_u32 v16, 32768, v12
    v_add_u32 v18, 32768, v14
    v_add_u32 v17, 32768, v13
    v_add_u32 v19, 32768, v15
    v_mfma_f32_16x16x32_bf16 v[40:43], v[100:103], v[72:75], v[40:43]
    ds_read_b64_tr_b16 v[84:85], v18 offset:0
    ds_read_b64_tr_b16 v[86:87], v18 offset:1024
    ds_read_b64_tr_b16 v[88:89], v19 offset:0
    ds_read_b64_tr_b16 v[90:91], v19 offset:1024
    v_mfma_f32_16x16x32_bf16 v[44:47], v[104:107], v[68:71], v[44:47]
    ds_read_b128 v[52:55], v16 offset:0
    ds_read_b128 v[56:59], v16 offset:2048
    ds_read_b64_tr_b16 v[92:93], v18 offset:4096
    ds_read_b64_tr_b16 v[94:95], v18 offset:5120
    v_mfma_f32_16x16x32_bf16 v[48:51], v[104:107], v[72:75], v[48:51]
    ds_read_b64_tr_b16 v[96:97], v19 offset:4096
    ds_read_b64_tr_b16 v[98:99], v19 offset:5120
    ds_read_b128 v[60:63], v17 offset:0
    v_mfma_f32_16x16x32_bf16 v[36:39], v[108:111], v[76:79], v[36:39]
    ds_read_b128 v[64:67], v17 offset:2048
    s_movk_i32 s46, 384
    s_add_u32 m0, s45, 0
    s_nop 0
    v_mfma_f32_16x16x32_bf16 v[40:43], v[108:111], v[80:83], v[40:43]
    buffer_load_dwordx4 v8, s[8:11], s46 offen sc1 lds
    s_add_u32 m0, s45, 4096
    s_nop 0
    buffer_load_dwordx4 v9, s[8:11], s46 offen sc1 lds
    v_mfma_f32_16x16x32_bf16 v[44:47], v[112:115], v[76:79], v[44:47]
    s_mov_b32 s46, 245760
    s_add_u32 m0, s45, 8192
    s_nop 0
    buffer_load_dwordx4 v10, s[12:15], s46 offen lds
    v_mfma_f32_16x16x32_bf16 v[48:51], v[112:115], v[80:83], v[48:51]
    s_add_u32 m0, s45, 12288
    s_nop 0
    buffer_load_dwordx4 v11, s[12:15], s46 offen lds
    s_waitcnt vmcnt(24) lgkmcnt(0)
    s_barrier
    v_mfma_f32_16x16x32_bf16 v[36:39], v[84:87], v[52:55], v[36:39]
    v_add_u32 v16, 49152, v12
    v_add_u32 v18, 49152, v14
    v_add_u32 v17, 49152, v13
    v_add_u32 v19, 49152, v15
    v_mfma_f32_16x16x32_bf16 v[40:43], v[84:87], v[56:59], v[40:43]
    ds_read_b64_tr_b16 v[100:101], v18 offset:0
    ds_read_b64_tr_b16 v[102:103], v18 offset:1024
    ds_read_b64_tr_b16 v[104:105], v19 offset:0
    ds_read_b64_tr_b16 v[106:107], v19 offset:1024
    v_mfma_f32_16x16x32_bf16 v[44:47], v[88:91], v[52:55], v[44:47]
    ds_read_b128 v[68:71], v16 offset:0
    ds_read_b128 v[72:75], v16 offset:2048
    ds_read_b64_tr_b16 v[108:109], v18 offset:4096
    ds_read_b64_tr_b16 v[110:111], v18 offset:5120
    v_mfma_f32_16x16x32_bf16 v[48:51], v[88:91], v[56:59], v[48:51]
    ds_read_b64_tr_b16 v[112:113], v19 offset:4096
    ds_read_b64_tr_b16 v[114:115], v19 offset:5120
    ds_read_b128 v[76:79], v17 offset:0
    v_mfma_f32_16x16x32_bf16 v[36:39], v[92:95], v[60:63], v[36:39]
    ds_read_b128 v[80:83], v17 offset:2048
    s_movk_i32 s46, 512
    s_add_u32 m0, s45, 16384
    s_nop 0
    v_mfma_f32_16x16x32_bf16 v[40:43], v[92:95], v[64:67], v[40:43]
    buffer_load_dwordx4 v8, s[8:11], s46 offen sc1 lds
    s_add_u32 m0, s45, 20480
    s_nop 0
    buffer_load_dwordx4 v9, s[8:11], s46 offen sc1 lds
    v_mfma_f32_16x16x32_bf16 v[44:47], v[96:99], v[60:63], v[44:47]
    s_mov_b32 s46, 327680
    s_add_u32 m0, s45, 24576
    s_nop 0
    buffer_load_dwordx4 v10, s[12:15], s46 offen lds
    v_mfma_f32_16x16x32_bf16 v[48:51], v[96:99], v[64:67], v[48:51]
    s_add_u32 m0, s45, 28672
    s_nop 0
    buffer_load_dwordx4 v11, s[12:15], s46 offen lds
    s_waitcnt vmcnt(24) lgkmcnt(0)
    s_barrier
    v_mfma_f32_16x16x32_bf16 v[36:39], v[100:103], v[68:71], v[36:39]
    v_add_u32 v16, 65536, v12
    v_add_u32 v18, 65536, v14
    v_add_u32 v17, 65536, v13
    v_add_u32 v19, 65536, v15
    v_mfma_f32_16x16x32_bf16 v[40:43], v[100:103], v[72:75], v[40:43]
    ds_read_b64_tr_b16 v[84:85], v18 offset:0
    ds_read_b64_tr_b16 v[86:87], v18 offset:1024
    ds_read_b64_tr_b16 v[88:89], v19 offset:0
    ds_read_b64_tr_b16 v[90:91], v19 offset:1024
    v_mfma_f32_16x16x32_bf16 v[44:47], v[104:107], v[68:71], v[44:47]
    ds_read_b128 v[52:55], v16 offset:0
    ds_read_b128 v[56:59], v16 offset:2048
    ds_read_b64_tr_b16 v[92:93], v18 offset:4096
    ds_read_b64_tr_b16 v[94:95], v18 offset:5120
    v_mfma_f32_16x16x32_bf16 v[48:51], v[104:107], v[72:75], v[48:51]
    ds_read_b64_tr_b16 v[96:97], v19 offset:4096
    ds_read_b64_tr_b16 v[98:99], v19 offset:5120
    ds_read_b128 v[60:63], v17 offset:0
    v_mfma_f32_16x16x32_bf16 v[36:39], v[108:111], v[76:79], v[36:39]
    ds_read_b128 v[64:67], v17 offset:2048
    s_movk_i32 s46, 640
    s_add_u32 m0, s45, 32768
    s_nop 0
    v_mfma_f32_16x16x32_bf16 v[40:43], v[108:111], v[80:83], v[40:43]
    buffer_load_dwordx4 v8, s[8:11], s46 offen sc1 lds
    s_add_u32 m0, s45, 36864
    s_nop 0
    buffer_load_dwordx4 v9, s[8:11], s46 offen sc1 lds
    v_mfma_f32_16x16x32_bf16 v[44:47], v[112:115], v[76:79], v[44:47]
    s_mov_b32 s46, 409600
    s_add_u32 m0, s45, 40960
    s_nop 0
    buffer_load_dwordx4 v10, s[12:15], s46 offen lds
    v_mfma_f32_16x16x32_bf16 v[48:51], v[112:115], v[80:83], v[48:51]
    s_add_u32 m0, s45, 45056
    s_nop 0
    buffer_load_dwordx4 v11, s[12:15], s46 offen lds
    s_waitcnt vmcnt(24) lgkmcnt(0)
    s_barrier
    v_mfma_f32_16x16x32_bf16 v[36:39], v[84:87], v[52:55], v[36:39]
    v_add_u32 v16, 81920, v12
    v_add_u32 v18, 81920, v14
    v_add_u32 v17, 81920, v13
    v_add_u32 v19, 81920, v15
    v_mfma_f32_16x16x32_bf16 v[40:43], v[84:87], v[56:59], v[40:43]
    ds_read_b64_tr_b16 v[100:101], v18 offset:0
    ds_read_b64_tr_b16 v[102:103], v18 offset:1024
    ds_read_b64_tr_b16 v[104:105], v19 offset:0
    ds_read_b64_tr_b16 v[106:107], v19 offset:1024
    v_mfma_f32_16x16x32_bf16 v[44:47], v[88:91], v[52:55], v[44:47]
    ds_read_b128 v[68:71], v16 offset:0
    ds_read_b128 v[72:75], v16 offset:2048
    ds_read_b64_tr_b16 v[108:109], v18 offset:4096
    ds_read_b64_tr_b16 v[110:111], v18 offset:5120
    v_mfma_f32_16x16x32_bf16 v[48:51], v[88:91], v[56:59], v[48:51]
    ds_read_b64_tr_b16 v[112:113], v19 offset:4096
    ds_read_b64_tr_b16 v[114:115], v19 offset:5120
    ds_read_b128 v[76:79], v17 offset:0
    v_mfma_f32_16x16x32_bf16 v[36:39], v[92:95], v[60:63], v[36:39]
    ds_read_b128 v[80:83], v17 offset:2048
    s_movk_i32 s46, 768
    s_add_u32 m0, s45, 49152
    s_nop 0
    v_mfma_f32_16x16x32_bf16 v[40:43], v[92:95], v[64:67], v[40:43]
    buffer_load_dwordx4 v8, s[8:11], s46 offen sc1 lds
    s_add_u32 m0, s45, 53248
    s_nop 0
    buffer_load_dwordx4 v9, s[8:11], s46 offen sc1 lds
    v_mfma_f32_16x16x32_bf16 v[44:47], v[96:99], v[60:63], v[44:47]
    s_mov_b32 s46, 491520
    s_add_u32 m0, s45, 57344
    s_nop 0
    buffer_load_dwordx4 v10, s[12:15], s46 offen lds
    v_mfma_f32_16x16x32_bf16 v[48:51], v[96:99], v[64:67], v[48:51]
    s_add_u32 m0, s45, 61440
    s_nop 0
    buffer_load_dwordx4 v11, s[12:15], s46 offen lds
    s_waitcnt vmcnt(24) lgkmcnt(0)
    s_barrier
    v_mfma_f32_16x16x32_bf16 v[36:39], v[100:103], v[68:71], v[36:39]
    v_add_u32 v16, 98304, v12
    v_add_u32 v18, 98304, v14
    v_add_u32 v17, 98304, v13
    v_add_u32 v19, 98304, v15
    v_mfma_f32_16x16x32_bf16 v[40:43], v[100:103], v[72:75], v[40:43]
    ds_read_b64_tr_b16 v[84:85], v18 offset:0
    ds_read_b64_tr_b16 v[86:87], v18 offset:1024
    ds_read_b64_tr_b16 v[88:89], v19 offset:0
    ds_read_b64_tr_b16 v[90:91], v19 offset:1024
    v_mfma_f32_16x16x32_bf16 v[44:47], v[104:107], v[68:71], v[44:47]
    ds_read_b128 v[52:55], v16 offset:0
    ds_read_b128 v[56:59], v16 offset:2048
    ds_read_b64_tr_b16 v[92:93], v18 offset:4096
    ds_read_b64_tr_b16 v[94:95], v18 offset:5120
    v_mfma_f32_16x16x32_bf16 v[48:51], v[104:107], v[72:75], v[48:51]
    ds_read_b64_tr_b16 v[96:97], v19 offset:4096
    ds_read_b64_tr_b16 v[98:99], v19 offset:5120
    ds_read_b128 v[60:63], v17 offset:0
    v_mfma_f32_16x16x32_bf16 v[36:39], v[108:111], v[76:79], v[36:39]
    ds_read_b128 v[64:67], v17 offset:2048
    s_movk_i32 s46, 896
    s_add_u32 m0, s45, 65536
    s_nop 0
    v_mfma_f32_16x16x32_bf16 v[40:43], v[108:111], v[80:83], v[40:43]
    buffer_load_dwordx4 v8, s[8:11], s46 offen sc1 lds
    s_add_u32 m0, s45, 69632
    s_nop 0
    buffer_load_dwordx4 v9, s[8:11], s46 offen sc1 lds
    v_mfma_f32_16x16x32_bf16 v[44:47], v[112:115], v[76:79], v[44:47]
    s_mov_b32 s46, 573440
    s_add_u32 m0, s45, 73728
    s_nop 0
    buffer_load_dwordx4 v10, s[12:15], s46 offen lds
    v_mfma_f32_16x16x32_bf16 v[48:51], v[112:115], v[80:83], v[48:51]
    s_add_u32 m0, s45, 77824
    s_nop 0
    buffer_load_dwordx4 v11, s[12:15], s46 offen lds
    s_waitcnt vmcnt(24) lgkmcnt(0)
    s_barrier
    v_mfma_f32_16x16x32_bf16 v[36:39], v[84:87], v[52:55], v[36:39]
    v_add_u32 v16, 114688, v12
    v_add_u32 v18, 114688, v14
    v_add_u32 v17, 114688, v13
    v_add_u32 v19, 114688, v15
    v_mfma_f32_16x16x32_bf16 v[40:43], v[84:87], v[56:59], v[40:43]
    ds_read_b64_tr_b16 v[100:101], v18 offset:0
    ds_read_b64_tr_b16 v[102:103], v18 offset:1024
    ds_read_b64_tr_b16 v[104:105], v19 offset:0
    ds_read_b64_tr_b16 v[106:107], v19 offset:1024
    v_mfma_f32_16x16x32_bf16 v[44:47], v[88:91], v[52:55], v[44:47]
    ds_read_b128 v[68:71], v16 offset:0
    ds_read_b128 v[72:75], v16 offset:2048
    ds_read_b64_tr_b16 v[108:109], v18 offset:4096
    ds_read_b64_tr_b16 v[110:111], v18 offset:5120
    v_mfma_f32_16x16x32_bf16 v[48:51], v[88:91], v[56:59], v[48:51]
    ds_read_b64_tr_b16 v[112:113], v19 offset:4096
    ds_read_b64_tr_b16 v[114:115], v19 offset:5120
    ds_read_b128 v[76:79], v17 offset:0
    v_mfma_f32_16x16x32_bf16 v[36:39], v[92:95], v[60:63], v[36:39]
    ds_read_b128 v[80:83], v17 offset:2048
    s_movk_i32 s46, 1024
    s_add_u32 m0, s45, 81920
    s_nop 0
    v_mfma_f32_16x16x32_bf16 v[40:43], v[92:95], v[64:67], v[40:43]
    buffer_load_dwordx4 v8, s[8:11], s46 offen sc1 lds
    s_add_u32 m0, s45, 86016
    s_nop 0
    buffer_load_dwordx4 v9, s[8:11], s46 offen sc1 lds
    v_mfma_f32_16x16x32_bf16 v[44:47], v[96:99], v[60:63], v[44:47]
    s_mov_b32 s46, 655360
    s_add_u32 m0, s45, 90112
    s_nop 0
    buffer_load_dwordx4 v10, s[12:15], s46 offen lds
    v_mfma_f32_16x16x32_bf16 v[48:51], v[96:99], v[64:67], v[48:51]
    s_add_u32 m0, s45, 94208
    s_nop 0
    buffer_load_dwordx4 v11, s[12:15], s46 offen lds
    s_waitcnt vmcnt(24) lgkmcnt(0)
    s_barrier
    v_mfma_f32_16x16x32_bf16 v[36:39], v[100:103], v[68:71], v[36:39]
    v_add_u32 v16, 131072, v12
    v_add_u32 v18, 131072, v14
    v_add_u32 v17, 131072, v13
    v_add_u32 v19, 131072, v15
    v_mfma_f32_16x16x32_bf16 v[40:43], v[100:103], v[72:75], v[40:43]
    ds_read_b64_tr_b16 v[84:85], v18 offset:0
    ds_read_b64_tr_b16 v[86:87], v18 offset:1024
    ds_read_b64_tr_b16 v[88:89], v19 offset:0
    ds_read_b64_tr_b16 v[90:91], v19 offset:1024
    v_mfma_f32_16x16x32_bf16 v[44:47], v[104:107], v[68:71], v[44:47]
    ds_read_b128 v[52:55], v16 offset:0
    ds_read_b128 v[56:59], v16 offset:2048
    ds_read_b64_tr_b16 v[92:93], v18 offset:4096
    ds_read_b64_tr_b16 v[94:95], v18 offset:5120
    v_mfma_f32_16x16x32_bf16 v[48:51], v[104:107], v[72:75], v[48:51]
    ds_read_b64_tr_b16 v[96:97], v19 offset:4096
    ds_read_b64_tr_b16 v[98:99], v19 offset:5120
    ds_read_b128 v[60:63], v17 offset:0
    v_mfma_f32_16x16x32_bf16 v[36:39], v[108:111], v[76:79], v[36:39]
    ds_read_b128 v[64:67], v17 offset:2048
    s_movk_i32 s46, 1152
    s_add_u32 m0, s45, 98304
    s_nop 0
    v_mfma_f32_16x16x32_bf16 v[40:43], v[108:111], v[80:83], v[40:43]
    buffer_load_dwordx4 v8, s[8:11], s46 offen sc1 lds
    s_add_u32 m0, s45, 102400
    s_nop 0
    buffer_load_dwordx4 v9, s[8:11], s46 offen sc1 lds
    v_mfma_f32_16x16x32_bf16 v[44:47], v[112:115], v[76:79], v[44:47]
    s_mov_b32 s46, 737280
    s_add_u32 m0, s45, 106496
    s_nop 0
    buffer_load_dwordx4 v10, s[12:15], s46 offen lds
    v_mfma_f32_16x16x32_bf16 v[48:51], v[112:115], v[80:83], v[48:51]
    s_add_u32 m0, s45, 110592
    s_nop 0
    buffer_load_dwordx4 v11, s[12:15], s46 offen lds
    s_waitcnt vmcnt(24) lgkmcnt(0)
    s_barrier
    v_mfma_f32_16x16x32_bf16 v[36:39], v[84:87], v[52:55], v[36:39]
    v_add_u32 v16, 0, v12
    v_add_u32 v18, 0, v14
    v_mfma_f32_16x16x32_bf16 v[40:43], v[84:87], v[56:59], v[40:43]
    v_add_u32 v17, 0, v13
    v_add_u32 v19, 0, v15
    v_mfma_f32_16x16x32_bf16 v[44:47], v[88:91], v[52:55], v[44:47]
    ds_read_b64_tr_b16 v[100:101], v18 offset:0
    ds_read_b64_tr_b16 v[102:103], v18 offset:1024
    v_mfma_f32_16x16x32_bf16 v[48:51], v[88:91], v[56:59], v[48:51]
    ds_read_b64_tr_b16 v[104:105], v19 offset:0
    ds_read_b64_tr_b16 v[106:107], v19 offset:1024
    v_mfma_f32_16x16x32_bf16 v[36:39], v[92:95], v[60:63], v[36:39]
    ds_read_b128 v[68:71], v16 offset:0
    ds_read_b128 v[72:75], v16 offset:2048
    v_mfma_f32_16x16x32_bf16 v[40:43], v[92:95], v[64:67], v[40:43]
    ds_read_b64_tr_b16 v[108:109], v18 offset:4096
    ds_read_b64_tr_b16 v[110:111], v18 offset:5120
    v_mfma_f32_16x16x32_bf16 v[44:47], v[96:99], v[60:63], v[44:47]
    ds_read_b64_tr_b16 v[112:113], v19 offset:4096
    ds_read_b64_tr_b16 v[114:115], v19 offset:5120
    v_mfma_f32_16x16x32_bf16 v[48:51], v[96:99], v[64:67], v[48:51]
    ds_read_b128 v[76:79], v17 offset:0
    ds_read_b128 v[80:83], v17 offset:2048
    s_waitcnt vmcnt(20) lgkmcnt(0)
    s_barrier
    v_mfma_f32_16x16x32_bf16 v[36:39], v[100:103], v[68:71], v[36:39]
    v_add_u32 v16, 16384, v12
    v_add_u32 v18, 16384, v14
    v_mfma_f32_16x16x32_bf16 v[40:43], v[100:103], v[72:75], v[40:43]
    v_add_u32 v17, 16384, v13
    v_add_u32 v19, 16384, v15
    v_mfma_f32_16x16x32_bf16 v[44:47], v[104:107], v[68:71], v[44:47]
    ds_read_b64_tr_b16 v[84:85], v18 offset:0
    ds_read_b64_tr_b16 v[86:87], v18 offset:1024
    v_mfma_f32_16x16x32_bf16 v[48:51], v[104:107], v[72:75], v[48:51]
    ds_read_b64_tr_b16 v[88:89], v19 offset:0
    ds_read_b64_tr_b16 v[90:91], v19 offset:1024
    v_mfma_f32_16x16x32_bf16 v[36:39], v[108:111], v[76:79], v[36:39]
    ds_read_b128 v[52:55], v16 offset:0
    ds_read_b128 v[56:59], v16 offset:2048
    v_mfma_f32_16x16x32_bf16 v[40:43], v[108:111], v[80:83], v[40:43]
    ds_read_b64_tr_b16 v[92:93], v18 offset:4096
    ds_read_b64_tr_b16 v[94:95], v18 offset:5120
    v_mfma_f32_16x16x32_bf16 v[44:47], v[112:115], v[76:79], v[44:47]
    ds_read_b64_tr_b16 v[96:97], v19 offset:4096
    ds_read_b64_tr_b16 v[98:99], v19 offset:5120
    v_mfma_f32_16x16x32_bf16 v[48:51], v[112:115], v[80:83], v[48:51]
    ds_read_b128 v[60:63], v17 offset:0
    ds_read_b128 v[64:67], v17 offset:2048
    s_waitcnt vmcnt(16) lgkmcnt(0)
    s_barrier
    v_mfma_f32_16x16x32_bf16 v[36:39], v[84:87], v[52:55], v[36:39]
    v_add_u32 v16, 32768, v12
    v_add_u32 v18, 32768, v14
    v_mfma_f32_16x16x32_bf16 v[40:43], v[84:87], v[56:59], v[40:43]
    v_add_u32 v17, 32768, v13
    v_add_u32 v19, 32768, v15
    v_mfma_f32_16x16x32_bf16 v[44:47], v[88:91], v[52:55], v[44:47]
    ds_read_b64_tr_b16 v[100:101], v18 offset:0
    ds_read_b64_tr_b16 v[102:103], v18 offset:1024
    v_mfma_f32_16x16x32_bf16 v[48:51], v[88:91], v[56:59], v[48:51]
    ds_read_b64_tr_b16 v[104:105], v19 offset:0
    ds_read_b64_tr_b16 v[106:107], v19 offset:1024
    v_mfma_f32_16x16x32_bf16 v[36:39], v[92:95], v[60:63], v[36:39]
    ds_read_b128 v[68:71], v16 offset:0
    ds_read_b128 v[72:75], v16 offset:2048
    v_mfma_f32_16x16x32_bf16 v[40:43], v[92:95], v[64:67], v[40:43]
    ds_read_b64_tr_b16 v[108:109], v18 offset:4096
    ds_read_b64_tr_b16 v[110:111], v18 offset:5120
    v_mfma_f32_16x16x32_bf16 v[44:47], v[96:99], v[60:63], v[44:47]
    ds_read_b64_tr_b16 v[112:113], v19 offset:4096
    ds_read_b64_tr_b16 v[114:115], v19 offset:5120
    v_mfma_f32_16x16x32_bf16 v[48:51], v[96:99], v[64:67], v[48:51]
    ds_read_b128 v[76:79], v17 offset:0
    ds_read_b128 v[80:83], v17 offset:2048
    s_waitcnt vmcnt(12) lgkmcnt(0)
    s_barrier
    v_mfma_f32_16x16x32_bf16 v[36:39], v[100:103], v[68:71], v[36:39]
    v_add_u32 v16, 49152, v12
    v_add_u32 v18, 49152, v14
    v_mfma_f32_16x16x32_bf16 v[40:43], v[100:103], v[72:75], v[40:43]
    v_add_u32 v17, 49152, v13
    v_add_u32 v19, 49152, v15
    v_mfma_f32_16x16x32_bf16 v[44:47], v[104:107], v[68:71], v[44:47]
    ds_read_b64_tr_b16 v[84:85], v18 offset:0
    ds_read_b64_tr_b16 v[86:87], v18 offset:1024
    v_mfma_f32_16x16x32_bf16 v[48:51], v[104:107], v[72:75], v[48:51]
    ds_read_b64_tr_b16 v[88:89], v19 offset:0
    ds_read_b64_tr_b16 v[90:91], v19 offset:1024
    v_mfma_f32_16x16x32_bf16 v[36:39], v[108:111], v[76:79], v[36:39]
    ds_read_b128 v[52:55], v16 offset:0
    ds_read_b128 v[56:59], v16 offset:2048
    v_mfma_f32_16x16x32_bf16 v[40:43], v[108:111], v[80:83], v[40:43]
    ds_read_b64_tr_b16 v[92:93], v18 offset:4096
    ds_read_b64_tr_b16 v[94:95], v18 offset:5120
    v_mfma_f32_16x16x32_bf16 v[44:47], v[112:115], v[76:79], v[44:47]
    ds_read_b64_tr_b16 v[96:97], v19 offset:4096
    ds_read_b64_tr_b16 v[98:99], v19 offset:5120
    v_mfma_f32_16x16x32_bf16 v[48:51], v[112:115], v[80:83], v[48:51]
    ds_read_b128 v[60:63], v17 offset:0
    ds_read_b128 v[64:67], v17 offset:2048
    s_waitcnt vmcnt(8) lgkmcnt(0)
    s_barrier
    v_mfma_f32_16x16x32_bf16 v[36:39], v[84:87], v[52:55], v[36:39]
    v_add_u32 v16, 65536, v12
    v_add_u32 v18, 65536, v14
    v_mfma_f32_16x16x32_bf16 v[40:43], v[84:87], v[56:59], v[40:43]
    v_add_u32 v17, 65536, v13
    v_add_u32 v19, 65536, v15
    v_mfma_f32_16x16x32_bf16 v[44:47], v[88:91], v[52:55], v[44:47]
    ds_read_b64_tr_b16 v[100:101], v18 offset:0
    ds_read_b64_tr_b16 v[102:103], v18 offset:1024
    v_mfma_f32_16x16x32_bf16 v[48:51], v[88:91], v[56:59], v[48:51]
    ds_read_b64_tr_b16 v[104:105], v19 offset:0
    ds_read_b64_tr_b16 v[106:107], v19 offset:1024
    v_mfma_f32_16x16x32_bf16 v[36:39], v[92:95], v[60:63], v[36:39]
    ds_read_b128 v[68:71], v16 offset:0
    ds_read_b128 v[72:75], v16 offset:2048
    v_mfma_f32_16x16x32_bf16 v[40:43], v[92:95], v[64:67], v[40:43]
    ds_read_b64_tr_b16 v[108:109], v18 offset:4096
    ds_read_b64_tr_b16 v[110:111], v18 offset:5120
    v_mfma_f32_16x16x32_bf16 v[44:47], v[96:99], v[60:63], v[44:47]
    ds_read_b64_tr_b16 v[112:113], v19 offset:4096
    ds_read_b64_tr_b16 v[114:115], v19 offset:5120
    v_mfma_f32_16x16x32_bf16 v[48:51], v[96:99], v[64:67], v[48:51]
    ds_read_b128 v[76:79], v17 offset:0
    ds_read_b128 v[80:83], v17 offset:2048
    s_waitcnt vmcnt(4) lgkmcnt(0)
    s_barrier
    v_mfma_f32_16x16x32_bf16 v[36:39], v[100:103], v[68:71], v[36:39]
    v_add_u32 v16, 81920, v12
    v_add_u32 v18, 81920, v14
    v_mfma_f32_16x16x32_bf16 v[40:43], v[100:103], v[72:75], v[40:43]
    v_add_u32 v17, 81920, v13
    v_add_u32 v19, 81920, v15
    v_mfma_f32_16x16x32_bf16 v[44:47], v[104:107], v[68:71], v[44:47]
    ds_read_b64_tr_b16 v[84:85], v18 offset:0
    ds_read_b64_tr_b16 v[86:87], v18 offset:1024
    v_mfma_f32_16x16x32_bf16 v[48:51], v[104:107], v[72:75], v[48:51]
    ds_read_b64_tr_b16 v[88:89], v19 offset:0
    ds_read_b64_tr_b16 v[90:91], v19 offset:1024
    v_mfma_f32_16x16x32_bf16 v[36:39], v[108:111], v[76:79], v[36:39]
    ds_read_b128 v[52:55], v16 offset:0
    ds_read_b128 v[56:59], v16 offset:2048
    v_mfma_f32_16x16x32_bf16 v[40:43], v[108:111], v[80:83], v[40:43]
    ds_read_b64_tr_b16 v[92:93], v18 offset:4096
    ds_read_b64_tr_b16 v[94:95], v18 offset:5120
    v_mfma_f32_16x16x32_bf16 v[44:47], v[112:115], v[76:79], v[44:47]
    ds_read_b64_tr_b16 v[96:97], v19 offset:4096
    ds_read_b64_tr_b16 v[98:99], v19 offset:5120
    v_mfma_f32_16x16x32_bf16 v[48:51], v[112:115], v[80:83], v[48:51]
    ds_read_b128 v[60:63], v17 offset:0
    ds_read_b128 v[64:67], v17 offset:2048
    s_waitcnt vmcnt(0) lgkmcnt(0)
    s_barrier
    v_mfma_f32_16x16x32_bf16 v[36:39], v[84:87], v[52:55], v[36:39]
    v_add_u32 v16, 98304, v12
    v_add_u32 v18, 98304, v14
    v_mfma_f32_16x16x32_bf16 v[40:43], v[84:87], v[56:59], v[40:43]
    v_add_u32 v17, 98304, v13
    v_add_u32 v19, 98304, v15
    v_mfma_f32_16x16x32_bf16 v[44:47], v[88:91], v[52:55], v[44:47]
    ds_read_b64_tr_b16 v[100:101], v18 offset:0
    ds_read_b64_tr_b16 v[102:103], v18 offset:1024
    v_mfma_f32_16x16x32_bf16 v[48:51], v[88:91], v[56:59], v[48:51]
    ds_read_b64_tr_b16 v[104:105], v19 offset:0
    ds_read_b64_tr_b16 v[106:107], v19 offset:1024
    v_mfma_f32_16x16x32_bf16 v[36:39], v[92:95], v[60:63], v[36:39]
    ds_read_b128 v[68:71], v16 offset:0
    ds_read_b128 v[72:75], v16 offset:2048
    v_mfma_f32_16x16x32_bf16 v[40:43], v[92:95], v[64:67], v[40:43]
    ds_read_b64_tr_b16 v[108:109], v18 offset:4096
    ds_read_b64_tr_b16 v[110:111], v18 offset:5120
    v_mfma_f32_16x16x32_bf16 v[44:47], v[96:99], v[60:63], v[44:47]
    ds_read_b64_tr_b16 v[112:113], v19 offset:4096
    ds_read_b64_tr_b16 v[114:115], v19 offset:5120
    v_mfma_f32_16x16x32_bf16 v[48:51], v[96:99], v[64:67], v[48:51]
    ds_read_b128 v[76:79], v17 offset:0
    ds_read_b128 v[80:83], v17 offset:2048
    s_waitcnt lgkmcnt(0)
    v_mfma_f32_16x16x32_bf16 v[36:39], v[100:103], v[68:71], v[36:39]
    v_mfma_f32_16x16x32_bf16 v[40:43], v[100:103], v[72:75], v[40:43]
    v_mfma_f32_16x16x32_bf16 v[44:47], v[104:107], v[68:71], v[44:47]
    v_mfma_f32_16x16x32_bf16 v[48:51], v[104:107], v[72:75], v[48:51]
    v_mfma_f32_16x16x32_bf16 v[36:39], v[108:111], v[76:79], v[36:39]
    v_mfma_f32_16x16x32_bf16 v[40:43], v[108:111], v[80:83], v[40:43]
    v_mfma_f32_16x16x32_bf16 v[44:47], v[112:115], v[76:79], v[44:47]
    v_mfma_f32_16x16x32_bf16 v[48:51], v[112:115], v[80:83], v[48:51]
    s_waitcnt vmcnt(0)
    s_nop 7
    v_lshlrev_b32 v4, 16, v24
    v_and_b32 v5, 0xffff0000, v24
    v_lshlrev_b32 v6, 16, v32
    v_and_b32 v7, 0xffff0000, v32
    v_add_f32 v4, v4, v6
    v_add_f32 v5, v5, v7
    v_add_f32 v36, v36, v4
    v_add_f32 v37, v37, v5
    v_lshlrev_b32 v4, 16, v25
    v_and_b32 v5, 0xffff0000, v25
    v_lshlrev_b32 v6, 16, v33
    v_and_b32 v7, 0xffff0000, v33
    v_add_f32 v4, v4, v6
    v_add_f32 v5, v5, v7
    v_add_f32 v38, v38, v4
    v_add_f32 v39, v39, v5
    v_cvt_pk_bf16_f32 v36, v36, v37
    v_cvt_pk_bf16_f32 v37, v38, v39
    buffer_store_dwordx2 v[36:37], v20, s[20:23], 0 offen offset:0
    v_lshlrev_b32 v4, 16, v28
    v_and_b32 v5, 0xffff0000, v28
    v_lshlrev_b32 v6, 16, v32
    v_and_b32 v7, 0xffff0000, v32
    v_add_f32 v4, v4, v6
    v_add_f32 v5, v5, v7
    v_add_f32 v40, v40, v4
    v_add_f32 v41, v41, v5
    v_lshlrev_b32 v4, 16, v29
    v_and_b32 v5, 0xffff0000, v29
    v_lshlrev_b32 v6, 16, v33
    v_and_b32 v7, 0xffff0000, v33
    v_add_f32 v4, v4, v6
    v_add_f32 v5, v5, v7
    v_add_f32 v42, v42, v4
    v_add_f32 v43, v43, v5
    v_cvt_pk_bf16_f32 v40, v40, v41
    v_cvt_pk_bf16_f32 v41, v42, v43
    buffer_store_dwordx2 v[40:41], v21, s[20:23], 0 offen offset:0
    v_lshlrev_b32 v4, 16, v26
    v_and_b32 v5, 0xffff0000, v26
    v_lshlrev_b32 v6, 16, v34
    v_and_b32 v7, 0xffff0000, v34
    v_add_f32 v4, v4, v6
    v_add_f32 v5, v5, v7
    v_add_f32 v44, v44, v4
    v_add_f32 v45, v45, v5
    v_lshlrev_b32 v4, 16, v27
    v_and_b32 v5, 0xffff0000, v27
    v_lshlrev_b32 v6, 16, v35
    v_and_b32 v7, 0xffff0000, v35
    v_add_f32 v4, v4, v6
    v_add_f32 v5, v5, v7
    v_add_f32 v46, v46, v4
    v_add_f32 v47, v47, v5
    v_cvt_pk_bf16_f32 v44, v44, v45
    v_cvt_pk_bf16_f32 v45, v46, v47
    buffer_store_dwordx2 v[44:45], v20, s[20:23], 0 offen offset:32
    v_lshlrev_b32 v4, 16, v30
    v_and_b32 v5, 0xffff0000, v30
    v_lshlrev_b32 v6, 16, v34
    v_and_b32 v7, 0xffff0000, v34
    v_add_f32 v4, v4, v6
    v_add_f32 v5, v5, v7
    v_add_f32 v48, v48, v4
    v_add_f32 v49, v49, v5
    v_lshlrev_b32 v4, 16, v31
    v_and_b32 v5, 0xffff0000, v31
    v_lshlrev_b32 v6, 16, v35
    v_and_b32 v7, 0xffff0000, v35
    v_add_f32 v4, v4, v6
    v_add_f32 v5, v5, v7
    v_add_f32 v50, v50, v4
    v_add_f32 v51, v51, v5
    v_cvt_pk_bf16_f32 v48, v48, v49
    v_cvt_pk_bf16_f32 v49, v50, v51
    buffer_store_dwordx2 v[48:49], v21, s[20:23], 0 offen offset:32
    s_branch K1_END
K1_MLP:
    s_mul_i32 s42, s38, 384
    s_movk_i32 s41, 1280
    s_add_u32 s46, s39, 0
    s_lshl_b32 s47, s46, 6
    v_add_u32 v4, s47, v1
    v_mul_u32_u24 v5, 2731, v4
    v_lshrrev_b32 v5, 16, v5
    v_mul_u32_u24 v6, 24, v5
    v_sub_u32 v4, v4, v6
    v_bfe_u32 v6, v5, 1, 2
    v_lshlrev_b32 v6, 1, v6
    v_xor_b32 v4, v4, v6
    v_lshlrev_b32 v4, 4, v4
    v_and_b32 v6, 0xfffffff3, v5
    v_and_b32 v7, 4, v5
    v_lshl_or_b32 v6, v7, 1, v6
    v_and_b32 v7, 8, v5
    v_lshrrev_b32 v7, 1, v7
    v_or_b32 v6, v6, v7
    v_mul_u32_u24 v6, 3072, v6
    v_add3_u32 v8, v6, v4, s42
    v_mov_b32 v12, v8
    s_add_u32 s46, s39, 8
    s_lshl_b32 s47, s46, 6
    v_add_u32 v4, s47, v1
    v_mul_u32_u24 v5, 2731, v4
    v_lshrrev_b32 v5, 16, v5
    v_mul_u32_u24 v6, 24, v5
    v_sub_u32 v4, v4, v6
    v_bfe_u32 v6, v5, 1, 2
    v_lshlrev_b32 v6, 1, v6
    v_xor_b32 v4, v4, v6
    v_lshlrev_b32 v4, 4, v4
    v_and_b32 v6, 0xfffffff3, v5
    v_and_b32 v7, 4, v5
    v_lshl_or_b32 v6, v7, 1, v6
    v_and_b32 v7, 8, v5
    v_lshrrev_b32 v7, 1, v7
    v_or_b32 v6, v6, v7
    v_mul_u32_u24 v6, 3072, v6
    v_add3_u32 v8, v6, v4, s42
    s_sub_u32 s47, s46, 12
    s_lshl_b32 s47, s47, 3
    v_lshrrev_b32 v4, 3, v1
    v_add_u32 v4, s47, v4
    v_and_b32 v5, 7, v1
    v_and_b32 v6, 7, v4
    v_xor_b32 v5, v5, v6
    s_sub_u32 s47, s40, 0
    v_add_u32 v4, s47, v4
    v_mul_lo_u32 v4, v4, s41
    v_lshl_add_u32 v9, v5, 4, v4
    s_cmp_lt_u32 s46, 12
    s_cselect_b64 vcc, -1, 0
    v_cndmask_b32 v13, v9, v8, vcc
    s_add_u32 s46, s39, 16
    s_sub_u32 s47, s46, 12
    s_lshl_b32 s47, s47, 3
    v_lshrrev_b32 v4, 3, v1
    v_add_u32 v4, s47, v4
    v_and_b32 v5, 7, v1
    v_and_b32 v6, 7, v4
    v_xor_b32 v5, v5, v6
    s_sub_u32 s47, s40, 0
    v_add_u32 v4, s47, v4
    v_mul_lo_u32 v4, v4, s41
    v_lshl_add_u32 v9, v5, 4, v4
    s_cmp_lt_u32 s46, 20
    s_cselect_b64 vcc, -1, 0
    v_mov_b32 v4, 2146435072
    v_cndmask_b32 v14, v4, v9, vcc
    v_add_u32 v16, 81920, v14
    v_add_u32 v4, 81920, v13
    s_add_u32 s46, s39, 8
    s_cmp_lt_u32 s46, 12
    s_cselect_b64 vcc, -1, 0
    v_cndmask_b32 v15, v4, v13, vcc
    s_waitcnt lgkmcnt(0)
    s_mov_b32 s8, s4
    s_and_b32 s9, s5, 0xffff
    s_mov_b32 s10, 2621440
    s_mov_b32 s11, 0x00020000
    s_mov_b32 s12, s28
    s_and_b32 s13, s29, 0xffff
    s_mov_b32 s14, 1966080
    s_mov_b32 s15, 0x00020000
    s_mov_b32 s24, s30
    s_and_b32 s25, s31, 0xffff
    s_mov_b32 s26, 3072
    s_mov_b32 s27, 0x00020000
    s_mov_b32 s20, s34
    s_and_b32 s21, s35, 0xffff
    s_mov_b32 s22, 8912896
    s_mov_b32 s23, 0x00020000
    s_add_u32 s46, s39, 8
    s_cmp_lt_u32 s46, 12
    s_cselect_b32 s53, 1, 0
    s_cselect_b32 s16, s12, s8
    s_cselect_b32 s17, s13, s9
    s_cselect_b32 s18, s14, s10
    s_cselect_b32 s19, s15, s11
    s_add_u32 s46, s39, 16
    s_cmp_lt_u32 s46, 20
    s_cselect_b32 s52, 1, 0
    s_mov_b32 s46, 0
    s_add_u32 m0, s45, 65536
    s_nop 0
    buffer_load_dwordx4 v12, s[12:15], s46 offen lds
    s_cmp_lg_u32 s53, 0
    s_mov_b32 s46, 0
    s_cmov_b32 s46, 0
    s_mov_b32 s47, 4294963200
    s_cmov_b32 s47, 73728
    s_add_u32 m0, s45, s47
    s_nop 0
    buffer_load_dwordx4 v13, s[16:19], s46 offen lds
    s_mov_b32 s46, 0
    s_cmp_lg_u32 s52, 0
    s_mov_b32 s47, 196608
    s_cmov_b32 s47, 4096
    s_add_u32 m0, s45, s47
    s_nop 0
    buffer_load_dwordx4 v14, s[8:11], s46 offen lds
    s_mov_b32 s46, 98304
    s_add_u32 m0, s45, 77824
    s_nop 0
    buffer_load_dwordx4 v12, s[12:15], s46 offen lds
    s_cmp_lg_u32 s53, 0
    s_mov_b32 s46, 0
    s_cmov_b32 s46, 98304
    s_mov_b32 s47, 4096
    s_cmov_b32 s47, 86016
    s_add_u32 m0, s45, s47
    s_nop 0
    buffer_load_dwordx4 v15, s[16:19], s46 offen lds
    s_mov_b32 s46, 0
    s_cmp_lg_u32 s52, 0
    s_mov_b32 s47, 196608
    s_cmov_b32 s47, 12288
    s_add_u32 m0, s45, s47
    s_nop 0
    buffer_load_dwordx4 v16, s[8:11], s46 offen lds
    v_and_b32 v4, 7, v2
    v_add_u32 v5, 0, v3
    v_xor_b32 v5, v5, v4
    v_lshlrev_b32 v5, 4, v5
    v_lshl_add_u32 v6, v2, 7, v5
    v_add_u32 v5, 4, v3
    v_xor_b32 v5, v5, v4
    v_lshlrev_b32 v5, 4, v5
    v_lshl_add_u32 v7, v2, 7, v5
    s_lshl_b32 s46, s43, 2
    s_add_u32 s47, s46, 0
    s_lshl_b32 s47, s47, 11
    s_add_u32 s47, s47, 0
    v_add_u32 v17, s47, v6
    v_add_u32 v18, s47, v7
    s_add_u32 s47, s46, 1
    s_lshl_b32 s47, s47, 11
    s_add_u32 s47, s47, 0
    v_add_u32 v19, s47, v6
    v_add_u32 v20, s47, v7
    s_add_u32 s47, s46, 2
    s_lshl_b32 s47, s47, 11
    s_add_u32 s47, s47, 0
    v_add_u32 v21, s47, v6
    v_add_u32 v22, s47, v7
    s_add_u32 s47, s46, 3
    s_lshl_b32 s47, s47, 11
    s_add_u32 s47, s47, 0
    v_add_u32 v23, s47, v6
    v_add_u32 v24, s47, v7
    s_add_u32 s47, s46, s44
    s_lshl_b32 s47, s47, 11
    v_add_u32 v25, s47, v6
    v_add_u32 v26, s47, v7
    v_lshrrev_b32 v4, 1, v3
    v_lshlrev_b32 v4, 4, v4
    v_and_b32 v5, 1, v3
    v_lshl_add_u32 v4, v5, 2, v4
    v_bfe_u32 v5, v1, 2, 2
    v_add_u32 v4, v4, v5
    v_bfe_u32 v5, v4, 1, 2
    v_mul_u32_u24 v4, 384, v4
    v_and_b32 v6, 3, v1
    v_lshl_add_u32 v4, v6, 3, v4
    v_add_u32 v4, 65536, v4
    s_mul_i32 s46, s44, 3
    s_add_u32 s56, s46, 0
    v_xor_b32 v6, s56, v5
    v_lshl_add_u32 v27, v6, 5, v4
    s_mul_i32 s46, s44, 3
    s_add_u32 s57, s46, 1
    v_xor_b32 v6, s57, v5
    v_lshl_add_u32 v28, v6, 5, v4
    s_mul_i32 s46, s44, 3
    s_add_u32 s58, s46, 2
    v_xor_b32 v6, s58, v5
    v_lshl_add_u32 v29, v6, 5, v4
    v_add_u32 v31, 73728, v27
    v_add_u32 v32, 73728, v28
    v_add_u32 v33, 73728, v29
    v_mov_b32 v64, 0
    v_mov_b32 v65, 0
    v_mov_b32 v66, 0
    v_mov_b32 v67, 0
    v_mov_b32 v68, 0
    v_mov_b32 v69, 0
    v_mov_b32 v70, 0
    v_mov_b32 v71, 0
    v_mov_b32 v72, 0
    v_mov_b32 v73, 0
    v_mov_b32 v74, 0
    v_mov_b32 v75, 0
    v_mov_b32 v76, 0
    v_mov_b32 v77, 0
    v_mov_b32 v78, 0
    v_mov_b32 v79, 0
    v_mov_b32 v80, 0
    v_mov_b32 v81, 0
    v_mov_b32 v82, 0
    v_mov_b32 v83, 0
    v_mov_b32 v84, 0
    v_mov_b32 v85, 0
    v_mov_b32 v86, 0
    v_mov_b32 v87, 0
    v_mov_b32 v88, 0
    v_mov_b32 v89, 0
    v_mov_b32 v90, 0
    v_mov_b32 v91, 0
    v_mov_b32 v92, 0
    v_mov_b32 v93, 0
    v_mov_b32 v94, 0
    v_mov_b32 v95, 0
    v_mov_b32 v96, 0
    v_mov_b32 v97, 0
    v_mov_b32 v98, 0
    v_mov_b32 v99, 0
    v_mov_b32 v100, 0
    v_mov_b32 v101, 0
    v_mov_b32 v102, 0
    v_mov_b32 v103, 0
    v_mov_b32 v104, 0
    v_mov_b32 v105, 0
    v_mov_b32 v106, 0
    v_mov_b32 v107, 0
    v_mov_b32 v108, 0
    v_mov_b32 v109, 0
    v_mov_b32 v110, 0
    v_mov_b32 v111, 0
    v_mov_b32 v112, 0
    v_mov_b32 v113, 0
    v_mov_b32 v114, 0
    v_mov_b32 v115, 0
    v_mov_b32 v116, 0
    v_mov_b32 v117, 0
    v_mov_b32 v118, 0
    v_mov_b32 v119, 0
    v_mov_b32 v120, 0
    v_mov_b32 v121, 0
    v_mov_b32 v122, 0
    v_mov_b32 v123, 0
    v_mov_b32 v36, 0
    v_mov_b32 v37, 0
    v_mov_b32 v38, 0
    v_mov_b32 v39, 0
    v_mov_b32 v40, 0
    v_mov_b32 v41, 0
    v_mov_b32 v42, 0
    v_mov_b32 v43, 0
    v_mov_b32 v44, 0
    v_mov_b32 v45, 0
    v_mov_b32 v46, 0
    v_mov_b32 v47, 0
    v_mov_b32 v48, 0
    v_mov_b32 v49, 0
    v_mov_b32 v50, 0
    v_mov_b32 v51, 0
    v_mov_b32 v52, 0x3f803f80
    v_mov_b32 v53, 0x3f803f80
    v_mov_b32 v54, 0x3f803f80
    v_mov_b32 v55, 0x3f803f80
    v_cmp_eq_u32 s[54:55], 0, v2
    s_mov_b32 s60, 0x3f803f80
    s_and_b32 s46, s2, 7
    s_lshl_b32 s46, s46, 4
    s_lshr_b32 s47, s2, 4
    s_add_u32 s46, s46, s47
    s_add_u32 s46, s46, 128
    s_lshl_b32 s46, s46, 7
    s_add_u32 s46, s46, 16777216
    v_mov_b32 v4, s46
    v_mov_b32 v5, 2146435072
    v_cmp_eq_u32 vcc, 0, v0
    v_mov_b32 v6, 0
    v_mov_b32 v7, 0
    v_cndmask_b32 v4, v5, v4, vcc
    s_mov_b32 s92, s34
    s_and_b32 s93, s35, 0xffff
    s_mov_b32 s94, 33554432
    s_mov_b32 s95, 0x00020000
    buffer_store_dwordx2 v[6:7], v4, s[92:95], 0 offen sc1
    v_mul_u32_u24 v4, 21846, v1
    v_lshrrev_b32 v4, 16, v4
    v_mul_u32_u24 v5, 3, v4
    v_sub_u32 v5, v1, v5
    s_mul_i32 s46, s37, 40
    s_mul_i32 s47, s39, 5
    s_add_u32 s46, s46, s47
    v_add_u32 v4, s46, v4
    v_mul_u32_u24 v4, 3072, v4
    v_lshl_add_u32 v4, v5, 7, v4
    v_add_u32 v4, s42, v4
    v_mov_b32 v7, 2146435072
    v_cmp_gt_u32 vcc, 15, v1
    s_nop 1
    v_cndmask_b32 v4, v7, v4, vcc
    buffer_load_dword v11, v4, s[12:15], 0 offen
    s_lshl_b32 s46, s38, 1
    s_add_u32 s46, s46, s36
    s_mul_i32 s46, s46, 80
    s_mul_i32 s47, s39, 10
    s_add_u32 s46, s46, s47
    s_mul_i32 s47, s40, 10
    s_add_u32 s46, s46, s47
    v_add_u32 v4, s46, v1
    v_lshlrev_b32 v4, 7, v4
    v_cmp_gt_u32 vcc, 10, v1
    s_nop 1
    v_cndmask_b32 v4, v7, v4, vcc
    buffer_load_dword v11, v4, s[8:11], 0 offen
    s_lshl_b32 s46, s56, 5
    s_add_u32 s46, s46, s42
    v_lshl_add_u32 v4, v3, 3, s46
    buffer_load_dwordx2 v[56:57], v4, s[24:27], 0 offen
    s_lshl_b32 s46, s57, 5
    s_add_u32 s46, s46, s42
    v_lshl_add_u32 v4, v3, 3, s46
    buffer_load_dwordx2 v[58:59], v4, s[24:27], 0 offen
    s_lshl_b32 s46, s58, 5
    s_add_u32 s46, s46, s42
    v_lshl_add_u32 v4, v3, 3, s46
    buffer_load_dwordx2 v[60:61], v4, s[24:27], 0 offen
    s_waitcnt vmcnt(6)
    s_barrier
    ds_read_b64_tr_b16 v[164:165], v27 offset:0
    ds_read_b64_tr_b16 v[166:167], v27 offset:3072
    ds_read_b64_tr_b16 v[168:169], v28 offset:0
    ds_read_b64_tr_b16 v[170:171], v28 offset:3072
    ds_read_b64_tr_b16 v[172:173], v29 offset:0
    ds_read_b64_tr_b16 v[174:175], v29 offset:3072
    ds_read_b128 v[124:127], v17 offset:0
    ds_read_b128 v[128:131], v19 offset:0
    ds_read_b128 v[132:135], v21 offset:0
    ds_read_b128 v[136:139], v23 offset:0
    ds_read_b128 v[140:143], v25 offset:0
    s_waitcnt lgkmcnt(0)
    s_barrier
    v_mfma_f32_16x16x32_bf16 v[64:67], v[164:167], v[124:127], v[64:67]
    ds_read_b64_tr_b16 v[176:177], v27 offset:12288
    ds_read_b64_tr_b16 v[178:179], v27 offset:15360
    ds_read_b64_tr_b16 v[180:181], v28 offset:12288
    ds_read_b64_tr_b16 v[182:183], v28 offset:15360
    v_mfma_f32_16x16x32_bf16 v[68:71], v[164:167], v[128:131], v[68:71]
    ds_read_b64_tr_b16 v[184:185], v29 offset:12288
    ds_read_b64_tr_b16 v[186:187], v29 offset:15360
    ds_read_b128 v[144:147], v18 offset:0
    v_mfma_f32_16x16x32_bf16 v[72:75], v[164:167], v[132:135], v[72:75]
    ds_read_b128 v[148:151], v20 offset:0
    ds_read_b128 v[152:155], v22 offset:0
    ds_read_b128 v[156:159], v24 offset:0
    ds_read_b128 v[160:163], v26 offset:0
    v_mfma_f32_16x16x32_bf16 v[76:79], v[164:167], v[136:139], v[76:79]
    s_mov_b32 s46, 196608
    s_add_u32 m0, s45, 90112
    s_nop 0
    v_mfma_f32_16x16x32_bf16 v[80:83], v[168:171], v[124:127], v[80:83]
    buffer_load_dwordx4 v12, s[12:15], s46 offen lds
    s_cmp_lg_u32 s53, 0
    s_mov_b32 s46, 128
    s_cmov_b32 s46, 196608
    v_mfma_f32_16x16x32_bf16 v[84:87], v[168:171], v[128:131], v[84:87]
    s_mov_b32 s47, 12288
    s_cmov_b32 s47, 98304
    s_add_u32 m0, s45, s47
    v_mfma_f32_16x16x32_bf16 v[88:91], v[168:171], v[132:135], v[88:91]
    s_nop 0
    buffer_load_dwordx4 v13, s[16:19], s46 offen lds
    s_mov_b32 s46, 128
    s_cmp_lg_u32 s52, 0
    v_mfma_f32_16x16x32_bf16 v[92:95], v[168:171], v[136:139], v[92:95]
    s_mov_b32 s47, 196608
    s_cmov_b32 s47, 20480
    s_add_u32 m0, s45, s47
    v_mfma_f32_16x16x32_bf16 v[96:99], v[172:175], v[124:127], v[96:99]
    s_nop 0
    buffer_load_dwordx4 v14, s[8:11], s46 offen lds
    s_mov_b32 s46, 294912
    s_add_u32 m0, s45, 102400
    v_mfma_f32_16x16x32_bf16 v[100:103], v[172:175], v[128:131], v[100:103]
    s_nop 0
    buffer_load_dwordx4 v12, s[12:15], s46 offen lds
    s_cmp_lg_u32 s53, 0
    v_mfma_f32_16x16x32_bf16 v[104:107], v[172:175], v[132:135], v[104:107]
    s_mov_b32 s46, 128
    s_cmov_b32 s46, 294912
    s_mov_b32 s47, 20480
    s_cmov_b32 s47, 110592
    v_mfma_f32_16x16x32_bf16 v[108:111], v[172:175], v[136:139], v[108:111]
    s_add_u32 m0, s45, s47
    s_nop 0
    buffer_load_dwordx4 v15, s[16:19], s46 offen lds
    v_mfma_f32_16x16x32_bf16 v[36:39], v[52:55], v[140:143], v[36:39]
    s_mov_b32 s46, 128
    s_cmp_lg_u32 s52, 0
    s_mov_b32 s47, 196608
    s_cmov_b32 s47, 28672
    v_mfma_f32_16x16x32_bf16 v[40:43], v[140:143], v[140:143], v[40:43]
    s_add_u32 m0, s45, s47
    s_nop 0
    buffer_load_dwordx4 v16, s[8:11], s46 offen lds
    s_nop 1
    v_mfma_f32_16x16x32_bf16 v[112:115], v[164:167], v[52:55], v[112:115]
    v_mfma_f32_16x16x32_bf16 v[116:119], v[168:171], v[52:55], v[116:119]
    v_mfma_f32_16x16x32_bf16 v[120:123], v[172:175], v[52:55], v[120:123]
    s_waitcnt vmcnt(0) lgkmcnt(0)
    s_barrier
    v_mfma_f32_16x16x32_bf16 v[64:67], v[176:179], v[144:147], v[64:67]
    ds_read_b64_tr_b16 v[164:165], v27 offset:24576
    ds_read_b64_tr_b16 v[166:167], v27 offset:27648
    ds_read_b64_tr_b16 v[168:169], v28 offset:24576
    ds_read_b64_tr_b16 v[170:171], v28 offset:27648
    v_mfma_f32_16x16x32_bf16 v[68:71], v[176:179], v[148:151], v[68:71]
    ds_read_b64_tr_b16 v[172:173], v29 offset:24576
    ds_read_b64_tr_b16 v[174:175], v29 offset:27648
    ds_read_b128 v[124:127], v17 offset:16384
    v_mfma_f32_16x16x32_bf16 v[72:75], v[176:179], v[152:155], v[72:75]
    ds_read_b128 v[128:131], v19 offset:16384
    ds_read_b128 v[132:135], v21 offset:16384
    ds_read_b128 v[136:139], v23 offset:16384
    ds_read_b128 v[140:143], v25 offset:16384
    v_mfma_f32_16x16x32_bf16 v[76:79], v[176:179], v[156:159], v[76:79]
    s_mov_b32 s46, 393216
    s_add_u32 m0, s45, 114688
    s_nop 0
    v_mfma_f32_16x16x32_bf16 v[80:83], v[180:183], v[144:147], v[80:83]
    buffer_load_dwordx4 v12, s[12:15], s46 offen lds
    s_cmp_lg_u32 s53, 0
    s_mov_b32 s46, 256
    s_cmov_b32 s46, 393216
    v_mfma_f32_16x16x32_bf16 v[84:87], v[180:183], v[148:151], v[84:87]
    s_mov_b32 s47, 28672
    s_cmov_b32 s47, 122880
    s_add_u32 m0, s45, s47
    v_mfma_f32_16x16x32_bf16 v[88:91], v[180:183], v[152:155], v[88:91]
    s_nop 0
    buffer_load_dwordx4 v13, s[16:19], s46 offen lds
    s_mov_b32 s46, 256
    s_cmp_lg_u32 s52, 0
    v_mfma_f32_16x16x32_bf16 v[92:95], v[180:183], v[156:159], v[92:95]
    s_mov_b32 s47, 196608
    s_cmov_b32 s47, 36864
    s_add_u32 m0, s45, s47
    v_mfma_f32_16x16x32_bf16 v[96:99], v[184:187], v[144:147], v[96:99]
    s_nop 0
    buffer_load_dwordx4 v14, s[8:11], s46 offen lds
    s_mov_b32 s46, 491520
    s_add_u32 m0, s45, 126976
    v_mfma_f32_16x16x32_bf16 v[100:103], v[184:187], v[148:151], v[100:103]
    s_nop 0
    buffer_load_dwordx4 v12, s[12:15], s46 offen lds
    s_cmp_lg_u32 s53, 0
    v_mfma_f32_16x16x32_bf16 v[104:107], v[184:187], v[152:155], v[104:107]
    s_mov_b32 s46, 256
    s_cmov_b32 s46, 491520
    s_mov_b32 s47, 36864
    s_cmov_b32 s47, 135168
    v_mfma_f32_16x16x32_bf16 v[108:111], v[184:187], v[156:159], v[108:111]
    s_add_u32 m0, s45, s47
    s_nop 0
    buffer_load_dwordx4 v15, s[16:19], s46 offen lds
    v_mfma_f32_16x16x32_bf16 v[36:39], v[52:55], v[160:163], v[36:39]
    s_mov_b32 s46, 256
    s_cmp_lg_u32 s52, 0
    s_mov_b32 s47, 196608
    s_cmov_b32 s47, 45056
    v_mfma_f32_16x16x32_bf16 v[40:43], v[160:163], v[160:163], v[40:43]
    s_add_u32 m0, s45, s47
    s_nop 0
    buffer_load_dwordx4 v16, s[8:11], s46 offen lds
    s_nop 1
    v_mfma_f32_16x16x32_bf16 v[112:115], v[176:179], v[52:55], v[112:115]
    v_mfma_f32_16x16x32_bf16 v[116:119], v[180:183], v[52:55], v[116:119]
    v_mfma_f32_16x16x32_bf16 v[120:123], v[184:187], v[52:55], v[120:123]
    s_waitcnt lgkmcnt(0)
    s_barrier
    v_mfma_f32_16x16x32_bf16 v[64:67], v[164:167], v[124:127], v[64:67]
    ds_read_b64_tr_b16 v[176:177], v27 offset:36864
    ds_read_b64_tr_b16 v[178:179], v27 offset:39936
    ds_read_b64_tr_b16 v[180:181], v28 offset:36864
    ds_read_b64_tr_b16 v[182:183], v28 offset:39936
    v_mfma_f32_16x16x32_bf16 v[68:71], v[164:167], v[128:131], v[68:71]
    ds_read_b64_tr_b16 v[184:185], v29 offset:36864
    ds_read_b64_tr_b16 v[186:187], v29 offset:39936
    ds_read_b128 v[144:147], v18 offset:16384
    v_mfma_f32_16x16x32_bf16 v[72:75], v[164:167], v[132:135], v[72:75]
    ds_read_b128 v[148:151], v20 offset:16384
    ds_read_b128 v[152:155], v22 offset:16384
    ds_read_b128 v[156:159], v24 offset:16384
    ds_read_b128 v[160:163], v26 offset:16384
    v_mfma_f32_16x16x32_bf16 v[76:79], v[164:167], v[136:139], v[76:79]
    s_mov_b32 s46, 589824
    s_add_u32 m0, s45, 139264
    s_nop 0
    v_mfma_f32_16x16x32_bf16 v[80:83], v[168:171], v[124:127], v[80:83]
    buffer_load_dwordx4 v12, s[12:15], s46 offen lds
    s_cmp_lg_u32 s53, 0
    s_mov_b32 s46, 384
    s_cmov_b32 s46, 589824
    v_mfma_f32_16x16x32_bf16 v[84:87], v[168:171], v[128:131], v[84:87]
    s_mov_b32 s47, 45056
    s_cmov_b32 s47, 147456
    s_add_u32 m0, s45, s47
    v_mfma_f32_16x16x32_bf16 v[88:91], v[168:171], v[132:135], v[88:91]
    s_nop 0
    buffer_load_dwordx4 v13, s[16:19], s46 offen lds
    s_mov_b32 s46, 384
    s_cmp_lg_u32 s52, 0
    v_mfma_f32_16x16x32_bf16 v[92:95], v[168:171], v[136:139], v[92:95]
    s_mov_b32 s47, 196608
    s_cmov_b32 s47, 53248
    s_add_u32 m0, s45, s47
    v_mfma_f32_16x16x32_bf16 v[96:99], v[172:175], v[124:127], v[96:99]
    s_nop 0
    buffer_load_dwordx4 v14, s[8:11], s46 offen lds
    s_mov_b32 s46, 688128
    s_add_u32 m0, s45, 65536
    v_mfma_f32_16x16x32_bf16 v[100:103], v[172:175], v[128:131], v[100:103]
    s_nop 0
    buffer_load_dwordx4 v12, s[12:15], s46 offen lds
    s_cmp_lg_u32 s53, 0
    v_mfma_f32_16x16x32_bf16 v[104:107], v[172:175], v[132:135], v[104:107]
    s_mov_b32 s46, 384
    s_cmov_b32 s46, 688128
    s_mov_b32 s47, 53248
    s_cmov_b32 s47, 73728
    v_mfma_f32_16x16x32_bf16 v[108:111], v[172:175], v[136:139], v[108:111]
    s_add_u32 m0, s45, s47
    s_nop 0
    buffer_load_dwordx4 v15, s[16:19], s46 offen lds
    v_mfma_f32_16x16x32_bf16 v[36:39], v[52:55], v[140:143], v[36:39]
    s_mov_b32 s46, 384
    s_cmp_lg_u32 s52, 0
    s_mov_b32 s47, 196608
    s_cmov_b32 s47, 61440
    v_mfma_f32_16x16x32_bf16 v[40:43], v[140:143], v[140:143], v[40:43]
    s_add_u32 m0, s45, s47
    s_nop 0
    buffer_load_dwordx4 v16, s[8:11], s46 offen lds
    s_nop 1
    v_mfma_f32_16x16x32_bf16 v[112:115], v[164:167], v[52:55], v[112:115]
    v_mfma_f32_16x16x32_bf16 v[116:119], v[168:171], v[52:55], v[116:119]
    v_mfma_f32_16x16x32_bf16 v[120:123], v[172:175], v[52:55], v[120:123]
    s_waitcnt vmcnt(6) lgkmcnt(0)
    s_barrier
    v_mfma_f32_16x16x32_bf16 v[64:67], v[176:179], v[144:147], v[64:67]
    ds_read_b64_tr_b16 v[164:165], v27 offset:49152
    ds_read_b64_tr_b16 v[166:167], v27 offset:52224
    ds_read_b64_tr_b16 v[168:169], v28 offset:49152
    ds_read_b64_tr_b16 v[170:171], v28 offset:52224
    v_mfma_f32_16x16x32_bf16 v[68:71], v[176:179], v[148:151], v[68:71]
    ds_read_b64_tr_b16 v[172:173], v29 offset:49152
    ds_read_b64_tr_b16 v[174:175], v29 offset:52224
    ds_read_b128 v[124:127], v17 offset:32768
    v_mfma_f32_16x16x32_bf16 v[72:75], v[176:179], v[152:155], v[72:75]
    ds_read_b128 v[128:131], v19 offset:32768
    ds_read_b128 v[132:135], v21 offset:32768
    ds_read_b128 v[136:139], v23 offset:32768
    ds_read_b128 v[140:143], v25 offset:32768
    v_mfma_f32_16x16x32_bf16 v[76:79], v[176:179], v[156:159], v[76:79]
    s_mov_b32 s46, 786432
    s_add_u32 m0, s45, 77824
    s_nop 0
    v_mfma_f32_16x16x32_bf16 v[80:83], v[180:183], v[144:147], v[80:83]
    buffer_load_dwordx4 v12, s[12:15], s46 offen lds
    s_cmp_lg_u32 s53, 0
    s_mov_b32 s46, 512
    s_cmov_b32 s46, 786432
    v_mfma_f32_16x16x32_bf16 v[84:87], v[180:183], v[148:151], v[84:87]
    s_mov_b32 s47, 4294963200
    s_cmov_b32 s47, 86016
    s_add_u32 m0, s45, s47
    v_mfma_f32_16x16x32_bf16 v[88:91], v[180:183], v[152:155], v[88:91]
    s_nop 0
    buffer_load_dwordx4 v13, s[16:19], s46 offen lds
    s_mov_b32 s46, 512
    s_cmp_lg_u32 s52, 0
    v_mfma_f32_16x16x32_bf16 v[92:95], v[180:183], v[156:159], v[92:95]
    s_mov_b32 s47, 196608
    s_cmov_b32 s47, 4096
    s_add_u32 m0, s45, s47
    v_mfma_f32_16x16x32_bf16 v[96:99], v[184:187], v[144:147], v[96:99]
    s_nop 0
    buffer_load_dwordx4 v14, s[8:11], s46 offen lds
    s_mov_b32 s46, 884736
    s_add_u32 m0, s45, 90112
    v_mfma_f32_16x16x32_bf16 v[100:103], v[184:187], v[148:151], v[100:103]
    s_nop 0
    buffer_load_dwordx4 v12, s[12:15], s46 offen lds
    s_cmp_lg_u32 s53, 0
    v_mfma_f32_16x16x32_bf16 v[104:107], v[184:187], v[152:155], v[104:107]
    s_mov_b32 s46, 512
    s_cmov_b32 s46, 884736
    s_mov_b32 s47, 4096
    s_cmov_b32 s47, 98304
    v_mfma_f32_16x16x32_bf16 v[108:111], v[184:187], v[156:159], v[108:111]
    s_add_u32 m0, s45, s47
    s_nop 0
    buffer_load_dwordx4 v15, s[16:19], s46 offen lds
    v_mfma_f32_16x16x32_bf16 v[36:39], v[52:55], v[160:163], v[36:39]
    s_mov_b32 s46, 512
    s_cmp_lg_u32 s52, 0
    s_mov_b32 s47, 196608
    s_cmov_b32 s47, 12288
    v_mfma_f32_16x16x32_bf16 v[40:43], v[160:163], v[160:163], v[40:43]
    s_add_u32 m0, s45, s47
    s_nop 0
    buffer_load_dwordx4 v16, s[8:11], s46 offen lds
    s_nop 1
    v_mfma_f32_16x16x32_bf16 v[112:115], v[176:179], v[52:55], v[112:115]
    v_mfma_f32_16x16x32_bf16 v[116:119], v[180:183], v[52:55], v[116:119]
    v_mfma_f32_16x16x32_bf16 v[120:123], v[184:187], v[52:55], v[120:123]
    s_waitcnt lgkmcnt(0)
    s_barrier
    v_mfma_f32_16x16x32_bf16 v[64:67], v[164:167], v[124:127], v[64:67]
    ds_read_b64_tr_b16 v[176:177], v27 offset:61440
    ds_read_b64_tr_b16 v[178:179], v27 offset:64512
    ds_read_b64_tr_b16 v[180:181], v28 offset:61440
    v_mfma_f32_16x16x32_bf16 v[68:71], v[164:167], v[128:131], v[68:71]
    ds_read_b64_tr_b16 v[182:183], v28 offset:64512
    ds_read_b64_tr_b16 v[184:185], v29 offset:61440
    v_mfma_f32_16x16x32_bf16 v[72:75], v[164:167], v[132:135], v[72:75]
    ds_read_b64_tr_b16 v[186:187], v29 offset:64512
    ds_read_b128 v[144:147], v18 offset:32768
    v_mfma_f32_16x16x32_bf16 v[76:79], v[164:167], v[136:139], v[76:79]
    ds_read_b128 v[148:151], v20 offset:32768
    ds_read_b128 v[152:155], v22 offset:32768
    v_mfma_f32_16x16x32_bf16 v[80:83], v[168:171], v[124:127], v[80:83]
    ds_read_b128 v[156:159], v24 offset:32768
    ds_read_b128 v[160:163], v26 offset:32768
    v_mfma_f32_16x16x32_bf16 v[84:87], v[168:171], v[128:131], v[84:87]
    s_mov_b32 s46, 983040
    s_add_u32 m0, s45, 102400
    v_mfma_f32_16x16x32_bf16 v[88:91], v[168:171], v[132:135], v[88:91]
    s_nop 0
    buffer_load_dwordx4 v12, s[12:15], s46 offen lds
    v_mfma_f32_16x16x32_bf16 v[92:95], v[168:171], v[136:139], v[92:95]
    s_cmp_lg_u32 s53, 0
    s_mov_b32 s46, 640
    s_cmov_b32 s46, 983040
    v_mfma_f32_16x16x32_bf16 v[96:99], v[172:175], v[124:127], v[96:99]
    s_mov_b32 s47, 12288
    s_cmov_b32 s47, 110592
    v_mfma_f32_16x16x32_bf16 v[100:103], v[172:175], v[128:131], v[100:103]
    s_add_u32 m0, s45, s47
    s_nop 0
    v_mfma_f32_16x16x32_bf16 v[104:107], v[172:175], v[132:135], v[104:107]
    buffer_load_dwordx4 v13, s[16:19], s46 offen lds
    s_mov_b32 s46, 640
    v_mfma_f32_16x16x32_bf16 v[108:111], v[172:175], v[136:139], v[108:111]
    s_cmp_lg_u32 s52, 0
    s_mov_b32 s47, 196608
    v_mfma_f32_16x16x32_bf16 v[36:39], v[52:55], v[140:143], v[36:39]
    s_cmov_b32 s47, 20480
    s_add_u32 m0, s45, s47
    v_mfma_f32_16x16x32_bf16 v[40:43], v[140:143], v[140:143], v[40:43]
    s_nop 0
    buffer_load_dwordx4 v14, s[8:11], s46 offen lds
    s_nop 1
    v_mfma_f32_16x16x32_bf16 v[112:115], v[164:167], v[52:55], v[112:115]
    v_mfma_f32_16x16x32_bf16 v[116:119], v[168:171], v[52:55], v[116:119]
    v_mfma_f32_16x16x32_bf16 v[120:123], v[172:175], v[52:55], v[120:123]
    s_waitcnt vmcnt(9) lgkmcnt(0)
    s_barrier
    v_mfma_f32_16x16x32_bf16 v[64:67], v[176:179], v[144:147], v[64:67]
    ds_read_b64_tr_b16 v[164:165], v31 offset:0
    ds_read_b64_tr_b16 v[166:167], v31 offset:3072
    ds_read_b64_tr_b16 v[168:169], v32 offset:0
    v_mfma_f32_16x16x32_bf16 v[68:71], v[176:179], v[148:151], v[68:71]
    ds_read_b64_tr_b16 v[170:171], v32 offset:3072
    ds_read_b64_tr_b16 v[172:173], v33 offset:0
    v_mfma_f32_16x16x32_bf16 v[72:75], v[176:179], v[152:155], v[72:75]
    ds_read_b64_tr_b16 v[174:175], v33 offset:3072
    ds_read_b128 v[124:127], v17 offset:49152
    v_mfma_f32_16x16x32_bf16 v[76:79], v[176:179], v[156:159], v[76:79]
    ds_read_b128 v[128:131], v19 offset:49152
    ds_read_b128 v[132:135], v21 offset:49152
    v_mfma_f32_16x16x32_bf16 v[80:83], v[180:183], v[144:147], v[80:83]
    ds_read_b128 v[136:139], v23 offset:49152
    ds_read_b128 v[140:143], v25 offset:49152
    s_mov_b32 s46, 1081344
    v_mfma_f32_16x16x32_bf16 v[84:87], v[180:183], v[148:151], v[84:87]
    s_add_u32 m0, s45, 114688
    s_nop 0
    v_mfma_f32_16x16x32_bf16 v[88:91], v[180:183], v[152:155], v[88:91]
    buffer_load_dwordx4 v12, s[12:15], s46 offen lds
    s_cmp_lg_u32 s53, 0
    v_mfma_f32_16x16x32_bf16 v[92:95], v[180:183], v[156:159], v[92:95]
    s_mov_b32 s46, 640
    s_cmov_b32 s46, 1081344
    v_mfma_f32_16x16x32_bf16 v[96:99], v[184:187], v[144:147], v[96:99]
    s_mov_b32 s47, 20480
    s_cmov_b32 s47, 122880
    v_mfma_f32_16x16x32_bf16 v[100:103], v[184:187], v[148:151], v[100:103]
    s_add_u32 m0, s45, s47
    s_nop 0
    buffer_load_dwordx4 v15, s[16:19], s46 offen lds
    v_mfma_f32_16x16x32_bf16 v[104:107], v[184:187], v[152:155], v[104:107]
    s_mov_b32 s46, 640
    s_cmp_lg_u32 s52, 0
    v_mfma_f32_16x16x32_bf16 v[108:111], v[184:187], v[156:159], v[108:111]
    s_mov_b32 s47, 196608
    s_cmov_b32 s47, 28672
    v_mfma_f32_16x16x32_bf16 v[36:39], v[52:55], v[160:163], v[36:39]
    s_add_u32 m0, s45, s47
    s_nop 0
    v_mfma_f32_16x16x32_bf16 v[40:43], v[160:163], v[160:163], v[40:43]
    buffer_load_dwordx4 v16, s[8:11], s46 offen lds
    s_load_dwordx2 s[92:93], s[0:1], 72
    s_nop 1
    v_mfma_f32_16x16x32_bf16 v[112:115], v[176:179], v[52:55], v[112:115]
    v_mfma_f32_16x16x32_bf16 v[116:119], v[180:183], v[52:55], v[116:119]
    v_mfma_f32_16x16x32_bf16 v[120:123], v[184:187], v[52:55], v[120:123]
    s_waitcnt lgkmcnt(0)
    s_barrier
    v_mfma_f32_16x16x32_bf16 v[64:67], v[164:167], v[124:127], v[64:67]
    ds_read_b64_tr_b16 v[176:177], v27 offset:0
    ds_read_b64_tr_b16 v[178:179], v27 offset:3072
    ds_read_b64_tr_b16 v[180:181], v28 offset:0
    v_mfma_f32_16x16x32_bf16 v[68:71], v[164:167], v[128:131], v[68:71]
    ds_read_b64_tr_b16 v[182:183], v28 offset:3072
    ds_read_b64_tr_b16 v[184:185], v29 offset:0
    ds_read_b64_tr_b16 v[186:187], v29 offset:3072
    v_mfma_f32_16x16x32_bf16 v[72:75], v[164:167], v[132:135], v[72:75]
    ds_read_b128 v[144:147], v18 offset:49152
    ds_read_b128 v[148:151], v20 offset:49152
    ds_read_b128 v[152:155], v22 offset:49152
    v_mfma_f32_16x16x32_bf16 v[76:79], v[164:167], v[136:139], v[76:79]
    ds_read_b128 v[156:159], v24 offset:49152
    ds_read_b128 v[160:163], v26 offset:49152
    s_mov_b32 s46, 1179648
    v_mfma_f32_16x16x32_bf16 v[80:83], v[168:171], v[124:127], v[80:83]
    s_add_u32 m0, s45, 126976
    s_nop 0
    buffer_load_dwordx4 v12, s[12:15], s46 offen lds
    v_mfma_f32_16x16x32_bf16 v[84:87], v[168:171], v[128:131], v[84:87]
    s_cmp_lg_u32 s53, 0
    s_mov_b32 s46, 768
    s_cmov_b32 s46, 1179648
    v_mfma_f32_16x16x32_bf16 v[88:91], v[168:171], v[132:135], v[88:91]
    s_mov_b32 s47, 28672
    s_cmov_b32 s47, 135168
    v_mfma_f32_16x16x32_bf16 v[92:95], v[168:171], v[136:139], v[92:95]
    s_add_u32 m0, s45, s47
    s_nop 0
    buffer_load_dwordx4 v13, s[16:19], s46 offen lds
    v_mfma_f32_16x16x32_bf16 v[96:99], v[172:175], v[124:127], v[96:99]
    s_mov_b32 s46, 768
    s_cmp_lg_u32 s52, 0
    s_mov_b32 s47, 196608
    v_mfma_f32_16x16x32_bf16 v[100:103], v[172:175], v[128:131], v[100:103]
    s_cmov_b32 s47, 36864
    s_add_u32 m0, s45, s47
    s_nop 0
    v_mfma_f32_16x16x32_bf16 v[104:107], v[172:175], v[132:135], v[104:107]
    buffer_load_dwordx4 v14, s[8:11], s46 offen lds
    s_mov_b32 s92, s92
    s_and_b32 s93, s93, 0xffff
    v_mfma_f32_16x16x32_bf16 v[108:111], v[172:175], v[136:139], v[108:111]
    s_mov_b32 s94, 256
    s_mov_b32 s95, 0x00020000
    v_mov_b32 v9, 2146435072
    v_mfma_f32_16x16x32_bf16 v[36:39], v[52:55], v[140:143], v[36:39]
    v_cmp_eq_u32 vcc, 0, v0
    v_mov_b32 v10, 1
    s_nop 0
    v_mfma_f32_16x16x32_bf16 v[40:43], v[140:143], v[140:143], v[40:43]
    v_cndmask_b32 v9, v9, 0, vcc
    buffer_atomic_add v10, v9, s[92:95], 0 offen
    s_nop 1
    v_mfma_f32_16x16x32_bf16 v[112:115], v[164:167], v[52:55], v[112:115]
    v_mfma_f32_16x16x32_bf16 v[116:119], v[168:171], v[52:55], v[116:119]
    v_mfma_f32_16x16x32_bf16 v[120:123], v[172:175], v[52:55], v[120:123]
    s_waitcnt vmcnt(10) lgkmcnt(0)
    s_barrier
    v_mfma_f32_16x16x32_bf16 v[64:67], v[176:179], v[144:147], v[64:67]
    ds_read_b64_tr_b16 v[164:165], v27 offset:12288
    ds_read_b64_tr_b16 v[166:167], v27 offset:15360
    ds_read_b64_tr_b16 v[168:169], v28 offset:12288
    ds_read_b64_tr_b16 v[170:171], v28 offset:15360
    v_mfma_f32_16x16x32_bf16 v[68:71], v[176:179], v[148:151], v[68:71]
    ds_read_b64_tr_b16 v[172:173], v29 offset:12288
    ds_read_b64_tr_b16 v[174:175], v29 offset:15360
    ds_read_b128 v[124:127], v17 offset:0
    ds_read_b128 v[128:131], v19 offset:0
    v_mfma_f32_16x16x32_bf16 v[72:75], v[176:179], v[152:155], v[72:75]
    ds_read_b128 v[132:135], v21 offset:0
    ds_read_b128 v[136:139], v23 offset:0
    ds_read_b128 v[140:143], v25 offset:0
    s_mov_b32 s46, 1277952
    v_mfma_f32_16x16x32_bf16 v[76:79], v[176:179], v[156:159], v[76:79]
    s_add_u32 m0, s45, 139264
    s_nop 0
    buffer_load_dwordx4 v12, s[12:15], s46 offen lds
    s_cmp_lg_u32 s53, 0
    v_mfma_f32_16x16x32_bf16 v[80:83], v[180:183], v[144:147], v[80:83]
    s_mov_b32 s46, 768
    s_cmov_b32 s46, 1277952
    s_mov_b32 s47, 36864
    s_cmov_b32 s47, 147456
    v_mfma_f32_16x16x32_bf16 v[84:87], v[180:183], v[148:151], v[84:87]
    s_add_u32 m0, s45, s47
    s_nop 0
    buffer_load_dwordx4 v15, s[16:19], s46 offen lds
    s_mov_b32 s46, 768
    v_mfma_f32_16x16x32_bf16 v[88:91], v[180:183], v[152:155], v[88:91]
    s_cmp_lg_u32 s52, 0
    s_mov_b32 s47, 196608
    s_cmov_b32 s47, 45056
    s_add_u32 m0, s45, s47
    v_mfma_f32_16x16x32_bf16 v[92:95], v[180:183], v[156:159], v[92:95]
    s_nop 0
    buffer_load_dwordx4 v16, s[8:11], s46 offen lds
    v_mov_b32 v7, 2146435072
    s_mov_b32 s68, s74
    v_mfma_f32_16x16x32_bf16 v[96:99], v[184:187], v[144:147], v[96:99]
    s_and_b32 s69, s75, 0xffff
    s_mov_b32 s70, 819200
    s_mov_b32 s71, 0x00020000
    s_mov_b32 s76, s76
    v_mfma_f32_16x16x32_bf16 v[100:103], v[184:187], v[148:151], v[100:103]
    s_and_b32 s77, s77, 0xffff
    s_mov_b32 s78, 1966080
    s_mov_b32 s79, 0x00020000
    s_mul_i32 s46, s2, 25
    v_mfma_f32_16x16x32_bf16 v[104:107], v[184:187], v[152:155], v[104:107]
    s_mul_i32 s47, s2, 60
    v_add_u32 v4, s46, v1
    v_lshlrev_b32 v4, 7, v4
    v_cmp_gt_u32 vcc, 25, v1
    v_mfma_f32_16x16x32_bf16 v[108:111], v[184:187], v[156:159], v[108:111]
    s_cmp_eq_u32 s39, 0
    s_cselect_b64 s[48:49], vcc, 0
    v_add_u32 v5, s47, v1
    v_lshlrev_b32 v5, 7, v5
    v_mfma_f32_16x16x32_bf16 v[36:39], v[52:55], v[160:163], v[36:39]
    v_cmp_gt_u32 vcc, 60, v1
    s_cmp_eq_u32 s39, 1
    s_cselect_b64 s[50:51], vcc, 0
    v_cndmask_b32 v4, v7, v4, s[48:49]
    v_mfma_f32_16x16x32_bf16 v[40:43], v[160:163], v[160:163], v[40:43]
    v_cndmask_b32 v5, v7, v5, s[50:51]
    buffer_load_dword v11, v4, s[68:71], 0 offen
    buffer_load_dword v11, v5, s[76:79], 0 offen
    s_nop 1
    v_mfma_f32_16x16x32_bf16 v[112:115], v[176:179], v[52:55], v[112:115]
    v_mfma_f32_16x16x32_bf16 v[116:119], v[180:183], v[52:55], v[116:119]
    v_mfma_f32_16x16x32_bf16 v[120:123], v[184:187], v[52:55], v[120:123]
    s_waitcnt lgkmcnt(0)
    s_barrier
    v_mfma_f32_16x16x32_bf16 v[64:67], v[164:167], v[124:127], v[64:67]
    ds_read_b64_tr_b16 v[176:177], v27 offset:24576
    ds_read_b64_tr_b16 v[178:179], v27 offset:27648
    ds_read_b64_tr_b16 v[180:181], v28 offset:24576
    v_mfma_f32_16x16x32_bf16 v[68:71], v[164:167], v[128:131], v[68:71]
    ds_read_b64_tr_b16 v[182:183], v28 offset:27648
    ds_read_b64_tr_b16 v[184:185], v29 offset:24576
    v_mfma_f32_16x16x32_bf16 v[72:75], v[164:167], v[132:135], v[72:75]
    ds_read_b64_tr_b16 v[186:187], v29 offset:27648
    ds_read_b128 v[144:147], v18 offset:0
    v_mfma_f32_16x16x32_bf16 v[76:79], v[164:167], v[136:139], v[76:79]
    ds_read_b128 v[148:151], v20 offset:0
    ds_read_b128 v[152:155], v22 offset:0
    v_mfma_f32_16x16x32_bf16 v[80:83], v[168:171], v[124:127], v[80:83]
    ds_read_b128 v[156:159], v24 offset:0
    ds_read_b128 v[160:163], v26 offset:0
    v_mfma_f32_16x16x32_bf16 v[84:87], v[168:171], v[128:131], v[84:87]
    s_mov_b32 s46, 1376256
    s_add_u32 m0, s45, 65536
    v_mfma_f32_16x16x32_bf16 v[88:91], v[168:171], v[132:135], v[88:91]
    s_nop 0
    buffer_load_dwordx4 v12, s[12:15], s46 offen lds
    v_mfma_f32_16x16x32_bf16 v[92:95], v[168:171], v[136:139], v[92:95]
    s_cmp_lg_u32 s53, 0
    s_mov_b32 s46, 896
    s_cmov_b32 s46, 1376256
    v_mfma_f32_16x16x32_bf16 v[96:99], v[172:175], v[124:127], v[96:99]
    s_mov_b32 s47, 45056
    s_cmov_b32 s47, 73728
    v_mfma_f32_16x16x32_bf16 v[100:103], v[172:175], v[128:131], v[100:103]
    s_add_u32 m0, s45, s47
    s_nop 0
    v_mfma_f32_16x16x32_bf16 v[104:107], v[172:175], v[132:135], v[104:107]
    buffer_load_dwordx4 v13, s[16:19], s46 offen lds
    s_mov_b32 s46, 896
    v_mfma_f32_16x16x32_bf16 v[108:111], v[172:175], v[136:139], v[108:111]
    s_cmp_lg_u32 s52, 0
    s_mov_b32 s47, 196608
    v_mfma_f32_16x16x32_bf16 v[36:39], v[52:55], v[140:143], v[36:39]
    s_cmov_b32 s47, 53248
    s_add_u32 m0, s45, s47
    v_mfma_f32_16x16x32_bf16 v[40:43], v[140:143], v[140:143], v[40:43]
    s_nop 0
    buffer_load_dwordx4 v14, s[8:11], s46 offen lds
    s_nop 1
    v_mfma_f32_16x16x32_bf16 v[112:115], v[164:167], v[52:55], v[112:115]
    v_mfma_f32_16x16x32_bf16 v[116:119], v[168:171], v[52:55], v[116:119]
    v_mfma_f32_16x16x32_bf16 v[120:123], v[172:175], v[52:55], v[120:123]
    s_waitcnt vmcnt(12) lgkmcnt(0)
    s_barrier
    v_mfma_f32_16x16x32_bf16 v[64:67], v[176:179], v[144:147], v[64:67]
    ds_read_b64_tr_b16 v[164:165], v27 offset:36864
    ds_read_b64_tr_b16 v[166:167], v27 offset:39936
    ds_read_b64_tr_b16 v[168:169], v28 offset:36864
    v_mfma_f32_16x16x32_bf16 v[68:71], v[176:179], v[148:151], v[68:71]
    ds_read_b64_tr_b16 v[170:171], v28 offset:39936
    ds_read_b64_tr_b16 v[172:173], v29 offset:36864
    v_mfma_f32_16x16x32_bf16 v[72:75], v[176:179], v[152:155], v[72:75]
    ds_read_b64_tr_b16 v[174:175], v29 offset:39936
    ds_read_b128 v[124:127], v17 offset:16384
    v_mfma_f32_16x16x32_bf16 v[76:79], v[176:179], v[156:159], v[76:79]
    ds_read_b128 v[128:131], v19 offset:16384
    ds_read_b128 v[132:135], v21 offset:16384
    v_mfma_f32_16x16x32_bf16 v[80:83], v[180:183], v[144:147], v[80:83]
    ds_read_b128 v[136:139], v23 offset:16384
    ds_read_b128 v[140:143], v25 offset:16384
    v_mfma_f32_16x16x32_bf16 v[84:87], v[180:183], v[148:151], v[84:87]
    s_mov_b32 s46, 1474560
    s_add_u32 m0, s45, 77824
    v_mfma_f32_16x16x32_bf16 v[88:91], v[180:183], v[152:155], v[88:91]
    s_nop 0
    buffer_load_dwordx4 v12, s[12:15], s46 offen lds
    v_mfma_f32_16x16x32_bf16 v[92:95], v[180:183], v[156:159], v[92:95]
    s_cmp_lg_u32 s53, 0
    s_mov_b32 s46, 896
    s_cmov_b32 s46, 1474560
    v_mfma_f32_16x16x32_bf16 v[96:99], v[184:187], v[144:147], v[96:99]
    s_mov_b32 s47, 53248
    s_cmov_b32 s47, 86016
    v_mfma_f32_16x16x32_bf16 v[100:103], v[184:187], v[148:151], v[100:103]
    s_add_u32 m0, s45, s47
    s_nop 0
    v_mfma_f32_16x16x32_bf16 v[104:107], v[184:187], v[152:155], v[104:107]
    buffer_load_dwordx4 v15, s[16:19], s46 offen lds
    s_mov_b32 s46, 896
    v_mfma_f32_16x16x32_bf16 v[108:111], v[184:187], v[156:159], v[108:111]
    s_cmp_lg_u32 s52, 0
    s_mov_b32 s47, 196608
    v_mfma_f32_16x16x32_bf16 v[36:39], v[52:55], v[160:163], v[36:39]
    s_cmov_b32 s47, 61440
    s_add_u32 m0, s45, s47
    v_mfma_f32_16x16x32_bf16 v[40:43], v[160:163], v[160:163], v[40:43]
    s_nop 0
    buffer_load_dwordx4 v16, s[8:11], s46 offen lds
    s_nop 1
    v_mfma_f32_16x16x32_bf16 v[112:115], v[176:179], v[52:55], v[112:115]
    v_mfma_f32_16x16x32_bf16 v[116:119], v[180:183], v[52:55], v[116:119]
    v_mfma_f32_16x16x32_bf16 v[120:123], v[184:187], v[52:55], v[120:123]
    s_waitcnt lgkmcnt(0)
    s_barrier
    v_mfma_f32_16x16x32_bf16 v[64:67], v[164:167], v[124:127], v[64:67]
    ds_read_b64_tr_b16 v[176:177], v27 offset:49152
    ds_read_b64_tr_b16 v[178:179], v27 offset:52224
    ds_read_b64_tr_b16 v[180:181], v28 offset:49152
    v_mfma_f32_16x16x32_bf16 v[68:71], v[164:167], v[128:131], v[68:71]
    ds_read_b64_tr_b16 v[182:183], v28 offset:52224
    ds_read_b64_tr_b16 v[184:185], v29 offset:49152
    v_mfma_f32_16x16x32_bf16 v[72:75], v[164:167], v[132:135], v[72:75]
    ds_read_b64_tr_b16 v[186:187], v29 offset:52224
    ds_read_b128 v[144:147], v18 offset:16384
    v_mfma_f32_16x16x32_bf16 v[76:79], v[164:167], v[136:139], v[76:79]
    ds_read_b128 v[148:151], v20 offset:16384
    ds_read_b128 v[152:155], v22 offset:16384
    v_mfma_f32_16x16x32_bf16 v[80:83], v[168:171], v[124:127], v[80:83]
    ds_read_b128 v[156:159], v24 offset:16384
    ds_read_b128 v[160:163], v26 offset:16384
    v_mfma_f32_16x16x32_bf16 v[84:87], v[168:171], v[128:131], v[84:87]
    s_mov_b32 s46, 1572864
    s_add_u32 m0, s45, 90112
    v_mfma_f32_16x16x32_bf16 v[88:91], v[168:171], v[132:135], v[88:91]
    s_nop 0
    buffer_load_dwordx4 v12, s[12:15], s46 offen lds
    v_mfma_f32_16x16x32_bf16 v[92:95], v[168:171], v[136:139], v[92:95]
    s_cmp_lg_u32 s53, 0
    s_mov_b32 s46, 1024
    s_cmov_b32 s46, 1572864
    v_mfma_f32_16x16x32_bf16 v[96:99], v[172:175], v[124:127], v[96:99]
    s_mov_b32 s47, 4294963200
    s_cmov_b32 s47, 98304
    v_mfma_f32_16x16x32_bf16 v[100:103], v[172:175], v[128:131], v[100:103]
    s_add_u32 m0, s45, s47
    s_nop 0
    v_mfma_f32_16x16x32_bf16 v[104:107], v[172:175], v[132:135], v[104:107]
    buffer_load_dwordx4 v13, s[16:19], s46 offen lds
    s_mov_b32 s46, 1024
    v_mfma_f32_16x16x32_bf16 v[108:111], v[172:175], v[136:139], v[108:111]
    s_cmp_lg_u32 s52, 0
    s_mov_b32 s47, 196608
    v_mfma_f32_16x16x32_bf16 v[36:39], v[52:55], v[140:143], v[36:39]
    s_cmov_b32 s47, 4096
    s_add_u32 m0, s45, s47
    v_mfma_f32_16x16x32_bf16 v[40:43], v[140:143], v[140:143], v[40:43]
    s_nop 0
    buffer_load_dwordx4 v14, s[8:11], s46 offen lds
    s_nop 1
    v_mfma_f32_16x16x32_bf16 v[112:115], v[164:167], v[52:55], v[112:115]
    v_mfma_f32_16x16x32_bf16 v[116:119], v[168:171], v[52:55], v[116:119]
    v_mfma_f32_16x16x32_bf16 v[120:123], v[172:175], v[52:55], v[120:123]
    s_waitcnt vmcnt(11) lgkmcnt(0)
    s_barrier
    v_mfma_f32_16x16x32_bf16 v[64:67], v[176:179], v[144:147], v[64:67]
    ds_read_b64_tr_b16 v[164:165], v27 offset:61440
    ds_read_b64_tr_b16 v[166:167], v27 offset:64512
    ds_read_b64_tr_b16 v[168:169], v28 offset:61440
    v_mfma_f32_16x16x32_bf16 v[68:71], v[176:179], v[148:151], v[68:71]
    ds_read_b64_tr_b16 v[170:171], v28 offset:64512
    ds_read_b64_tr_b16 v[172:173], v29 offset:61440
    v_mfma_f32_16x16x32_bf16 v[72:75], v[176:179], v[152:155], v[72:75]
    ds_read_b64_tr_b16 v[174:175], v29 offset:64512
    ds_read_b128 v[124:127], v17 offset:32768
    v_mfma_f32_16x16x32_bf16 v[76:79], v[176:179], v[156:159], v[76:79]
    ds_read_b128 v[128:131], v19 offset:32768
    ds_read_b128 v[132:135], v21 offset:32768
    v_mfma_f32_16x16x32_bf16 v[80:83], v[180:183], v[144:147], v[80:83]
    ds_read_b128 v[136:139], v23 offset:32768
    ds_read_b128 v[140:143], v25 offset:32768
    v_mfma_f32_16x16x32_bf16 v[84:87], v[180:183], v[148:151], v[84:87]
    s_mov_b32 s46, 1671168
    s_add_u32 m0, s45, 102400
    v_mfma_f32_16x16x32_bf16 v[88:91], v[180:183], v[152:155], v[88:91]
    s_nop 0
    buffer_load_dwordx4 v12, s[12:15], s46 offen lds
    v_mfma_f32_16x16x32_bf16 v[92:95], v[180:183], v[156:159], v[92:95]
    s_cmp_lg_u32 s53, 0
    s_mov_b32 s46, 1024
    s_cmov_b32 s46, 1671168
    v_mfma_f32_16x16x32_bf16 v[96:99], v[184:187], v[144:147], v[96:99]
    s_mov_b32 s47, 4096
    s_cmov_b32 s47, 110592
    v_mfma_f32_16x16x32_bf16 v[100:103], v[184:187], v[148:151], v[100:103]
    s_add_u32 m0, s45, s47
    s_nop 0
    v_mfma_f32_16x16x32_bf16 v[104:107], v[184:187], v[152:155], v[104:107]
    buffer_load_dwordx4 v15, s[16:19], s46 offen lds
    s_mov_b32 s46, 1024
    v_mfma_f32_16x16x32_bf16 v[108:111], v[184:187], v[156:159], v[108:111]
    s_cmp_lg_u32 s52, 0
    s_mov_b32 s47, 196608
    v_mfma_f32_16x16x32_bf16 v[36:39], v[52:55], v[160:163], v[36:39]
    s_cmov_b32 s47, 12288
    s_add_u32 m0, s45, s47
    v_mfma_f32_16x16x32_bf16 v[40:43], v[160:163], v[160:163], v[40:43]
    s_nop 0
    buffer_load_dwordx4 v16, s[8:11], s46 offen lds
    s_nop 1
    v_mfma_f32_16x16x32_bf16 v[112:115], v[176:179], v[52:55], v[112:115]
    v_mfma_f32_16x16x32_bf16 v[116:119], v[180:183], v[52:55], v[116:119]
    v_mfma_f32_16x16x32_bf16 v[120:123], v[184:187], v[52:55], v[120:123]
    s_waitcnt lgkmcnt(0)
    s_barrier
    v_mfma_f32_16x16x32_bf16 v[64:67], v[164:167], v[124:127], v[64:67]
    ds_read_b64_tr_b16 v[176:177], v31 offset:0
    ds_read_b64_tr_b16 v[178:179], v31 offset:3072
    ds_read_b64_tr_b16 v[180:181], v32 offset:0
    v_mfma_f32_16x16x32_bf16 v[68:71], v[164:167], v[128:131], v[68:71]
    ds_read_b64_tr_b16 v[182:183], v32 offset:3072
    ds_read_b64_tr_b16 v[184:185], v33 offset:0
    v_mfma_f32_16x16x32_bf16 v[72:75], v[164:167], v[132:135], v[72:75]
    ds_read_b64_tr_b16 v[186:187], v33 offset:3072
    ds_read_b128 v[144:147], v18 offset:32768
    v_mfma_f32_16x16x32_bf16 v[76:79], v[164:167], v[136:139], v[76:79]
    ds_read_b128 v[148:151], v20 offset:32768
    ds_read_b128 v[152:155], v22 offset:32768
    v_mfma_f32_16x16x32_bf16 v[80:83], v[168:171], v[124:127], v[80:83]
    ds_read_b128 v[156:159], v24 offset:32768
    ds_read_b128 v[160:163], v26 offset:32768
    v_mfma_f32_16x16x32_bf16 v[84:87], v[168:171], v[128:131], v[84:87]
    s_mov_b32 s46, 1769472
    s_add_u32 m0, s45, 114688
    v_mfma_f32_16x16x32_bf16 v[88:91], v[168:171], v[132:135], v[88:91]
    s_nop 0
    buffer_load_dwordx4 v12, s[12:15], s46 offen lds
    v_mfma_f32_16x16x32_bf16 v[92:95], v[168:171], v[136:139], v[92:95]
    s_cmp_lg_u32 s53, 0
    s_mov_b32 s46, 1152
    s_cmov_b32 s46, 1769472
    v_mfma_f32_16x16x32_bf16 v[96:99], v[172:175], v[124:127], v[96:99]
    s_mov_b32 s47, 12288
    s_cmov_b32 s47, 122880
    v_mfma_f32_16x16x32_bf16 v[100:103], v[172:175], v[128:131], v[100:103]
    s_add_u32 m0, s45, s47
    s_nop 0
    v_mfma_f32_16x16x32_bf16 v[104:107], v[172:175], v[132:135], v[104:107]
    buffer_load_dwordx4 v13, s[16:19], s46 offen lds
    s_mov_b32 s46, 1152
    v_mfma_f32_16x16x32_bf16 v[108:111], v[172:175], v[136:139], v[108:111]
    s_cmp_lg_u32 s52, 0
    s_mov_b32 s47, 196608
    v_mfma_f32_16x16x32_bf16 v[36:39], v[52:55], v[140:143], v[36:39]
    s_cmov_b32 s47, 20480
    s_add_u32 m0, s45, s47
    v_mfma_f32_16x16x32_bf16 v[40:43], v[140:143], v[140:143], v[40:43]
    s_nop 0
    buffer_load_dwordx4 v14, s[8:11], s46 offen lds
    s_nop 1
    v_mfma_f32_16x16x32_bf16 v[112:115], v[164:167], v[52:55], v[112:115]
    v_mfma_f32_16x16x32_bf16 v[116:119], v[168:171], v[52:55], v[116:119]
    v_mfma_f32_16x16x32_bf16 v[120:123], v[172:175], v[52:55], v[120:123]
    s_waitcnt vmcnt(9) lgkmcnt(0)
    s_barrier
    v_mfma_f32_16x16x32_bf16 v[64:67], v[176:179], v[144:147], v[64:67]
    ds_read_b64_tr_b16 v[164:165], v27 offset:0
    ds_read_b64_tr_b16 v[166:167], v27 offset:3072
    ds_read_b64_tr_b16 v[168:169], v28 offset:0
    v_mfma_f32_16x16x32_bf16 v[68:71], v[176:179], v[148:151], v[68:71]
    ds_read_b64_tr_b16 v[170:171], v28 offset:3072
    ds_read_b64_tr_b16 v[172:173], v29 offset:0
    v_mfma_f32_16x16x32_bf16 v[72:75], v[176:179], v[152:155], v[72:75]
    ds_read_b64_tr_b16 v[174:175], v29 offset:3072
    ds_read_b128 v[124:127], v17 offset:49152
    v_mfma_f32_16x16x32_bf16 v[76:79], v[176:179], v[156:159], v[76:79]
    ds_read_b128 v[128:131], v19 offset:49152
    ds_read_b128 v[132:135], v21 offset:49152
    v_mfma_f32_16x16x32_bf16 v[80:83], v[180:183], v[144:147], v[80:83]
    ds_read_b128 v[136:139], v23 offset:49152
    ds_read_b128 v[140:143], v25 offset:49152
    v_mfma_f32_16x16x32_bf16 v[84:87], v[180:183], v[148:151], v[84:87]
    s_mov_b32 s46, 1867776
    s_add_u32 m0, s45, 126976
    v_mfma_f32_16x16x32_bf16 v[88:91], v[180:183], v[152:155], v[88:91]
    s_nop 0
    buffer_load_dwordx4 v12, s[12:15], s46 offen lds
    v_mfma_f32_16x16x32_bf16 v[92:95], v[180:183], v[156:159], v[92:95]
    s_cmp_lg_u32 s53, 0
    s_mov_b32 s46, 1152
    s_cmov_b32 s46, 1867776
    v_mfma_f32_16x16x32_bf16 v[96:99], v[184:187], v[144:147], v[96:99]
    s_mov_b32 s47, 20480
    s_cmov_b32 s47, 135168
    v_mfma_f32_16x16x32_bf16 v[100:103], v[184:187], v[148:151], v[100:103]
    s_add_u32 m0, s45, s47
    s_nop 0
    v_mfma_f32_16x16x32_bf16 v[104:107], v[184:187], v[152:155], v[104:107]
    buffer_load_dwordx4 v15, s[16:19], s46 offen lds
    s_mov_b32 s46, 1152
    v_mfma_f32_16x16x32_bf16 v[108:111], v[184:187], v[156:159], v[108:111]
    s_cmp_lg_u32 s52, 0
    s_mov_b32 s47, 196608
    v_mfma_f32_16x16x32_bf16 v[36:39], v[52:55], v[160:163], v[36:39]
    s_cmov_b32 s47, 28672
    s_add_u32 m0, s45, s47
    v_mfma_f32_16x16x32_bf16 v[40:43], v[160:163], v[160:163], v[40:43]
    s_nop 0
    buffer_load_dwordx4 v16, s[8:11], s46 offen lds
    s_nop 1
    v_mfma_f32_16x16x32_bf16 v[112:115], v[176:179], v[52:55], v[112:115]
    v_mfma_f32_16x16x32_bf16 v[116:119], v[180:183], v[52:55], v[116:119]
    v_mfma_f32_16x16x32_bf16 v[120:123], v[184:187], v[52:55], v[120:123]
    s_waitcnt lgkmcnt(0)
    s_barrier
    v_mfma_f32_16x16x32_bf16 v[64:67], v[164:167], v[124:127], v[64:67]
    ds_read_b64_tr_b16 v[176:177], v27 offset:12288
    v_mfma_f32_16x16x32_bf16 v[68:71], v[164:167], v[128:131], v[68:71]
    ds_read_b64_tr_b16 v[178:179], v27 offset:15360
    v_mfma_f32_16x16x32_bf16 v[72:75], v[164:167], v[132:135], v[72:75]
    ds_read_b64_tr_b16 v[180:181], v28 offset:12288
    v_mfma_f32_16x16x32_bf16 v[76:79], v[164:167], v[136:139], v[76:79]
    ds_read_b64_tr_b16 v[182:183], v28 offset:15360
    v_mfma_f32_16x16x32_bf16 v[80:83], v[168:171], v[124:127], v[80:83]
    v_mfma_f32_16x16x32_bf16 v[84:87], v[168:171], v[128:131], v[84:87]
    ds_read_b64_tr_b16 v[184:185], v29 offset:12288
    v_mfma_f32_16x16x32_bf16 v[88:91], v[168:171], v[132:135], v[88:91]
    ds_read_b64_tr_b16 v[186:187], v29 offset:15360
    v_mfma_f32_16x16x32_bf16 v[92:95], v[168:171], v[136:139], v[92:95]
    ds_read_b128 v[144:147], v18 offset:49152
    v_mfma_f32_16x16x32_bf16 v[96:99], v[172:175], v[124:127], v[96:99]
    ds_read_b128 v[148:151], v20 offset:49152
    v_mfma_f32_16x16x32_bf16 v[100:103], v[172:175], v[128:131], v[100:103]
    v_mfma_f32_16x16x32_bf16 v[104:107], v[172:175], v[132:135], v[104:107]
    ds_read_b128 v[152:155], v22 offset:49152
    v_mfma_f32_16x16x32_bf16 v[108:111], v[172:175], v[136:139], v[108:111]
    ds_read_b128 v[156:159], v24 offset:49152
    v_mfma_f32_16x16x32_bf16 v[36:39], v[52:55], v[140:143], v[36:39]
    ds_read_b128 v[160:163], v26 offset:49152
    v_mfma_f32_16x16x32_bf16 v[40:43], v[140:143], v[140:143], v[40:43]
    s_nop 1
    v_mfma_f32_16x16x32_bf16 v[112:115], v[164:167], v[52:55], v[112:115]
    v_mfma_f32_16x16x32_bf16 v[116:119], v[168:171], v[52:55], v[116:119]
    v_mfma_f32_16x16x32_bf16 v[120:123], v[172:175], v[52:55], v[120:123]
    s_waitcnt vmcnt(6) lgkmcnt(0)
    s_barrier
    v_mfma_f32_16x16x32_bf16 v[64:67], v[176:179], v[144:147], v[64:67]
    ds_read_b64_tr_b16 v[164:165], v27 offset:24576
    v_mfma_f32_16x16x32_bf16 v[68:71], v[176:179], v[148:151], v[68:71]
    ds_read_b64_tr_b16 v[166:167], v27 offset:27648
    v_mfma_f32_16x16x32_bf16 v[72:75], v[176:179], v[152:155], v[72:75]
    ds_read_b64_tr_b16 v[168:169], v28 offset:24576
    v_mfma_f32_16x16x32_bf16 v[76:79], v[176:179], v[156:159], v[76:79]
    ds_read_b64_tr_b16 v[170:171], v28 offset:27648
    v_mfma_f32_16x16x32_bf16 v[80:83], v[180:183], v[144:147], v[80:83]
    v_mfma_f32_16x16x32_bf16 v[84:87], v[180:183], v[148:151], v[84:87]
    ds_read_b64_tr_b16 v[172:173], v29 offset:24576
    v_mfma_f32_16x16x32_bf16 v[88:91], v[180:183], v[152:155], v[88:91]
    ds_read_b64_tr_b16 v[174:175], v29 offset:27648
    v_mfma_f32_16x16x32_bf16 v[92:95], v[180:183], v[156:159], v[92:95]
    ds_read_b128 v[124:127], v17 offset:0
    v_mfma_f32_16x16x32_bf16 v[96:99], v[184:187], v[144:147], v[96:99]
    ds_read_b128 v[128:131], v19 offset:0
    v_mfma_f32_16x16x32_bf16 v[100:103], v[184:187], v[148:151], v[100:103]
    v_mfma_f32_16x16x32_bf16 v[104:107], v[184:187], v[152:155], v[104:107]
    ds_read_b128 v[132:135], v21 offset:0
    v_mfma_f32_16x16x32_bf16 v[108:111], v[184:187], v[156:159], v[108:111]
    ds_read_b128 v[136:139], v23 offset:0
    v_mfma_f32_16x16x32_bf16 v[36:39], v[52:55], v[160:163], v[36:39]
    ds_read_b128 v[140:143], v25 offset:0
    v_mfma_f32_16x16x32_bf16 v[40:43], v[160:163], v[160:163], v[40:43]
    s_nop 1
    v_mfma_f32_16x16x32_bf16 v[112:115], v[176:179], v[52:55], v[112:115]
    v_mfma_f32_16x16x32_bf16 v[116:119], v[180:183], v[52:55], v[116:119]
    v_mfma_f32_16x16x32_bf16 v[120:123], v[184:187], v[52:55], v[120:123]
    s_waitcnt lgkmcnt(0)
    s_barrier
    v_mfma_f32_16x16x32_bf16 v[64:67], v[164:167], v[124:127], v[64:67]
    ds_read_b64_tr_b16 v[176:177], v27 offset:36864
    v_mfma_f32_16x16x32_bf16 v[68:71], v[164:167], v[128:131], v[68:71]
    ds_read_b64_tr_b16 v[178:179], v27 offset:39936
    v_mfma_f32_16x16x32_bf16 v[72:75], v[164:167], v[132:135], v[72:75]
    ds_read_b64_tr_b16 v[180:181], v28 offset:36864
    v_mfma_f32_16x16x32_bf16 v[76:79], v[164:167], v[136:139], v[76:79]
    ds_read_b64_tr_b16 v[182:183], v28 offset:39936
    v_mfma_f32_16x16x32_bf16 v[80:83], v[168:171], v[124:127], v[80:83]
    v_mfma_f32_16x16x32_bf16 v[84:87], v[168:171], v[128:131], v[84:87]
    ds_read_b64_tr_b16 v[184:185], v29 offset:36864
    v_mfma_f32_16x16x32_bf16 v[88:91], v[168:171], v[132:135], v[88:91]
    ds_read_b64_tr_b16 v[186:187], v29 offset:39936
    v_mfma_f32_16x16x32_bf16 v[92:95], v[168:171], v[136:139], v[92:95]
    ds_read_b128 v[144:147], v18 offset:0
    v_mfma_f32_16x16x32_bf16 v[96:99], v[172:175], v[124:127], v[96:99]
    ds_read_b128 v[148:151], v20 offset:0
    v_mfma_f32_16x16x32_bf16 v[100:103], v[172:175], v[128:131], v[100:103]
    v_mfma_f32_16x16x32_bf16 v[104:107], v[172:175], v[132:135], v[104:107]
    ds_read_b128 v[152:155], v22 offset:0
    v_mfma_f32_16x16x32_bf16 v[108:111], v[172:175], v[136:139], v[108:111]
    ds_read_b128 v[156:159], v24 offset:0
    v_mfma_f32_16x16x32_bf16 v[36:39], v[52:55], v[140:143], v[36:39]
    ds_read_b128 v[160:163], v26 offset:0
    v_mfma_f32_16x16x32_bf16 v[40:43], v[140:143], v[140:143], v[40:43]
    s_nop 1
    v_mfma_f32_16x16x32_bf16 v[112:115], v[164:167], v[52:55], v[112:115]
    v_mfma_f32_16x16x32_bf16 v[116:119], v[168:171], v[52:55], v[116:119]
    v_mfma_f32_16x16x32_bf16 v[120:123], v[172:175], v[52:55], v[120:123]
    s_waitcnt vmcnt(0) lgkmcnt(0)
    s_barrier
    v_mfma_f32_16x16x32_bf16 v[64:67], v[176:179], v[144:147], v[64:67]
    ds_read_b64_tr_b16 v[164:165], v27 offset:49152
    v_mfma_f32_16x16x32_bf16 v[68:71], v[176:179], v[148:151], v[68:71]
    ds_read_b64_tr_b16 v[166:167], v27 offset:52224
    v_mfma_f32_16x16x32_bf16 v[72:75], v[176:179], v[152:155], v[72:75]
    ds_read_b64_tr_b16 v[168:169], v28 offset:49152
    v_mfma_f32_16x16x32_bf16 v[76:79], v[176:179], v[156:159], v[76:79]
    ds_read_b64_tr_b16 v[170:171], v28 offset:52224
    v_mfma_f32_16x16x32_bf16 v[80:83], v[180:183], v[144:147], v[80:83]
    v_mfma_f32_16x16x32_bf16 v[84:87], v[180:183], v[148:151], v[84:87]
    ds_read_b64_tr_b16 v[172:173], v29 offset:49152
    v_mfma_f32_16x16x32_bf16 v[88:91], v[180:183], v[152:155], v[88:91]
    ds_read_b64_tr_b16 v[174:175], v29 offset:52224
    v_mfma_f32_16x16x32_bf16 v[92:95], v[180:183], v[156:159], v[92:95]
    ds_read_b128 v[124:127], v17 offset:16384
    v_mfma_f32_16x16x32_bf16 v[96:99], v[184:187], v[144:147], v[96:99]
    ds_read_b128 v[128:131], v19 offset:16384
    v_mfma_f32_16x16x32_bf16 v[100:103], v[184:187], v[148:151], v[100:103]
    v_mfma_f32_16x16x32_bf16 v[104:107], v[184:187], v[152:155], v[104:107]
    ds_read_b128 v[132:135], v21 offset:16384
    v_mfma_f32_16x16x32_bf16 v[108:111], v[184:187], v[156:159], v[108:111]
    ds_read_b128 v[136:139], v23 offset:16384
    v_mfma_f32_16x16x32_bf16 v[36:39], v[52:55], v[160:163], v[36:39]
    ds_read_b128 v[140:143], v25 offset:16384
    v_mfma_f32_16x16x32_bf16 v[40:43], v[160:163], v[160:163], v[40:43]
    s_nop 1
    v_mfma_f32_16x16x32_bf16 v[112:115], v[176:179], v[52:55], v[112:115]
    v_mfma_f32_16x16x32_bf16 v[116:119], v[180:183], v[52:55], v[116:119]
    v_mfma_f32_16x16x32_bf16 v[120:123], v[184:187], v[52:55], v[120:123]
    s_waitcnt lgkmcnt(0)
    s_barrier
    v_mfma_f32_16x16x32_bf16 v[64:67], v[164:167], v[124:127], v[64:67]
    ds_read_b64_tr_b16 v[176:177], v27 offset:61440
    v_mfma_f32_16x16x32_bf16 v[68:71], v[164:167], v[128:131], v[68:71]
    ds_read_b64_tr_b16 v[178:179], v27 offset:64512
    v_mfma_f32_16x16x32_bf16 v[72:75], v[164:167], v[132:135], v[72:75]
    ds_read_b64_tr_b16 v[180:181], v28 offset:61440
    v_mfma_f32_16x16x32_bf16 v[76:79], v[164:167], v[136:139], v[76:79]
    ds_read_b64_tr_b16 v[182:183], v28 offset:64512
    v_mfma_f32_16x16x32_bf16 v[80:83], v[168:171], v[124:127], v[80:83]
    v_mfma_f32_16x16x32_bf16 v[84:87], v[168:171], v[128:131], v[84:87]
    ds_read_b64_tr_b16 v[184:185], v29 offset:61440
    v_mfma_f32_16x16x32_bf16 v[88:91], v[168:171], v[132:135], v[88:91]
    ds_read_b64_tr_b16 v[186:187], v29 offset:64512
    v_mfma_f32_16x16x32_bf16 v[92:95], v[168:171], v[136:139], v[92:95]
    ds_read_b128 v[144:147], v18 offset:16384
    v_mfma_f32_16x16x32_bf16 v[96:99], v[172:175], v[124:127], v[96:99]
    ds_read_b128 v[148:151], v20 offset:16384
    v_mfma_f32_16x16x32_bf16 v[100:103], v[172:175], v[128:131], v[100:103]
    v_mfma_f32_16x16x32_bf16 v[104:107], v[172:175], v[132:135], v[104:107]
    ds_read_b128 v[152:155], v22 offset:16384
    v_mfma_f32_16x16x32_bf16 v[108:111], v[172:175], v[136:139], v[108:111]
    ds_read_b128 v[156:159], v24 offset:16384
    v_mfma_f32_16x16x32_bf16 v[36:39], v[52:55], v[140:143], v[36:39]
    ds_read_b128 v[160:163], v26 offset:16384
    v_mfma_f32_16x16x32_bf16 v[40:43], v[140:143], v[140:143], v[40:43]
    s_nop 1
    v_mfma_f32_16x16x32_bf16 v[112:115], v[164:167], v[52:55], v[112:115]
    v_mfma_f32_16x16x32_bf16 v[116:119], v[168:171], v[52:55], v[116:119]
    v_mfma_f32_16x16x32_bf16 v[120:123], v[172:175], v[52:55], v[120:123]
    s_waitcnt lgkmcnt(0)
    v_mfma_f32_16x16x32_bf16 v[64:67], v[176:179], v[144:147], v[64:67]
    v_mfma_f32_16x16x32_bf16 v[68:71], v[176:179], v[148:151], v[68:71]
    v_mfma_f32_16x16x32_bf16 v[72:75], v[176:179], v[152:155], v[72:75]
    v_mfma_f32_16x16x32_bf16 v[76:79], v[176:179], v[156:159], v[76:79]
    v_mfma_f32_16x16x32_bf16 v[80:83], v[180:183], v[144:147], v[80:83]
    v_mfma_f32_16x16x32_bf16 v[84:87], v[180:183], v[148:151], v[84:87]
    v_mfma_f32_16x16x32_bf16 v[88:91], v[180:183], v[152:155], v[88:91]
    v_mfma_f32_16x16x32_bf16 v[92:95], v[180:183], v[156:159], v[92:95]
    v_mfma_f32_16x16x32_bf16 v[96:99], v[184:187], v[144:147], v[96:99]
    v_mfma_f32_16x16x32_bf16 v[100:103], v[184:187], v[148:151], v[100:103]
    v_mfma_f32_16x16x32_bf16 v[104:107], v[184:187], v[152:155], v[104:107]
    v_mfma_f32_16x16x32_bf16 v[108:111], v[184:187], v[156:159], v[108:111]
    v_mfma_f32_16x16x32_bf16 v[36:39], v[52:55], v[160:163], v[36:39]
    v_mfma_f32_16x16x32_bf16 v[40:43], v[160:163], v[160:163], v[40:43]
    s_nop 1
    v_mfma_f32_16x16x32_bf16 v[112:115], v[176:179], v[52:55], v[112:115]
    v_mfma_f32_16x16x32_bf16 v[116:119], v[180:183], v[52:55], v[116:119]
    v_mfma_f32_16x16x32_bf16 v[120:123], v[184:187], v[52:55], v[120:123]
    s_nop 7
    v_and_b32 v4, 3, v2
    v_cmp_eq_u32 s[66:67], 1, v4
    v_cmp_eq_u32 s[68:69], 2, v4
    v_cmp_eq_u32 s[70:71], 3, v4
    v_lshrrev_b32 v5, 2, v2
    v_cmp_eq_u32 s[72:73], v5, v3
    s_mov_b32 s46, 986500301
    s_mov_b32 s47, 925353388
    v_cndmask_b32 v37, v40, v41, s[66:67]
    v_cndmask_b32 v37, v37, v42, s[68:69]
    v_cndmask_b32 v37, v37, v43, s[70:71]
    v_mul_f32 v36, s46, v36
    v_mul_f32 v37, s46, v37
    v_fma_f32 v37, -v36, v36, v37
    v_max_f32 v37, 0, v37
    v_cvt_pk_bf16_f32 v4, v36, v36
    v_lshlrev_b32 v4, 16, v4
    v_cvt_pk_bf16_f32 v5, v37, v37
    v_lshlrev_b32 v5, 16, v5
    v_add_f32 v5, s47, v5
    v_cvt_pk_bf16_f32 v5, v5, v5
    v_lshlrev_b32 v5, 16, v5
    v_sqrt_f32 v5, v5
    s_nop 0
    v_cvt_pk_bf16_f32 v5, v5, v5
    v_lshlrev_b32 v5, 16, v5
    v_rcp_f32 v5, v5
    s_nop 0
    v_sub_f32 v6, v36, v4
    v_mul_f32 v6, v6, v5
    v_mul_f32 v7, v37, v5
    v_mul_f32 v7, v7, v5
    v_cvt_pk_bf16_f32 v6, v6, v6
    v_lshlrev_b32 v6, 16, v6
    v_cvt_pk_bf16_f32 v7, v7, v7
    v_lshlrev_b32 v7, 16, v7
    v_add_f32 v7, s47, v7
    v_cvt_pk_bf16_f32 v7, v7, v7
    v_lshlrev_b32 v7, 16, v7
    v_sqrt_f32 v7, v7
    s_nop 0
    v_cvt_pk_bf16_f32 v7, v7, v7
    v_lshlrev_b32 v7, 16, v7
    v_rcp_f32 v7, v7
    v_fma_f32 v6, v4, v5, v6
    v_mul_f32 v36, v5, v7
    v_mul_f32 v37, -v6, v7
    s_lshl_b32 s46, s43, 2
    s_add_u32 s46, s46, s44
    s_lshl_b32 s46, s46, 7
    s_add_u32 s46, s46, 0
    v_lshl_add_u32 v4, v2, 3, s46
    v_lshlrev_b32 v5, 3, v2
    s_barrier
    s_mov_b64 s[48:49], exec
    s_mov_b64 exec, s[72:73]
    ds_write_b64 v4, v[36:37]
    s_mov_b64 exec, s[48:49]
    s_mov_b32 s47, 0
    s_lshl_b32 s46, s43, 2
    s_add_u32 s62, s47, s46
    s_mov_b32 s47, 1
    s_lshl_b32 s46, s43, 2
    s_add_u32 s63, s47, s46
    s_mov_b32 s47, 2
    s_lshl_b32 s46, s43, 2
    s_add_u32 s64, s47, s46
    s_mov_b32 s47, 3
    s_lshl_b32 s46, s43, 2
    s_add_u32 s65, s47, s46
    v_mul_u32_u24 v6, 400, v2
    v_lshl_add_u32 v6, v3, 3, v6
    s_mul_i32 s49, s44, 96
    v_add_u32 v6, s49, v6
    s_mul_i32 s48, s62, 6400
    v_add_u32 v164, s48, v6
    s_mul_i32 s48, s63, 6400
    v_add_u32 v165, s48, v6
    s_mul_i32 s48, s64, 6400
    v_add_u32 v166, s48, v6
    s_mul_i32 s48, s65, 6400
    v_add_u32 v167, s48, v6
    s_waitcnt lgkmcnt(0)
    s_barrier
    s_lshl_b32 s47, s62, 7
    v_add_u32 v4, s47, v5
    ds_read_b64 v[124:125], v4 offset:0
    s_lshl_b32 s47, s63, 7
    v_add_u32 v4, s47, v5
    ds_read_b64 v[126:127], v4 offset:0
    s_lshl_b32 s47, s64, 7
    v_add_u32 v4, s47, v5
    ds_read_b64 v[128:129], v4 offset:0
    s_lshl_b32 s47, s65, 7
    v_add_u32 v4, s47, v5
    ds_read_b64 v[130:131], v4 offset:0
    s_mov_b32 s46, 3222493025
    s_mov_b32 s47, 3184710632
    v_mov_b32 v11, s46
    v_lshlrev_b32 v136, 16, v56
    v_and_b32 v137, 0xffff0000, v56
    v_lshlrev_b32 v138, 16, v57
    v_and_b32 v139, 0xffff0000, v57
    s_lshl_b32 s48, s56, 5
    s_add_u32 s48, s48, s42
    s_add_u32 s66, s48, 1280
    v_lshlrev_b32 v140, 16, v58
    v_and_b32 v141, 0xffff0000, v58
    v_lshlrev_b32 v142, 16, v59
    v_and_b32 v143, 0xffff0000, v59
    s_lshl_b32 s48, s57, 5
    s_add_u32 s48, s48, s42
    s_add_u32 s67, s48, 1280
    v_lshlrev_b32 v144, 16, v60
    v_and_b32 v145, 0xffff0000, v60
    v_lshlrev_b32 v146, 16, v61
    v_and_b32 v147, 0xffff0000, v61
    s_lshl_b32 s48, s58, 5
    s_add_u32 s48, s48, s42
    s_add_u32 s68, s48, 1280
    s_waitcnt lgkmcnt(0)
    s_movk_i32 s51, 4352
    v_add_u32 v8, 0, v0
    v_mul_u32_u24 v9, 2731, v8
    v_lshrrev_b32 v9, 16, v9
    v_mul_u32_u24 v10, 24, v9
    v_sub_u32 v10, v8, v10
    v_lshrrev_b32 v17, 4, v9
    v_and_b32 v9, 15, v9
    v_lshl_add_u32 v9, v17, 6, v9
    v_mul_u32_u24 v17, 400, v9
    v_lshl_add_u32 v17, v10, 4, v17
    v_add_u32 v9, s40, v9
    v_mul_lo_u32 v9, v9, s51
    v_lshl_add_u32 v19, v10, 4, v9
    v_add_u32 v8, 512, v0
    v_mul_u32_u24 v9, 2731, v8
    v_lshrrev_b32 v9, 16, v9
    v_mul_u32_u24 v10, 24, v9
    v_sub_u32 v10, v8, v10
    v_lshrrev_b32 v18, 4, v9
    v_and_b32 v9, 15, v9
    v_lshl_add_u32 v9, v18, 6, v9
    v_mul_u32_u24 v18, 400, v9
    v_lshl_add_u32 v18, v10, 4, v18
    v_add_u32 v9, s40, v9
    v_mul_lo_u32 v9, v9, s51
    v_lshl_add_u32 v20, v10, 4, v9
    v_mov_b32 v9, 2146435072
    v_cmp_gt_u32 vcc, 0x100, v0
    s_add_u32 s66, s42, 1280
    s_nop 0
    v_cndmask_b32 v20, v9, v20, vcc
    v_fma_f32 v4, v112, v125, v136
    v_fma_f32 v5, v113, v125, v137
    v_fma_f32 v6, v114, v125, v138
    v_fma_f32 v7, v115, v125, v139
    v_fma_f32 v64, v64, v124, v4
    v_fma_f32 v65, v65, v124, v5
    v_fma_f32 v66, v66, v124, v6
    v_fma_f32 v67, v67, v124, v7
    v_mul_f32 v4, v64, v64
    v_mul_f32 v5, v65, v65
    v_mul_f32 v6, v66, v66
    v_mul_f32 v7, v67, v67
    v_fma_f32 v4, v4, s47, v11
    v_fma_f32 v5, v5, s47, v11
    v_fma_f32 v6, v6, s47, v11
    v_fma_f32 v7, v7, s47, v11
    v_mul_f32 v4, v4, v64
    v_mul_f32 v5, v5, v65
    v_mul_f32 v6, v6, v66
    v_mul_f32 v7, v7, v67
    v_exp_f32 v4, v4
    v_exp_f32 v5, v5
    v_exp_f32 v6, v6
    v_exp_f32 v7, v7
    v_add_f32 v4, 1.0, v4
    v_add_f32 v5, 1.0, v5
    v_add_f32 v6, 1.0, v6
    v_add_f32 v7, 1.0, v7
    v_rcp_f32 v4, v4
    v_rcp_f32 v5, v5
    v_rcp_f32 v6, v6
    v_rcp_f32 v7, v7
    v_mul_f32 v64, v64, v4
    v_mul_f32 v65, v65, v5
    v_mul_f32 v66, v66, v6
    v_mul_f32 v67, v67, v7
    v_cvt_pk_bf16_f32 v64, v64, v65
    v_cvt_pk_bf16_f32 v65, v66, v67
    ds_write_b64 v164, v[64:65] offset:4096
    v_fma_f32 v4, v116, v125, v140
    v_fma_f32 v5, v117, v125, v141
    v_fma_f32 v6, v118, v125, v142
    v_fma_f32 v7, v119, v125, v143
    v_fma_f32 v80, v80, v124, v4
    v_fma_f32 v81, v81, v124, v5
    v_fma_f32 v82, v82, v124, v6
    v_fma_f32 v83, v83, v124, v7
    v_mul_f32 v4, v80, v80
    v_mul_f32 v5, v81, v81
    v_mul_f32 v6, v82, v82
    v_mul_f32 v7, v83, v83
    v_fma_f32 v4, v4, s47, v11
    v_fma_f32 v5, v5, s47, v11
    v_fma_f32 v6, v6, s47, v11
    v_fma_f32 v7, v7, s47, v11
    v_mul_f32 v4, v4, v80
    v_mul_f32 v5, v5, v81
    v_mul_f32 v6, v6, v82
    v_mul_f32 v7, v7, v83
    v_exp_f32 v4, v4
    v_exp_f32 v5, v5
    v_exp_f32 v6, v6
    v_exp_f32 v7, v7
    v_add_f32 v4, 1.0, v4
    v_add_f32 v5, 1.0, v5
    v_add_f32 v6, 1.0, v6
    v_add_f32 v7, 1.0, v7
    v_rcp_f32 v4, v4
    v_rcp_f32 v5, v5
    v_rcp_f32 v6, v6
    v_rcp_f32 v7, v7
    v_mul_f32 v80, v80, v4
    v_mul_f32 v81, v81, v5
    v_mul_f32 v82, v82, v6
    v_mul_f32 v83, v83, v7
    v_cvt_pk_bf16_f32 v80, v80, v81
    v_cvt_pk_bf16_f32 v81, v82, v83
    ds_write_b64 v164, v[80:81] offset:4128
    v_fma_f32 v4, v120, v125, v144
    v_fma_f32 v5, v121, v125, v145
    v_fma_f32 v6, v122, v125, v146
    v_fma_f32 v7, v123, v125, v147
    v_fma_f32 v96, v96, v124, v4
    v_fma_f32 v97, v97, v124, v5
    v_fma_f32 v98, v98, v124, v6
    v_fma_f32 v99, v99, v124, v7
    v_mul_f32 v4, v96, v96
    v_mul_f32 v5, v97, v97
    v_mul_f32 v6, v98, v98
    v_mul_f32 v7, v99, v99
    v_fma_f32 v4, v4, s47, v11
    v_fma_f32 v5, v5, s47, v11
    v_fma_f32 v6, v6, s47, v11
    v_fma_f32 v7, v7, s47, v11
    v_mul_f32 v4, v4, v96
    v_mul_f32 v5, v5, v97
    v_mul_f32 v6, v6, v98
    v_mul_f32 v7, v7, v99
    v_exp_f32 v4, v4
    v_exp_f32 v5, v5
    v_exp_f32 v6, v6
    v_exp_f32 v7, v7
    v_add_f32 v4, 1.0, v4
    v_add_f32 v5, 1.0, v5
    v_add_f32 v6, 1.0, v6
    v_add_f32 v7, 1.0, v7
    v_rcp_f32 v4, v4
    v_rcp_f32 v5, v5
    v_rcp_f32 v6, v6
    v_rcp_f32 v7, v7
    v_mul_f32 v96, v96, v4
    v_mul_f32 v97, v97, v5
    v_mul_f32 v98, v98, v6
    v_mul_f32 v99, v99, v7
    v_cvt_pk_bf16_f32 v96, v96, v97
    v_cvt_pk_bf16_f32 v97, v98, v99
    ds_write_b64 v164, v[96:97] offset:4160
    s_waitcnt lgkmcnt(0)
    s_barrier
    ds_read_b128 v[172:175], v17 offset:4096
    ds_read_b128 v[176:179], v18 offset:4096
    v_fma_f32 v4, v112, v127, v136
    v_fma_f32 v5, v113, v127, v137
    v_fma_f32 v6, v114, v127, v138
    v_fma_f32 v7, v115, v127, v139
    v_fma_f32 v68, v68, v126, v4
    v_fma_f32 v69, v69, v126, v5
    v_fma_f32 v70, v70, v126, v6
    v_fma_f32 v71, v71, v126, v7
    v_mul_f32 v4, v68, v68
    v_mul_f32 v5, v69, v69
    v_mul_f32 v6, v70, v70
    v_mul_f32 v7, v71, v71
    v_fma_f32 v4, v4, s47, v11
    v_fma_f32 v5, v5, s47, v11
    v_fma_f32 v6, v6, s47, v11
    v_fma_f32 v7, v7, s47, v11
    v_mul_f32 v4, v4, v68
    v_mul_f32 v5, v5, v69
    v_mul_f32 v6, v6, v70
    v_mul_f32 v7, v7, v71
    v_exp_f32 v4, v4
    v_exp_f32 v5, v5
    v_exp_f32 v6, v6
    v_exp_f32 v7, v7
    v_add_f32 v4, 1.0, v4
    v_add_f32 v5, 1.0, v5
    v_add_f32 v6, 1.0, v6
    v_add_f32 v7, 1.0, v7
    v_rcp_f32 v4, v4
    v_rcp_f32 v5, v5
    v_rcp_f32 v6, v6
    v_rcp_f32 v7, v7
    v_mul_f32 v68, v68, v4
    v_mul_f32 v69, v69, v5
    v_mul_f32 v70, v70, v6
    v_mul_f32 v71, v71, v7
    v_cvt_pk_bf16_f32 v68, v68, v69
    v_cvt_pk_bf16_f32 v69, v70, v71
    s_waitcnt lgkmcnt(0)
    s_add_u32 s67, s66, 0
    buffer_store_dwordx4 v[172:175], v19, s[20:23], s67 offen sc1
    buffer_store_dwordx4 v[176:179], v20, s[20:23], s67 offen sc1
    ds_write_b64 v165, v[68:69] offset:4096
    v_fma_f32 v4, v116, v127, v140
    v_fma_f32 v5, v117, v127, v141
    v_fma_f32 v6, v118, v127, v142
    v_fma_f32 v7, v119, v127, v143
    v_fma_f32 v84, v84, v126, v4
    v_fma_f32 v85, v85, v126, v5
    v_fma_f32 v86, v86, v126, v6
    v_fma_f32 v87, v87, v126, v7
    v_mul_f32 v4, v84, v84
    v_mul_f32 v5, v85, v85
    v_mul_f32 v6, v86, v86
    v_mul_f32 v7, v87, v87
    v_fma_f32 v4, v4, s47, v11
    v_fma_f32 v5, v5, s47, v11
    v_fma_f32 v6, v6, s47, v11
    v_fma_f32 v7, v7, s47, v11
    v_mul_f32 v4, v4, v84
    v_mul_f32 v5, v5, v85
    v_mul_f32 v6, v6, v86
    v_mul_f32 v7, v7, v87
    v_exp_f32 v4, v4
    v_exp_f32 v5, v5
    v_exp_f32 v6, v6
    v_exp_f32 v7, v7
    v_add_f32 v4, 1.0, v4
    v_add_f32 v5, 1.0, v5
    v_add_f32 v6, 1.0, v6
    v_add_f32 v7, 1.0, v7
    v_rcp_f32 v4, v4
    v_rcp_f32 v5, v5
    v_rcp_f32 v6, v6
    v_rcp_f32 v7, v7
    v_mul_f32 v84, v84, v4
    v_mul_f32 v85, v85, v5
    v_mul_f32 v86, v86, v6
    v_mul_f32 v87, v87, v7
    v_cvt_pk_bf16_f32 v84, v84, v85
    v_cvt_pk_bf16_f32 v85, v86, v87
    ds_write_b64 v165, v[84:85] offset:4128
    v_fma_f32 v4, v120, v127, v144
    v_fma_f32 v5, v121, v127, v145
    v_fma_f32 v6, v122, v127, v146
    v_fma_f32 v7, v123, v127, v147
    v_fma_f32 v100, v100, v126, v4
    v_fma_f32 v101, v101, v126, v5
    v_fma_f32 v102, v102, v126, v6
    v_fma_f32 v103, v103, v126, v7
    v_mul_f32 v4, v100, v100
    v_mul_f32 v5, v101, v101
    v_mul_f32 v6, v102, v102
    v_mul_f32 v7, v103, v103
    v_fma_f32 v4, v4, s47, v11
    v_fma_f32 v5, v5, s47, v11
    v_fma_f32 v6, v6, s47, v11
    v_fma_f32 v7, v7, s47, v11
    v_mul_f32 v4, v4, v100
    v_mul_f32 v5, v5, v101
    v_mul_f32 v6, v6, v102
    v_mul_f32 v7, v7, v103
    v_exp_f32 v4, v4
    v_exp_f32 v5, v5
    v_exp_f32 v6, v6
    v_exp_f32 v7, v7
    v_add_f32 v4, 1.0, v4
    v_add_f32 v5, 1.0, v5
    v_add_f32 v6, 1.0, v6
    v_add_f32 v7, 1.0, v7
    v_rcp_f32 v4, v4
    v_rcp_f32 v5, v5
    v_rcp_f32 v6, v6
    v_rcp_f32 v7, v7
    v_mul_f32 v100, v100, v4
    v_mul_f32 v101, v101, v5
    v_mul_f32 v102, v102, v6
    v_mul_f32 v103, v103, v7
    v_cvt_pk_bf16_f32 v100, v100, v101
    v_cvt_pk_bf16_f32 v101, v102, v103
    ds_write_b64 v165, v[100:101] offset:4160
    s_waitcnt lgkmcnt(0)
    s_barrier
    ds_read_b128 v[180:183], v17 offset:10496
    ds_read_b128 v[184:187], v18 offset:10496
    v_fma_f32 v4, v112, v129, v136
    v_fma_f32 v5, v113, v129, v137
    v_fma_f32 v6, v114, v129, v138
    v_fma_f32 v7, v115, v129, v139
    v_fma_f32 v72, v72, v128, v4
    v_fma_f32 v73, v73, v128, v5
    v_fma_f32 v74, v74, v128, v6
    v_fma_f32 v75, v75, v128, v7
    v_mul_f32 v4, v72, v72
    v_mul_f32 v5, v73, v73
    v_mul_f32 v6, v74, v74
    v_mul_f32 v7, v75, v75
    v_fma_f32 v4, v4, s47, v11
    v_fma_f32 v5, v5, s47, v11
    v_fma_f32 v6, v6, s47, v11
    v_fma_f32 v7, v7, s47, v11
    v_mul_f32 v4, v4, v72
    v_mul_f32 v5, v5, v73
    v_mul_f32 v6, v6, v74
    v_mul_f32 v7, v7, v75
    v_exp_f32 v4, v4
    v_exp_f32 v5, v5
    v_exp_f32 v6, v6
    v_exp_f32 v7, v7
    v_add_f32 v4, 1.0, v4
    v_add_f32 v5, 1.0, v5
    v_add_f32 v6, 1.0, v6
    v_add_f32 v7, 1.0, v7
    v_rcp_f32 v4, v4
    v_rcp_f32 v5, v5
    v_rcp_f32 v6, v6
    v_rcp_f32 v7, v7
    v_mul_f32 v72, v72, v4
    v_mul_f32 v73, v73, v5
    v_mul_f32 v74, v74, v6
    v_mul_f32 v75, v75, v7
    v_cvt_pk_bf16_f32 v72, v72, v73
    v_cvt_pk_bf16_f32 v73, v74, v75
    s_waitcnt lgkmcnt(0)
    s_add_u32 s67, s66, 69632
    buffer_store_dwordx4 v[180:183], v19, s[20:23], s67 offen sc1
    buffer_store_dwordx4 v[184:187], v20, s[20:23], s67 offen sc1
    ds_write_b64 v166, v[72:73] offset:4096
    v_fma_f32 v4, v116, v129, v140
    v_fma_f32 v5, v117, v129, v141
    v_fma_f32 v6, v118, v129, v142
    v_fma_f32 v7, v119, v129, v143
    v_fma_f32 v88, v88, v128, v4
    v_fma_f32 v89, v89, v128, v5
    v_fma_f32 v90, v90, v128, v6
    v_fma_f32 v91, v91, v128, v7
    v_mul_f32 v4, v88, v88
    v_mul_f32 v5, v89, v89
    v_mul_f32 v6, v90, v90
    v_mul_f32 v7, v91, v91
    v_fma_f32 v4, v4, s47, v11
    v_fma_f32 v5, v5, s47, v11
    v_fma_f32 v6, v6, s47, v11
    v_fma_f32 v7, v7, s47, v11
    v_mul_f32 v4, v4, v88
    v_mul_f32 v5, v5, v89
    v_mul_f32 v6, v6, v90
    v_mul_f32 v7, v7, v91
    v_exp_f32 v4, v4
    v_exp_f32 v5, v5
    v_exp_f32 v6, v6
    v_exp_f32 v7, v7
    v_add_f32 v4, 1.0, v4
    v_add_f32 v5, 1.0, v5
    v_add_f32 v6, 1.0, v6
    v_add_f32 v7, 1.0, v7
    v_rcp_f32 v4, v4
    v_rcp_f32 v5, v5
    v_rcp_f32 v6, v6
    v_rcp_f32 v7, v7
    v_mul_f32 v88, v88, v4
    v_mul_f32 v89, v89, v5
    v_mul_f32 v90, v90, v6
    v_mul_f32 v91, v91, v7
    v_cvt_pk_bf16_f32 v88, v88, v89
    v_cvt_pk_bf16_f32 v89, v90, v91
    ds_write_b64 v166, v[88:89] offset:4128
    v_fma_f32 v4, v120, v129, v144
    v_fma_f32 v5, v121, v129, v145
    v_fma_f32 v6, v122, v129, v146
    v_fma_f32 v7, v123, v129, v147
    v_fma_f32 v104, v104, v128, v4
    v_fma_f32 v105, v105, v128, v5
    v_fma_f32 v106, v106, v128, v6
    v_fma_f32 v107, v107, v128, v7
    v_mul_f32 v4, v104, v104
    v_mul_f32 v5, v105, v105
    v_mul_f32 v6, v106, v106
    v_mul_f32 v7, v107, v107
    v_fma_f32 v4, v4, s47, v11
    v_fma_f32 v5, v5, s47, v11
    v_fma_f32 v6, v6, s47, v11
    v_fma_f32 v7, v7, s47, v11
    v_mul_f32 v4, v4, v104
    v_mul_f32 v5, v5, v105
    v_mul_f32 v6, v6, v106
    v_mul_f32 v7, v7, v107
    v_exp_f32 v4, v4
    v_exp_f32 v5, v5
    v_exp_f32 v6, v6
    v_exp_f32 v7, v7
    v_add_f32 v4, 1.0, v4
    v_add_f32 v5, 1.0, v5
    v_add_f32 v6, 1.0, v6
    v_add_f32 v7, 1.0, v7
    v_rcp_f32 v4, v4
    v_rcp_f32 v5, v5
    v_rcp_f32 v6, v6
    v_rcp_f32 v7, v7
    v_mul_f32 v104, v104, v4
    v_mul_f32 v105, v105, v5
    v_mul_f32 v106, v106, v6
    v_mul_f32 v107, v107, v7
    v_cvt_pk_bf16_f32 v104, v104, v105
    v_cvt_pk_bf16_f32 v105, v106, v107
    ds_write_b64 v166, v[104:105] offset:4160
    s_waitcnt lgkmcnt(0)
    s_barrier
    ds_read_b128 v[172:175], v17 offset:16896
    ds_read_b128 v[176:179], v18 offset:16896
    v_fma_f32 v4, v112, v131, v136
    v_fma_f32 v5, v113, v131, v137
    v_fma_f32 v6, v114, v131, v138
    v_fma_f32 v7, v115, v131, v139
    v_fma_f32 v76, v76, v130, v4
    v_fma_f32 v77, v77, v130, v5
    v_fma_f32 v78, v78, v130, v6
    v_fma_f32 v79, v79, v130, v7
    v_mul_f32 v4, v76, v76
    v_mul_f32 v5, v77, v77
    v_mul_f32 v6, v78, v78
    v_mul_f32 v7, v79, v79
    v_fma_f32 v4, v4, s47, v11
    v_fma_f32 v5, v5, s47, v11
    v_fma_f32 v6, v6, s47, v11
    v_fma_f32 v7, v7, s47, v11
    v_mul_f32 v4, v4, v76
    v_mul_f32 v5, v5, v77
    v_mul_f32 v6, v6, v78
    v_mul_f32 v7, v7, v79
    v_exp_f32 v4, v4
    v_exp_f32 v5, v5
    v_exp_f32 v6, v6
    v_exp_f32 v7, v7
    v_add_f32 v4, 1.0, v4
    v_add_f32 v5, 1.0, v5
    v_add_f32 v6, 1.0, v6
    v_add_f32 v7, 1.0, v7
    v_rcp_f32 v4, v4
    v_rcp_f32 v5, v5
    v_rcp_f32 v6, v6
    v_rcp_f32 v7, v7
    v_mul_f32 v76, v76, v4
    v_mul_f32 v77, v77, v5
    v_mul_f32 v78, v78, v6
    v_mul_f32 v79, v79, v7
    v_cvt_pk_bf16_f32 v76, v76, v77
    v_cvt_pk_bf16_f32 v77, v78, v79
    s_waitcnt lgkmcnt(0)
    s_add_u32 s67, s66, 139264
    buffer_store_dwordx4 v[172:175], v19, s[20:23], s67 offen sc1
    buffer_store_dwordx4 v[176:179], v20, s[20:23], s67 offen sc1
    ds_write_b64 v167, v[76:77] offset:4096
    v_fma_f32 v4, v116, v131, v140
    v_fma_f32 v5, v117, v131, v141
    v_fma_f32 v6, v118, v131, v142
    v_fma_f32 v7, v119, v131, v143
    v_fma_f32 v92, v92, v130, v4
    v_fma_f32 v93, v93, v130, v5
    v_fma_f32 v94, v94, v130, v6
    v_fma_f32 v95, v95, v130, v7
    v_mul_f32 v4, v92, v92
    v_mul_f32 v5, v93, v93
    v_mul_f32 v6, v94, v94
    v_mul_f32 v7, v95, v95
    v_fma_f32 v4, v4, s47, v11
    v_fma_f32 v5, v5, s47, v11
    v_fma_f32 v6, v6, s47, v11
    v_fma_f32 v7, v7, s47, v11
    v_mul_f32 v4, v4, v92
    v_mul_f32 v5, v5, v93
    v_mul_f32 v6, v6, v94
    v_mul_f32 v7, v7, v95
    v_exp_f32 v4, v4
    v_exp_f32 v5, v5
    v_exp_f32 v6, v6
    v_exp_f32 v7, v7
    v_add_f32 v4, 1.0, v4
    v_add_f32 v5, 1.0, v5
    v_add_f32 v6, 1.0, v6
    v_add_f32 v7, 1.0, v7
    v_rcp_f32 v4, v4
    v_rcp_f32 v5, v5
    v_rcp_f32 v6, v6
    v_rcp_f32 v7, v7
    v_mul_f32 v92, v92, v4
    v_mul_f32 v93, v93, v5
    v_mul_f32 v94, v94, v6
    v_mul_f32 v95, v95, v7
    v_cvt_pk_bf16_f32 v92, v92, v93
    v_cvt_pk_bf16_f32 v93, v94, v95
    ds_write_b64 v167, v[92:93] offset:4128
    v_fma_f32 v4, v120, v131, v144
    v_fma_f32 v5, v121, v131, v145
    v_fma_f32 v6, v122, v131, v146
    v_fma_f32 v7, v123, v131, v147
    v_fma_f32 v108, v108, v130, v4
    v_fma_f32 v109, v109, v130, v5
    v_fma_f32 v110, v110, v130, v6
    v_fma_f32 v111, v111, v130, v7
    v_mul_f32 v4, v108, v108
    v_mul_f32 v5, v109, v109
    v_mul_f32 v6, v110, v110
    v_mul_f32 v7, v111, v111
    v_fma_f32 v4, v4, s47, v11
    v_fma_f32 v5, v5, s47, v11
    v_fma_f32 v6, v6, s47, v11
    v_fma_f32 v7, v7, s47, v11
    v_mul_f32 v4, v4, v108
    v_mul_f32 v5, v5, v109
    v_mul_f32 v6, v6, v110
    v_mul_f32 v7, v7, v111
    v_exp_f32 v4, v4
    v_exp_f32 v5, v5
    v_exp_f32 v6, v6
    v_exp_f32 v7, v7
    v_add_f32 v4, 1.0, v4
    v_add_f32 v5, 1.0, v5
    v_add_f32 v6, 1.0, v6
    v_add_f32 v7, 1.0, v7
    v_rcp_f32 v4, v4
    v_rcp_f32 v5, v5
    v_rcp_f32 v6, v6
    v_rcp_f32 v7, v7
    v_mul_f32 v108, v108, v4
    v_mul_f32 v109, v109, v5
    v_mul_f32 v110, v110, v6
    v_mul_f32 v111, v111, v7
    v_cvt_pk_bf16_f32 v108, v108, v109
    v_cvt_pk_bf16_f32 v109, v110, v111
    ds_write_b64 v167, v[108:109] offset:4160
    s_waitcnt lgkmcnt(0)
    s_barrier
    ds_read_b128 v[180:183], v17 offset:23296
    ds_read_b128 v[184:187], v18 offset:23296
    s_waitcnt lgkmcnt(0)
    s_add_u32 s67, s66, 208896
    buffer_store_dwordx4 v[180:183], v19, s[20:23], s67 offen sc1
    buffer_store_dwordx4 v[184:187], v20, s[20:23], s67 offen sc1
    s_barrier
    s_cmp_lt_u32 s39, 4
    s_cbranch_scc1 P2_34
    s_cmp_eq_u32 s39, 7
    s_cbranch_scc1 W7_35
    s_waitcnt vmcnt(0)
    s_barrier
    s_branch K1_END
W7_35:
    s_load_dwordx4 s[48:51], s[0:1], 72
    s_waitcnt lgkmcnt(0)
    s_mov_b32 s52, s48
    s_and_b32 s53, s49, 0xffff
    s_mov_b32 s54, 256
    s_mov_b32 s55, 0x00020000
    v_mov_b32 v4, 0
    s_mov_b64 exec, 1
    s_mov_b32 s58, 200000
    s_movk_i32 s59, 256
NI_37:
    buffer_load_dword v5, v4, s[52:55], 0 offen sc1
    s_waitcnt vmcnt(0)
    v_cmp_gt_u32 vcc, s59, v5
    s_nop 4
    s_cbranch_vccz ND_38
    s_sleep 8
    s_sub_u32 s58, s58, 1
    s_cmp_lg_u32 s58, 0
    s_cbranch_scc1 NI_37
ND_38:
    s_mov_b64 exec, -1
    s_add_u32 s50, s50, 16777216
    s_addc_u32 s51, s51, 0
    s_mov_b32 s52, s50
    s_and_b32 s53, s51, 0xffff
    s_mov_b32 s54, 32768
    s_mov_b32 s55, 0x00020000
    v_and_b32 v4, 31, v1
    v_mul_u32_u24 v5, 205, v4
    v_lshrrev_b32 v5, 11, v5
    v_mul_u32_u24 v6, 10, v5
    v_sub_u32 v6, v4, v6
    s_lshl_b32 s46, s37, 2
    s_mul_i32 s47, s46, 171
    s_lshr_b32 s47, s47, 9
    s_add_u32 s46, s46, 3
    s_mul_i32 s46, s46, 171
    s_lshr_b32 s46, s46, 9
    s_min_u32 s46, s46, 13
    v_mul_u32_u24 v7, 171, v6
    v_lshrrev_b32 v7, 9, v7
    v_mul_u32_u24 v8, 61, v7
    v_add_u32 v8, v8, v6
    v_subrev_u32 v9, 6, v6
    v_lshrrev_b32 v10, 1, v9
    v_and_b32 v9, 1, v9
    v_lshl_add_u32 v9, v10, 6, v9
    v_add_u32 v9, 3, v9
    v_cmp_gt_u32 s[56:57], 6, v6
    s_nop 1
    v_cndmask_b32 v11, v9, v8, s[56:57]
    v_add_u32 v7, s47, v5
    v_mul_u32_u24 v8, 5, v7
    v_add_u32 v8, v8, v11
    v_lshl_add_u32 v9, v7, 1, v11
    v_add_u32 v9, 33, v9
    v_cmp_gt_u32 s[48:49], 12, v7
    s_nop 1
    v_cndmask_b32 v8, v9, v8, s[48:49]
    s_orn2_b64 s[48:49], s[48:49], s[56:57]
    v_cmp_ge_u32 vcc, s46, v7
    s_and_b64 s[48:49], s[48:49], vcc
    v_cmp_gt_u32 vcc, 30, v4
    s_and_b64 s[48:49], s[48:49], vcc
    v_add_u32 v8, 128, v8
    s_lshl_b32 s46, s37, 1
    s_sub_u32 s46, s46, 18
    v_add_u32 v7, s46, v5
    v_mul_u32_u24 v9, 3, v7
    v_add_u32 v9, v9, v11
    v_mul_u32_u24 v10, 5, v7
    v_add_u32 v10, v10, v11
    v_subrev_u32 v10, 6, v10
    v_cmp_gt_u32 s[50:51], 3, v7
    s_nop 1
    v_cndmask_b32 v9, v10, v9, s[50:51]
    s_orn2_b64 s[50:51], s[56:57], s[50:51]
    v_cmp_gt_u32 vcc, 2, v5
    s_and_b64 s[50:51], s[50:51], vcc
    s_cmp_ge_u32 s37, 9
    s_cselect_b64 s[50:51], s[50:51], 0
    s_mov_b32 s49, s51
    v_cmp_gt_u32 vcc, 32, v1
    s_nop 1
    v_cndmask_b32 v8, v9, v8, vcc
    v_lshlrev_b32 v8, 7, v8
    v_mov_b32 v5, 1
    s_waitcnt vmcnt(0)
    s_barrier
    s_mov_b64 exec, s[48:49]
    buffer_atomic_add v5, v8, s[52:55], 0 offen offset:0
    s_mov_b64 exec, -1
    s_branch K1_END
P2_34:
    s_load_dwordx2 s[4:5], s[0:1], 0
    s_load_dwordx2 s[6:7], s[0:1], 16
    s_load_dwordx2 s[28:29], s[0:1], 48
    s_load_dwordx2 s[30:31], s[0:1], 56
    s_load_dwordx4 s[32:35], s[0:1], 64
    s_load_dwordx2 s[60:61], s[0:1], 80
    s_and_b32 s36, s2, 7
    s_lshl_b32 s36, s36, 4
    s_lshr_b32 s46, s2, 4
    s_add_u32 s36, s36, s46
    s_and_b32 s62, s36, 63
    s_lshr_b32 s63, s36, 6
    s_mul_i32 s46, s62, 205
    s_lshr_b32 s46, s46, 10
    s_mul_i32 s47, s46, 5
    s_sub_u32 s47, s62, s47
    s_sub_u32 s48, s62, 60
    s_lshr_b32 s49, s48, 1
    s_add_u32 s49, s49, 12
    s_and_b32 s48, s48, 1
    s_add_u32 s48, s48, 3
    s_cmp_lt_u32 s62, 60
    s_cselect_b32 s46, s46, s49
    s_cselect_b32 s47, s47, s48
    s_mul_i32 s40, s46, 96
    s_mul_i32 s48, s63, 3
    s_add_u32 s48, s48, s47
    s_lshl_b32 s49, s63, 1
    s_add_u32 s49, s49, s47
    s_add_u32 s49, s49, 3
    s_cmp_lt_u32 s47, 3
    s_cselect_b32 s47, s48, s49
    s_lshl_b32 s42, s47, 7
    s_lshr_b32 s56, s40, 7
    s_add_u32 s57, s40, 95
    s_lshr_b32 s57, s57, 7
    s_sub_u32 s59, s57, s56
    s_lshl_b32 s59, s59, 3
    s_add_u32 s59, s59, 8
    s_add_u32 s56, s36, 128
    s_lshl_b32 s56, s56, 7
    s_and_b32 s43, s39, 1
    s_lshr_b32 s44, s39, 1
    s_lshl_b32 s45, s39, 3
    v_lshrrev_b32 v4, 3, v1
    v_add_u32 v4, s45, v4
    v_and_b32 v5, 7, v1
    v_and_b32 v6, 7, v4
    v_xor_b32 v5, v5, v6
    v_lshlrev_b32 v5, 4, v5
    s_movk_i32 s41, 4352
    v_add_u32 v6, 0, v4
    v_add_u32 v6, s40, v6
    v_mul_lo_u32 v6, v6, s41
    v_add_u32 v8, v6, v5
    v_add_u32 v6, 32, v4
    v_add_u32 v6, s40, v6
    v_mul_lo_u32 v6, v6, s41
    v_add_u32 v9, v6, v5
    v_add_u32 v6, 64, v4
    v_add_u32 v6, s40, v6
    v_mul_lo_u32 v6, v6, s41
    v_add_u32 v10, v6, v5
    v_add_u32 v6, 0, v4
    v_bfe_u32 v5, v6, 1, 2
    v_bfe_u32 v7, v1, 1, 2
    v_xor_b32 v5, v5, v7
    v_and_b32 v7, 1, v1
    v_lshl_or_b32 v5, v5, 1, v7
    v_and_b32 v11, 0xfffffff3, v6
    v_and_b32 v7, 4, v6
    v_lshl_or_b32 v11, v7, 1, v11
    v_and_b32 v7, 8, v6
    v_lshrrev_b32 v7, 1, v7
    v_or_b32 v11, v11, v7
    v_mul_u32_u24 v11, 1280, v11
    v_lshl_add_u32 v11, v5, 4, v11
    v_add_u32 v11, s42, v11
    v_add_u32 v6, 32, v4
    v_bfe_u32 v5, v6, 1, 2
    v_bfe_u32 v7, v1, 1, 2
    v_xor_b32 v5, v5, v7
    v_and_b32 v7, 1, v1
    v_lshl_or_b32 v5, v5, 1, v7
    v_and_b32 v12, 0xfffffff3, v6
    v_and_b32 v7, 4, v6
    v_lshl_or_b32 v12, v7, 1, v12
    v_and_b32 v7, 8, v6
    v_lshrrev_b32 v7, 1, v7
    v_or_b32 v12, v12, v7
    v_mul_u32_u24 v12, 1280, v12
    v_lshl_add_u32 v12, v5, 4, v12
    v_add_u32 v12, s42, v12
    s_mul_i32 s46, s43, 6144
    v_and_b32 v4, 7, v2
    v_lshl_add_u32 v6, v2, 7, s46
    v_add_u32 v5, 0, v3
    v_xor_b32 v5, v5, v4
    v_lshl_add_u32 v13, v5, 4, v6
    v_add_u32 v5, 4, v3
    v_xor_b32 v5, v5, v4
    v_lshl_add_u32 v14, v5, 4, v6
    v_lshrrev_b32 v4, 1, v3
    v_lshlrev_b32 v4, 4, v4
    v_and_b32 v5, 1, v3
    v_lshl_add_u32 v4, v5, 2, v4
    v_bfe_u32 v5, v1, 2, 2
    v_add_u32 v4, v4, v5
    v_bfe_u32 v5, v4, 1, 2
    v_lshlrev_b32 v4, 7, v4
    v_and_b32 v6, 3, v1
    v_lshl_add_u32 v4, v6, 3, v4
    v_add_u32 v4, 12288, v4
    s_lshl_b32 s46, s44, 1
    s_add_u32 s47, s46, 0
    v_xor_b32 v6, s47, v5
    v_lshl_add_u32 v15, v6, 5, v4
    s_add_u32 s47, s46, 1
    v_xor_b32 v6, s47, v5
    v_lshl_add_u32 v16, v6, 5, v4
    s_lshl_b32 s46, s44, 6
    s_add_u32 s46, s46, s42
    v_lshl_add_u32 v24, v3, 3, s46
    s_mul_i32 s47, s43, 48
    s_add_u32 s47, s47, s40
    v_add_u32 v4, s47, v2
    v_mul_u32_u24 v4, 1280, v4
    v_add_u32 v21, v4, v24
    v_add_u32 v4, s47, v2
    v_add_u32 v4, 16, v4
    v_mul_u32_u24 v4, 1280, v4
    v_add_u32 v22, v4, v24
    v_add_u32 v4, s47, v2
    v_add_u32 v4, 32, v4
    v_mul_u32_u24 v4, 1280, v4
    v_add_u32 v23, v4, v24
    v_mov_b32 v44, 0
    v_mov_b32 v45, 0
    v_mov_b32 v46, 0
    v_mov_b32 v47, 0
    v_mov_b32 v48, 0
    v_mov_b32 v49, 0
    v_mov_b32 v50, 0
    v_mov_b32 v51, 0
    v_mov_b32 v52, 0
    v_mov_b32 v53, 0
    v_mov_b32 v54, 0
    v_mov_b32 v55, 0
    v_mov_b32 v56, 0
    v_mov_b32 v57, 0
    v_mov_b32 v58, 0
    v_mov_b32 v59, 0
    v_mov_b32 v60, 0
    v_mov_b32 v61, 0
    v_mov_b32 v62, 0
    v_mov_b32 v63, 0
    v_mov_b32 v64, 0
    v_mov_b32 v65, 0
    v_mov_b32 v66, 0
    v_mov_b32 v67, 0
    s_lshl_b32 s45, s39, 10
    s_waitcnt lgkmcnt(0)
    s_mov_b32 s8, s60
    s_and_b32 s9, s61, 0xffff
    s_mov_b32 s10, 8912896
    s_mov_b32 s11, 0x00020000
    s_mov_b32 s12, s6
    s_and_b32 s13, s7, 0xffff
    s_mov_b32 s14, 819200
    s_mov_b32 s15, 0x00020000
    s_mov_b32 s48, s28
    s_and_b32 s49, s29, 0xffff
    s_mov_b32 s50, 1966080
    s_mov_b32 s51, 0x00020000
    s_mov_b32 s16, s4
    s_and_b32 s17, s5, 0xffff
    s_mov_b32 s18, 2621440
    s_mov_b32 s19, 0x00020000
    s_mov_b32 s20, s32
    s_and_b32 s21, s33, 0xffff
    s_mov_b32 s22, 2621440
    s_mov_b32 s23, 0x00020000
    s_mov_b32 s24, s30
    s_and_b32 s25, s31, 0xffff
    s_mov_b32 s26, 1280
    s_mov_b32 s27, 0x00020000
    s_add_u32 s60, s60, 16777216
    s_addc_u32 s61, s61, 0
    s_mov_b32 s52, s60
    s_and_b32 s53, s61, 0xffff
    s_mov_b32 s54, 32768
    s_mov_b32 s55, 0x00020000
    s_mov_b32 s46, 0
    s_add_u32 m0, s45, 12288
    s_nop 0
    buffer_load_dwordx4 v11, s[48:51], s46 offen lds
    s_add_u32 m0, s45, 16384
    s_nop 0
    buffer_load_dwordx4 v12, s[48:51], s46 offen lds
    s_mov_b32 s46, 81920
    s_add_u32 m0, s45, 32768
    s_nop 0
    buffer_load_dwordx4 v11, s[48:51], s46 offen lds
    s_add_u32 m0, s45, 36864
    s_nop 0
    buffer_load_dwordx4 v12, s[48:51], s46 offen lds
    s_mov_b32 s46, 163840
    s_add_u32 m0, s45, 53248
    s_nop 0
    buffer_load_dwordx4 v11, s[48:51], s46 offen lds
    s_add_u32 m0, s45, 57344
    s_nop 0
    buffer_load_dwordx4 v12, s[48:51], s46 offen lds
    s_mov_b32 s46, 245760
    s_add_u32 m0, s45, 73728
    s_nop 0
    buffer_load_dwordx4 v11, s[48:51], s46 offen lds
    s_add_u32 m0, s45, 77824
    s_nop 0
    buffer_load_dwordx4 v12, s[48:51], s46 offen lds
    buffer_load_dwordx2 v[26:27], v21, s[16:19], 0 offen offset:0
    buffer_load_dwordx2 v[28:29], v21, s[16:19], 0 offen offset:32
    buffer_load_dwordx2 v[30:31], v22, s[16:19], 0 offen offset:0
    buffer_load_dwordx2 v[32:33], v22, s[16:19], 0 offen offset:32
    buffer_load_dwordx2 v[34:35], v23, s[16:19], 0 offen offset:0
    buffer_load_dwordx2 v[36:37], v23, s[16:19], 0 offen offset:32
    buffer_load_dwordx2 v[38:39], v24, s[24:27], 0 offen offset:0
    buffer_load_dwordx2 v[40:41], v24, s[24:27], 0 offen offset:32
    s_waitcnt vmcnt(16)
    s_barrier
    s_cmp_lg_u32 s39, 0
    s_cbranch_scc1 PS_41
    v_mov_b32 v4, s56
    s_mov_b64 exec, 1
    s_mov_b32 s58, 200000
PL_39:
    buffer_load_dword v5, v4, s[52:55], 0 offen offset:0 sc1
    s_waitcnt vmcnt(0)
    v_cmp_gt_u32 vcc, s59, v5
    s_nop 4
    s_cbranch_vccz PD_40
    s_sleep 8
    s_sub_u32 s58, s58, 1
    s_cmp_lg_u32 s58, 0
    s_cbranch_scc1 PL_39
PD_40:
    s_mov_b64 exec, -1
PS_41:
    s_barrier
    s_movk_i32 s46, 1280
    s_add_u32 m0, s45, 0
    s_nop 0
    buffer_load_dwordx4 v8, s[8:11], s46 offen sc1 lds
    s_add_u32 m0, s45, 4096
    s_nop 0
    buffer_load_dwordx4 v9, s[8:11], s46 offen sc1 lds
    s_add_u32 m0, s45, 8192
    s_nop 0
    buffer_load_dwordx4 v10, s[8:11], s46 offen sc1 lds
    s_movk_i32 s46, 1408
    s_add_u32 m0, s45, 20480
    s_nop 0
    buffer_load_dwordx4 v8, s[8:11], s46 offen sc1 lds
    s_add_u32 m0, s45, 24576
    s_nop 0
    buffer_load_dwordx4 v9, s[8:11], s46 offen sc1 lds
    s_add_u32 m0, s45, 28672
    s_nop 0
    buffer_load_dwordx4 v10, s[8:11], s46 offen sc1 lds
    s_movk_i32 s46, 1536
    s_add_u32 m0, s45, 40960
    s_nop 0
    buffer_load_dwordx4 v8, s[8:11], s46 offen sc1 lds
    s_add_u32 m0, s45, 45056
    s_nop 0
    buffer_load_dwordx4 v9, s[8:11], s46 offen sc1 lds
    s_add_u32 m0, s45, 49152
    s_nop 0
    buffer_load_dwordx4 v10, s[8:11], s46 offen sc1 lds
    s_movk_i32 s46, 1664
    s_add_u32 m0, s45, 61440
    s_nop 0
    buffer_load_dwordx4 v8, s[8:11], s46 offen sc1 lds
    s_add_u32 m0, s45, 65536
    s_nop 0
    buffer_load_dwordx4 v9, s[8:11], s46 offen sc1 lds
    s_add_u32 m0, s45, 69632
    s_nop 0
    buffer_load_dwordx4 v10, s[8:11], s46 offen sc1 lds
    s_waitcnt vmcnt(9)
    s_barrier
    v_add_u32 v17, 0, v13
    v_add_u32 v19, 0, v15
    v_add_u32 v18, 0, v14
    v_add_u32 v20, 0, v16
    ds_read_b64_tr_b16 v[116:117], v19 offset:0
    ds_read_b64_tr_b16 v[118:119], v19 offset:1024
    ds_read_b64_tr_b16 v[120:121], v20 offset:0
    ds_read_b64_tr_b16 v[122:123], v20 offset:1024
    ds_read_b128 v[68:71], v17 offset:0
    ds_read_b128 v[72:75], v17 offset:2048
    ds_read_b128 v[76:79], v17 offset:4096
    ds_read_b64_tr_b16 v[124:125], v19 offset:4096
    ds_read_b64_tr_b16 v[126:127], v19 offset:5120
    ds_read_b64_tr_b16 v[128:129], v20 offset:4096
    ds_read_b64_tr_b16 v[130:131], v20 offset:5120
    ds_read_b128 v[80:83], v18 offset:0
    ds_read_b128 v[84:87], v18 offset:2048
    ds_read_b128 v[88:91], v18 offset:4096
    s_waitcnt vmcnt(6) lgkmcnt(0)
    s_barrier
    v_mfma_f32_16x16x32_bf16 v[44:47], v[116:119], v[68:71], v[44:47]
    v_add_u32 v17, 20480, v13
    v_add_u32 v19, 20480, v15
    v_add_u32 v18, 20480, v14
    v_add_u32 v20, 20480, v16
    ds_read_b64_tr_b16 v[132:133], v19 offset:0
    ds_read_b64_tr_b16 v[134:135], v19 offset:1024
    v_mfma_f32_16x16x32_bf16 v[48:51], v[116:119], v[72:75], v[48:51]
    ds_read_b64_tr_b16 v[136:137], v20 offset:0
    ds_read_b64_tr_b16 v[138:139], v20 offset:1024
    ds_read_b128 v[92:95], v17 offset:0
    ds_read_b128 v[96:99], v17 offset:2048
    ds_read_b128 v[100:103], v17 offset:4096
    ds_read_b64_tr_b16 v[140:141], v19 offset:4096
    v_mfma_f32_16x16x32_bf16 v[52:55], v[116:119], v[76:79], v[52:55]
    ds_read_b64_tr_b16 v[142:143], v19 offset:5120
    ds_read_b64_tr_b16 v[144:145], v20 offset:4096
    ds_read_b64_tr_b16 v[146:147], v20 offset:5120
    ds_read_b128 v[104:107], v18 offset:0
    ds_read_b128 v[108:111], v18 offset:2048
    ds_read_b128 v[112:115], v18 offset:4096
    v_mfma_f32_16x16x32_bf16 v[56:59], v[120:123], v[68:71], v[56:59]
    s_movk_i32 s46, 1792
    s_add_u32 m0, s45, 81920
    s_nop 0
    buffer_load_dwordx4 v8, s[8:11], s46 offen sc1 lds
    s_add_u32 m0, s45, 86016
    v_mfma_f32_16x16x32_bf16 v[60:63], v[120:123], v[72:75], v[60:63]
    s_nop 0
    buffer_load_dwordx4 v9, s[8:11], s46 offen sc1 lds
    s_add_u32 m0, s45, 90112
    s_nop 0
    buffer_load_dwordx4 v10, s[8:11], s46 offen sc1 lds
    s_mov_b32 s46, 327680
    v_mfma_f32_16x16x32_bf16 v[64:67], v[120:123], v[76:79], v[64:67]
    s_add_u32 m0, s45, 94208
    s_nop 0
    buffer_load_dwordx4 v11, s[48:51], s46 offen lds
    s_add_u32 m0, s45, 98304
    s_nop 0
    buffer_load_dwordx4 v12, s[48:51], s46 offen lds
    v_mfma_f32_16x16x32_bf16 v[44:47], v[124:127], v[80:83], v[44:47]
    s_movk_i32 s46, 1920
    s_add_u32 m0, s45, 102400
    s_nop 0
    buffer_load_dwordx4 v8, s[8:11], s46 offen sc1 lds
    s_add_u32 m0, s45, 106496
    s_nop 0
    v_mfma_f32_16x16x32_bf16 v[48:51], v[124:127], v[84:87], v[48:51]
    buffer_load_dwordx4 v9, s[8:11], s46 offen sc1 lds
    s_add_u32 m0, s45, 110592
    s_nop 0
    buffer_load_dwordx4 v10, s[8:11], s46 offen sc1 lds
    s_mov_b32 s46, 409600
    v_mfma_f32_16x16x32_bf16 v[52:55], v[124:127], v[88:91], v[52:55]
    s_add_u32 m0, s45, 114688
    s_nop 0
    buffer_load_dwordx4 v11, s[48:51], s46 offen lds
    s_add_u32 m0, s45, 118784
    s_nop 0
    buffer_load_dwordx4 v12, s[48:51], s46 offen lds
    v_mfma_f32_16x16x32_bf16 v[56:59], v[128:131], v[80:83], v[56:59]
    s_movk_i32 s46, 2048
    s_add_u32 m0, s45, 122880
    s_nop 0
    buffer_load_dwordx4 v8, s[8:11], s46 offen sc1 lds
    s_add_u32 m0, s45, 126976
    s_nop 0
    v_mfma_f32_16x16x32_bf16 v[60:63], v[128:131], v[84:87], v[60:63]
    buffer_load_dwordx4 v9, s[8:11], s46 offen sc1 lds
    s_add_u32 m0, s45, 131072
    s_nop 0
    buffer_load_dwordx4 v10, s[8:11], s46 offen sc1 lds
    s_mov_b32 s46, 491520
    s_add_u32 m0, s45, 135168
    v_mfma_f32_16x16x32_bf16 v[64:67], v[128:131], v[88:91], v[64:67]
    s_nop 0
    buffer_load_dwordx4 v11, s[48:51], s46 offen lds
    s_add_u32 m0, s45, 139264
    s_nop 0
    buffer_load_dwordx4 v12, s[48:51], s46 offen lds
    s_waitcnt vmcnt(18) lgkmcnt(0)
    s_barrier
    v_mfma_f32_16x16x32_bf16 v[44:47], v[132:135], v[92:95], v[44:47]
    v_add_u32 v17, 40960, v13
    v_add_u32 v19, 40960, v15
    v_add_u32 v18, 40960, v14
    v_mfma_f32_16x16x32_bf16 v[48:51], v[132:135], v[96:99], v[48:51]
    v_add_u32 v20, 40960, v16
    ds_read_b64_tr_b16 v[116:117], v19 offset:0
    ds_read_b64_tr_b16 v[118:119], v19 offset:1024
    v_mfma_f32_16x16x32_bf16 v[52:55], v[132:135], v[100:103], v[52:55]
    ds_read_b64_tr_b16 v[120:121], v20 offset:0
    ds_read_b64_tr_b16 v[122:123], v20 offset:1024
    ds_read_b128 v[68:71], v17 offset:0
    v_mfma_f32_16x16x32_bf16 v[56:59], v[136:139], v[92:95], v[56:59]
    ds_read_b128 v[72:75], v17 offset:2048
    ds_read_b128 v[76:79], v17 offset:4096
    ds_read_b64_tr_b16 v[124:125], v19 offset:4096
    v_mfma_f32_16x16x32_bf16 v[60:63], v[136:139], v[96:99], v[60:63]
    ds_read_b64_tr_b16 v[126:127], v19 offset:5120
    ds_read_b64_tr_b16 v[128:129], v20 offset:4096
    ds_read_b64_tr_b16 v[130:131], v20 offset:5120
    v_mfma_f32_16x16x32_bf16 v[64:67], v[136:139], v[100:103], v[64:67]
    ds_read_b128 v[80:83], v18 offset:0
    ds_read_b128 v[84:87], v18 offset:2048
    ds_read_b128 v[88:91], v18 offset:4096
    v_mfma_f32_16x16x32_bf16 v[44:47], v[140:143], v[104:107], v[44:47]
    s_movk_i32 s46, 2176
    s_add_u32 m0, s45, 0
    s_nop 0
    v_mfma_f32_16x16x32_bf16 v[48:51], v[140:143], v[108:111], v[48:51]
    buffer_load_dwordx4 v8, s[8:11], s46 offen sc1 lds
    s_add_u32 m0, s45, 4096
    s_nop 0
    v_mfma_f32_16x16x32_bf16 v[52:55], v[140:143], v[112:115], v[52:55]
    buffer_load_dwordx4 v9, s[8:11], s46 offen sc1 lds
    s_add_u32 m0, s45, 8192
    s_nop 0
    v_mfma_f32_16x16x32_bf16 v[56:59], v[144:147], v[104:107], v[56:59]
    buffer_load_dwordx4 v10, s[8:11], s46 offen sc1 lds
    s_mov_b32 s46, 573440
    s_add_u32 m0, s45, 12288
    v_mfma_f32_16x16x32_bf16 v[60:63], v[144:147], v[108:111], v[60:63]
    s_nop 0
    buffer_load_dwordx4 v11, s[48:51], s46 offen lds
    s_add_u32 m0, s45, 16384
    v_mfma_f32_16x16x32_bf16 v[64:67], v[144:147], v[112:115], v[64:67]
    s_nop 0
    buffer_load_dwordx4 v12, s[48:51], s46 offen lds
    s_waitcnt vmcnt(20) lgkmcnt(0)
    s_barrier
    v_mfma_f32_16x16x32_bf16 v[44:47], v[116:119], v[68:71], v[44:47]
    v_add_u32 v17, 61440, v13
    v_add_u32 v19, 61440, v15
    v_add_u32 v18, 61440, v14
    v_mfma_f32_16x16x32_bf16 v[48:51], v[116:119], v[72:75], v[48:51]
    v_add_u32 v20, 61440, v16
    ds_read_b64_tr_b16 v[132:133], v19 offset:0
    ds_read_b64_tr_b16 v[134:135], v19 offset:1024
    v_mfma_f32_16x16x32_bf16 v[52:55], v[116:119], v[76:79], v[52:55]
    ds_read_b64_tr_b16 v[136:137], v20 offset:0
    ds_read_b64_tr_b16 v[138:139], v20 offset:1024
    ds_read_b128 v[92:95], v17 offset:0
    v_mfma_f32_16x16x32_bf16 v[56:59], v[120:123], v[68:71], v[56:59]
    ds_read_b128 v[96:99], v17 offset:2048
    ds_read_b128 v[100:103], v17 offset:4096
    ds_read_b64_tr_b16 v[140:141], v19 offset:4096
    v_mfma_f32_16x16x32_bf16 v[60:63], v[120:123], v[72:75], v[60:63]
    ds_read_b64_tr_b16 v[142:143], v19 offset:5120
    ds_read_b64_tr_b16 v[144:145], v20 offset:4096
    ds_read_b64_tr_b16 v[146:147], v20 offset:5120
    v_mfma_f32_16x16x32_bf16 v[64:67], v[120:123], v[76:79], v[64:67]
    ds_read_b128 v[104:107], v18 offset:0
    ds_read_b128 v[108:111], v18 offset:2048
    ds_read_b128 v[112:115], v18 offset:4096
    v_mfma_f32_16x16x32_bf16 v[44:47], v[124:127], v[80:83], v[44:47]
    s_movk_i32 s46, 2304
    s_add_u32 m0, s45, 20480
    s_nop 0
    v_mfma_f32_16x16x32_bf16 v[48:51], v[124:127], v[84:87], v[48:51]
    buffer_load_dwordx4 v8, s[8:11], s46 offen sc1 lds
    s_add_u32 m0, s45, 24576
    s_nop 0
    v_mfma_f32_16x16x32_bf16 v[52:55], v[124:127], v[88:91], v[52:55]
    buffer_load_dwordx4 v9, s[8:11], s46 offen sc1 lds
    s_add_u32 m0, s45, 28672
    s_nop 0
    v_mfma_f32_16x16x32_bf16 v[56:59], v[128:131], v[80:83], v[56:59]
    buffer_load_dwordx4 v10, s[8:11], s46 offen sc1 lds
    s_mov_b32 s46, 655360
    s_add_u32 m0, s45, 32768
    v_mfma_f32_16x16x32_bf16 v[60:63], v[128:131], v[84:87], v[60:63]
    s_nop 0
    buffer_load_dwordx4 v11, s[48:51], s46 offen lds
    s_add_u32 m0, s45, 36864
    v_mfma_f32_16x16x32_bf16 v[64:67], v[128:131], v[88:91], v[64:67]
    s_nop 0
    buffer_load_dwordx4 v12, s[48:51], s46 offen lds
    s_waitcnt vmcnt(20) lgkmcnt(0)
    s_barrier
    v_mfma_f32_16x16x32_bf16 v[44:47], v[132:135], v[92:95], v[44:47]
    v_add_u32 v17, 81920, v13
    v_add_u32 v19, 81920, v15
    v_add_u32 v18, 81920, v14
    v_mfma_f32_16x16x32_bf16 v[48:51], v[132:135], v[96:99], v[48:51]
    v_add_u32 v20, 81920, v16
    ds_read_b64_tr_b16 v[116:117], v19 offset:0
    ds_read_b64_tr_b16 v[118:119], v19 offset:1024
    v_mfma_f32_16x16x32_bf16 v[52:55], v[132:135], v[100:103], v[52:55]
    ds_read_b64_tr_b16 v[120:121], v20 offset:0
    ds_read_b64_tr_b16 v[122:123], v20 offset:1024
    ds_read_b128 v[68:71], v17 offset:0
    v_mfma_f32_16x16x32_bf16 v[56:59], v[136:139], v[92:95], v[56:59]
    ds_read_b128 v[72:75], v17 offset:2048
    ds_read_b128 v[76:79], v17 offset:4096
    ds_read_b64_tr_b16 v[124:125], v19 offset:4096
    v_mfma_f32_16x16x32_bf16 v[60:63], v[136:139], v[96:99], v[60:63]
    ds_read_b64_tr_b16 v[126:127], v19 offset:5120
    ds_read_b64_tr_b16 v[128:129], v20 offset:4096
    ds_read_b64_tr_b16 v[130:131], v20 offset:5120
    v_mfma_f32_16x16x32_bf16 v[64:67], v[136:139], v[100:103], v[64:67]
    ds_read_b128 v[80:83], v18 offset:0
    ds_read_b128 v[84:87], v18 offset:2048
    ds_read_b128 v[88:91], v18 offset:4096
    v_mfma_f32_16x16x32_bf16 v[44:47], v[140:143], v[104:107], v[44:47]
    s_movk_i32 s46, 2432
    s_add_u32 m0, s45, 40960
    s_nop 0
    v_mfma_f32_16x16x32_bf16 v[48:51], v[140:143], v[108:111], v[48:51]
    buffer_load_dwordx4 v8, s[8:11], s46 offen sc1 lds
    s_add_u32 m0, s45, 45056
    s_nop 0
    v_mfma_f32_16x16x32_bf16 v[52:55], v[140:143], v[112:115], v[52:55]
    buffer_load_dwordx4 v9, s[8:11], s46 offen sc1 lds
    s_add_u32 m0, s45, 49152
    s_nop 0
    v_mfma_f32_16x16x32_bf16 v[56:59], v[144:147], v[104:107], v[56:59]
    buffer_load_dwordx4 v10, s[8:11], s46 offen sc1 lds
    s_mov_b32 s46, 737280
    s_add_u32 m0, s45, 53248
    v_mfma_f32_16x16x32_bf16 v[60:63], v[144:147], v[108:111], v[60:63]
    s_nop 0
    buffer_load_dwordx4 v11, s[48:51], s46 offen lds
    s_add_u32 m0, s45, 57344
    v_mfma_f32_16x16x32_bf16 v[64:67], v[144:147], v[112:115], v[64:67]
    s_nop 0
    buffer_load_dwordx4 v12, s[48:51], s46 offen lds
    s_waitcnt vmcnt(20) lgkmcnt(0)
    s_barrier
    v_mfma_f32_16x16x32_bf16 v[44:47], v[116:119], v[68:71], v[44:47]
    v_add_u32 v17, 102400, v13
    v_add_u32 v19, 102400, v15
    v_add_u32 v18, 102400, v14
    v_mfma_f32_16x16x32_bf16 v[48:51], v[116:119], v[72:75], v[48:51]
    v_add_u32 v20, 102400, v16
    ds_read_b64_tr_b16 v[132:133], v19 offset:0
    ds_read_b64_tr_b16 v[134:135], v19 offset:1024
    v_mfma_f32_16x16x32_bf16 v[52:55], v[116:119], v[76:79], v[52:55]
    ds_read_b64_tr_b16 v[136:137], v20 offset:0
    ds_read_b64_tr_b16 v[138:139], v20 offset:1024
    ds_read_b128 v[92:95], v17 offset:0
    v_mfma_f32_16x16x32_bf16 v[56:59], v[120:123], v[68:71], v[56:59]
    ds_read_b128 v[96:99], v17 offset:2048
    ds_read_b128 v[100:103], v17 offset:4096
    ds_read_b64_tr_b16 v[140:141], v19 offset:4096
    v_mfma_f32_16x16x32_bf16 v[60:63], v[120:123], v[72:75], v[60:63]
    ds_read_b64_tr_b16 v[142:143], v19 offset:5120
    ds_read_b64_tr_b16 v[144:145], v20 offset:4096
    ds_read_b64_tr_b16 v[146:147], v20 offset:5120
    v_mfma_f32_16x16x32_bf16 v[64:67], v[120:123], v[76:79], v[64:67]
    ds_read_b128 v[104:107], v18 offset:0
    ds_read_b128 v[108:111], v18 offset:2048
    ds_read_b128 v[112:115], v18 offset:4096
    v_mfma_f32_16x16x32_bf16 v[44:47], v[124:127], v[80:83], v[44:47]
    s_movk_i32 s46, 2560
    s_add_u32 m0, s45, 61440
    s_nop 0
    v_mfma_f32_16x16x32_bf16 v[48:51], v[124:127], v[84:87], v[48:51]
    buffer_load_dwordx4 v8, s[8:11], s46 offen sc1 lds
    s_add_u32 m0, s45, 65536
    s_nop 0
    v_mfma_f32_16x16x32_bf16 v[52:55], v[124:127], v[88:91], v[52:55]
    buffer_load_dwordx4 v9, s[8:11], s46 offen sc1 lds
    s_add_u32 m0, s45, 69632
    s_nop 0
    v_mfma_f32_16x16x32_bf16 v[56:59], v[128:131], v[80:83], v[56:59]
    buffer_load_dwordx4 v10, s[8:11], s46 offen sc1 lds
    s_mov_b32 s46, 819200
    s_add_u32 m0, s45, 73728
    v_mfma_f32_16x16x32_bf16 v[60:63], v[128:131], v[84:87], v[60:63]
    s_nop 0
    buffer_load_dwordx4 v11, s[48:51], s46 offen lds
    s_add_u32 m0, s45, 77824
    v_mfma_f32_16x16x32_bf16 v[64:67], v[128:131], v[88:91], v[64:67]
    s_nop 0
    buffer_load_dwordx4 v12, s[48:51], s46 offen lds
    s_waitcnt vmcnt(20) lgkmcnt(0)
    s_barrier
    v_mfma_f32_16x16x32_bf16 v[44:47], v[132:135], v[92:95], v[44:47]
    v_add_u32 v17, 122880, v13
    v_add_u32 v19, 122880, v15
    v_add_u32 v18, 122880, v14
    v_mfma_f32_16x16x32_bf16 v[48:51], v[132:135], v[96:99], v[48:51]
    v_add_u32 v20, 122880, v16
    ds_read_b64_tr_b16 v[116:117], v19 offset:0
    ds_read_b64_tr_b16 v[118:119], v19 offset:1024
    v_mfma_f32_16x16x32_bf16 v[52:55], v[132:135], v[100:103], v[52:55]
    ds_read_b64_tr_b16 v[120:121], v20 offset:0
    ds_read_b64_tr_b16 v[122:123], v20 offset:1024
    ds_read_b128 v[68:71], v17 offset:0
    v_mfma_f32_16x16x32_bf16 v[56:59], v[136:139], v[92:95], v[56:59]
    ds_read_b128 v[72:75], v17 offset:2048
    ds_read_b128 v[76:79], v17 offset:4096
    ds_read_b64_tr_b16 v[124:125], v19 offset:4096
    v_mfma_f32_16x16x32_bf16 v[60:63], v[136:139], v[96:99], v[60:63]
    ds_read_b64_tr_b16 v[126:127], v19 offset:5120
    ds_read_b64_tr_b16 v[128:129], v20 offset:4096
    ds_read_b64_tr_b16 v[130:131], v20 offset:5120
    v_mfma_f32_16x16x32_bf16 v[64:67], v[136:139], v[100:103], v[64:67]
    ds_read_b128 v[80:83], v18 offset:0
    ds_read_b128 v[84:87], v18 offset:2048
    ds_read_b128 v[88:91], v18 offset:4096
    v_mfma_f32_16x16x32_bf16 v[44:47], v[140:143], v[104:107], v[44:47]
    s_movk_i32 s46, 2688
    s_add_u32 m0, s45, 81920
    s_nop 0
    v_mfma_f32_16x16x32_bf16 v[48:51], v[140:143], v[108:111], v[48:51]
    buffer_load_dwordx4 v8, s[8:11], s46 offen sc1 lds
    s_add_u32 m0, s45, 86016
    s_nop 0
    v_mfma_f32_16x16x32_bf16 v[52:55], v[140:143], v[112:115], v[52:55]
    buffer_load_dwordx4 v9, s[8:11], s46 offen sc1 lds
    s_add_u32 m0, s45, 90112
    s_nop 0
    v_mfma_f32_16x16x32_bf16 v[56:59], v[144:147], v[104:107], v[56:59]
    buffer_load_dwordx4 v10, s[8:11], s46 offen sc1 lds
    s_mov_b32 s46, 901120
    s_add_u32 m0, s45, 94208
    v_mfma_f32_16x16x32_bf16 v[60:63], v[144:147], v[108:111], v[60:63]
    s_nop 0
    buffer_load_dwordx4 v11, s[48:51], s46 offen lds
    s_add_u32 m0, s45, 98304
    v_mfma_f32_16x16x32_bf16 v[64:67], v[144:147], v[112:115], v[64:67]
    s_nop 0
    buffer_load_dwordx4 v12, s[48:51], s46 offen lds
    s_waitcnt vmcnt(20) lgkmcnt(0)
    s_barrier
    v_mfma_f32_16x16x32_bf16 v[44:47], v[116:119], v[68:71], v[44:47]
    v_add_u32 v17, 0, v13
    v_add_u32 v19, 0, v15
    v_add_u32 v18, 0, v14
    v_mfma_f32_16x16x32_bf16 v[48:51], v[116:119], v[72:75], v[48:51]
    v_add_u32 v20, 0, v16
    ds_read_b64_tr_b16 v[132:133], v19 offset:0
    ds_read_b64_tr_b16 v[134:135], v19 offset:1024
    v_mfma_f32_16x16x32_bf16 v[52:55], v[116:119], v[76:79], v[52:55]
    ds_read_b64_tr_b16 v[136:137], v20 offset:0
    ds_read_b64_tr_b16 v[138:139], v20 offset:1024
    ds_read_b128 v[92:95], v17 offset:0
    v_mfma_f32_16x16x32_bf16 v[56:59], v[120:123], v[68:71], v[56:59]
    ds_read_b128 v[96:99], v17 offset:2048
    ds_read_b128 v[100:103], v17 offset:4096
    ds_read_b64_tr_b16 v[140:141], v19 offset:4096
    v_mfma_f32_16x16x32_bf16 v[60:63], v[120:123], v[72:75], v[60:63]
    ds_read_b64_tr_b16 v[142:143], v19 offset:5120
    ds_read_b64_tr_b16 v[144:145], v20 offset:4096
    ds_read_b64_tr_b16 v[146:147], v20 offset:5120
    v_mfma_f32_16x16x32_bf16 v[64:67], v[120:123], v[76:79], v[64:67]
    ds_read_b128 v[104:107], v18 offset:0
    ds_read_b128 v[108:111], v18 offset:2048
    ds_read_b128 v[112:115], v18 offset:4096
    v_mfma_f32_16x16x32_bf16 v[44:47], v[124:127], v[80:83], v[44:47]
    s_movk_i32 s46, 2816
    s_add_u32 m0, s45, 102400
    s_nop 0
    v_mfma_f32_16x16x32_bf16 v[48:51], v[124:127], v[84:87], v[48:51]
    buffer_load_dwordx4 v8, s[8:11], s46 offen sc1 lds
    s_add_u32 m0, s45, 106496
    s_nop 0
    v_mfma_f32_16x16x32_bf16 v[52:55], v[124:127], v[88:91], v[52:55]
    buffer_load_dwordx4 v9, s[8:11], s46 offen sc1 lds
    s_add_u32 m0, s45, 110592
    s_nop 0
    v_mfma_f32_16x16x32_bf16 v[56:59], v[128:131], v[80:83], v[56:59]
    buffer_load_dwordx4 v10, s[8:11], s46 offen sc1 lds
    s_mov_b32 s46, 983040
    s_add_u32 m0, s45, 114688
    v_mfma_f32_16x16x32_bf16 v[60:63], v[128:131], v[84:87], v[60:63]
    s_nop 0
    buffer_load_dwordx4 v11, s[48:51], s46 offen lds
    s_add_u32 m0, s45, 118784
    v_mfma_f32_16x16x32_bf16 v[64:67], v[128:131], v[88:91], v[64:67]
    s_nop 0
    buffer_load_dwordx4 v12, s[48:51], s46 offen lds
    s_waitcnt vmcnt(20) lgkmcnt(0)
    s_barrier
    v_mfma_f32_16x16x32_bf16 v[44:47], v[132:135], v[92:95], v[44:47]
    v_add_u32 v17, 20480, v13
    v_add_u32 v19, 20480, v15
    v_add_u32 v18, 20480, v14
    v_mfma_f32_16x16x32_bf16 v[48:51], v[132:135], v[96:99], v[48:51]
    v_add_u32 v20, 20480, v16
    ds_read_b64_tr_b16 v[116:117], v19 offset:0
    ds_read_b64_tr_b16 v[118:119], v19 offset:1024
    v_mfma_f32_16x16x32_bf16 v[52:55], v[132:135], v[100:103], v[52:55]
    ds_read_b64_tr_b16 v[120:121], v20 offset:0
    ds_read_b64_tr_b16 v[122:123], v20 offset:1024
    ds_read_b128 v[68:71], v17 offset:0
    v_mfma_f32_16x16x32_bf16 v[56:59], v[136:139], v[92:95], v[56:59]
    ds_read_b128 v[72:75], v17 offset:2048
    ds_read_b128 v[76:79], v17 offset:4096
    ds_read_b64_tr_b16 v[124:125], v19 offset:4096
    v_mfma_f32_16x16x32_bf16 v[60:63], v[136:139], v[96:99], v[60:63]
    ds_read_b64_tr_b16 v[126:127], v19 offset:5120
    ds_read_b64_tr_b16 v[128:129], v20 offset:4096
    ds_read_b64_tr_b16 v[130:131], v20 offset:5120
    v_mfma_f32_16x16x32_bf16 v[64:67], v[136:139], v[100:103], v[64:67]
    ds_read_b128 v[80:83], v18 offset:0
    ds_read_b128 v[84:87], v18 offset:2048
    ds_read_b128 v[88:91], v18 offset:4096
    v_mfma_f32_16x16x32_bf16 v[44:47], v[140:143], v[104:107], v[44:47]
    s_movk_i32 s46, 2944
    s_add_u32 m0, s45, 122880
    s_nop 0
    v_mfma_f32_16x16x32_bf16 v[48:51], v[140:143], v[108:111], v[48:51]
    buffer_load_dwordx4 v8, s[8:11], s46 offen sc1 lds
    s_add_u32 m0, s45, 126976
    s_nop 0
    v_mfma_f32_16x16x32_bf16 v[52:55], v[140:143], v[112:115], v[52:55]
    buffer_load_dwordx4 v9, s[8:11], s46 offen sc1 lds
    s_add_u32 m0, s45, 131072
    s_nop 0
    v_mfma_f32_16x16x32_bf16 v[56:59], v[144:147], v[104:107], v[56:59]
    buffer_load_dwordx4 v10, s[8:11], s46 offen sc1 lds
    s_mov_b32 s46, 1064960
    s_add_u32 m0, s45, 135168
    v_mfma_f32_16x16x32_bf16 v[60:63], v[144:147], v[108:111], v[60:63]
    s_nop 0
    buffer_load_dwordx4 v11, s[48:51], s46 offen lds
    s_add_u32 m0, s45, 139264
    v_mfma_f32_16x16x32_bf16 v[64:67], v[144:147], v[112:115], v[64:67]
    s_nop 0
    buffer_load_dwordx4 v12, s[48:51], s46 offen lds
    s_waitcnt vmcnt(20) lgkmcnt(0)
    s_barrier
    v_mfma_f32_16x16x32_bf16 v[44:47], v[116:119], v[68:71], v[44:47]
    v_add_u32 v17, 40960, v13
    v_add_u32 v19, 40960, v15
    v_add_u32 v18, 40960, v14
    v_mfma_f32_16x16x32_bf16 v[48:51], v[116:119], v[72:75], v[48:51]
    v_add_u32 v20, 40960, v16
    ds_read_b64_tr_b16 v[132:133], v19 offset:0
    ds_read_b64_tr_b16 v[134:135], v19 offset:1024
    v_mfma_f32_16x16x32_bf16 v[52:55], v[116:119], v[76:79], v[52:55]
    ds_read_b64_tr_b16 v[136:137], v20 offset:0
    ds_read_b64_tr_b16 v[138:139], v20 offset:1024
    ds_read_b128 v[92:95], v17 offset:0
    v_mfma_f32_16x16x32_bf16 v[56:59], v[120:123], v[68:71], v[56:59]
    ds_read_b128 v[96:99], v17 offset:2048
    ds_read_b128 v[100:103], v17 offset:4096
    ds_read_b64_tr_b16 v[140:141], v19 offset:4096
    v_mfma_f32_16x16x32_bf16 v[60:63], v[120:123], v[72:75], v[60:63]
    ds_read_b64_tr_b16 v[142:143], v19 offset:5120
    ds_read_b64_tr_b16 v[144:145], v20 offset:4096
    ds_read_b64_tr_b16 v[146:147], v20 offset:5120
    v_mfma_f32_16x16x32_bf16 v[64:67], v[120:123], v[76:79], v[64:67]
    ds_read_b128 v[104:107], v18 offset:0
    ds_read_b128 v[108:111], v18 offset:2048
    ds_read_b128 v[112:115], v18 offset:4096
    v_mfma_f32_16x16x32_bf16 v[44:47], v[124:127], v[80:83], v[44:47]
    s_movk_i32 s46, 3072
    s_add_u32 m0, s45, 0
    s_nop 0
    v_mfma_f32_16x16x32_bf16 v[48:51], v[124:127], v[84:87], v[48:51]
    buffer_load_dwordx4 v8, s[8:11], s46 offen sc1 lds
    s_add_u32 m0, s45, 4096
    s_nop 0
    v_mfma_f32_16x16x32_bf16 v[52:55], v[124:127], v[88:91], v[52:55]
    buffer_load_dwordx4 v9, s[8:11], s46 offen sc1 lds
    s_add_u32 m0, s45, 8192
    s_nop 0
    v_mfma_f32_16x16x32_bf16 v[56:59], v[128:131], v[80:83], v[56:59]
    buffer_load_dwordx4 v10, s[8:11], s46 offen sc1 lds
    s_mov_b32 s46, 1146880
    s_add_u32 m0, s45, 12288
    v_mfma_f32_16x16x32_bf16 v[60:63], v[128:131], v[84:87], v[60:63]
    s_nop 0
    buffer_load_dwordx4 v11, s[48:51], s46 offen lds
    s_add_u32 m0, s45, 16384
    v_mfma_f32_16x16x32_bf16 v[64:67], v[128:131], v[88:91], v[64:67]
    s_nop 0
    buffer_load_dwordx4 v12, s[48:51], s46 offen lds
    s_waitcnt vmcnt(20) lgkmcnt(0)
    s_barrier
    v_mfma_f32_16x16x32_bf16 v[44:47], v[132:135], v[92:95], v[44:47]
    v_add_u32 v17, 61440, v13
    v_add_u32 v19, 61440, v15
    v_add_u32 v18, 61440, v14
    v_mfma_f32_16x16x32_bf16 v[48:51], v[132:135], v[96:99], v[48:51]
    v_add_u32 v20, 61440, v16
    ds_read_b64_tr_b16 v[116:117], v19 offset:0
    ds_read_b64_tr_b16 v[118:119], v19 offset:1024
    v_mfma_f32_16x16x32_bf16 v[52:55], v[132:135], v[100:103], v[52:55]
    ds_read_b64_tr_b16 v[120:121], v20 offset:0
    ds_read_b64_tr_b16 v[122:123], v20 offset:1024
    ds_read_b128 v[68:71], v17 offset:0
    v_mfma_f32_16x16x32_bf16 v[56:59], v[136:139], v[92:95], v[56:59]
    ds_read_b128 v[72:75], v17 offset:2048
    ds_read_b128 v[76:79], v17 offset:4096
    ds_read_b64_tr_b16 v[124:125], v19 offset:4096
    v_mfma_f32_16x16x32_bf16 v[60:63], v[136:139], v[96:99], v[60:63]
    ds_read_b64_tr_b16 v[126:127], v19 offset:5120
    ds_read_b64_tr_b16 v[128:129], v20 offset:4096
    ds_read_b64_tr_b16 v[130:131], v20 offset:5120
    v_mfma_f32_16x16x32_bf16 v[64:67], v[136:139], v[100:103], v[64:67]
    ds_read_b128 v[80:83], v18 offset:0
    ds_read_b128 v[84:87], v18 offset:2048
    ds_read_b128 v[88:91], v18 offset:4096
    v_mfma_f32_16x16x32_bf16 v[44:47], v[140:143], v[104:107], v[44:47]
    s_movk_i32 s46, 3200
    s_add_u32 m0, s45, 20480
    s_nop 0
    v_mfma_f32_16x16x32_bf16 v[48:51], v[140:143], v[108:111], v[48:51]
    buffer_load_dwordx4 v8, s[8:11], s46 offen sc1 lds
    s_add_u32 m0, s45, 24576
    s_nop 0
    v_mfma_f32_16x16x32_bf16 v[52:55], v[140:143], v[112:115], v[52:55]
    buffer_load_dwordx4 v9, s[8:11], s46 offen sc1 lds
    s_add_u32 m0, s45, 28672
    s_nop 0
    v_mfma_f32_16x16x32_bf16 v[56:59], v[144:147], v[104:107], v[56:59]
    buffer_load_dwordx4 v10, s[8:11], s46 offen sc1 lds
    s_mov_b32 s46, 1228800
    s_add_u32 m0, s45, 32768
    v_mfma_f32_16x16x32_bf16 v[60:63], v[144:147], v[108:111], v[60:63]
    s_nop 0
    buffer_load_dwordx4 v11, s[48:51], s46 offen lds
    s_add_u32 m0, s45, 36864
    v_mfma_f32_16x16x32_bf16 v[64:67], v[144:147], v[112:115], v[64:67]
    s_nop 0
    buffer_load_dwordx4 v12, s[48:51], s46 offen lds
    s_waitcnt vmcnt(20) lgkmcnt(0)
    s_barrier
    v_mfma_f32_16x16x32_bf16 v[44:47], v[116:119], v[68:71], v[44:47]
    v_add_u32 v17, 81920, v13
    v_add_u32 v19, 81920, v15
    v_add_u32 v18, 81920, v14
    v_mfma_f32_16x16x32_bf16 v[48:51], v[116:119], v[72:75], v[48:51]
    v_add_u32 v20, 81920, v16
    ds_read_b64_tr_b16 v[132:133], v19 offset:0
    ds_read_b64_tr_b16 v[134:135], v19 offset:1024
    v_mfma_f32_16x16x32_bf16 v[52:55], v[116:119], v[76:79], v[52:55]
    ds_read_b64_tr_b16 v[136:137], v20 offset:0
    ds_read_b64_tr_b16 v[138:139], v20 offset:1024
    ds_read_b128 v[92:95], v17 offset:0
    v_mfma_f32_16x16x32_bf16 v[56:59], v[120:123], v[68:71], v[56:59]
    ds_read_b128 v[96:99], v17 offset:2048
    ds_read_b128 v[100:103], v17 offset:4096
    ds_read_b64_tr_b16 v[140:141], v19 offset:4096
    v_mfma_f32_16x16x32_bf16 v[60:63], v[120:123], v[72:75], v[60:63]
    ds_read_b64_tr_b16 v[142:143], v19 offset:5120
    ds_read_b64_tr_b16 v[144:145], v20 offset:4096
    ds_read_b64_tr_b16 v[146:147], v20 offset:5120
    v_mfma_f32_16x16x32_bf16 v[64:67], v[120:123], v[76:79], v[64:67]
    ds_read_b128 v[104:107], v18 offset:0
    ds_read_b128 v[108:111], v18 offset:2048
    ds_read_b128 v[112:115], v18 offset:4096
    v_mfma_f32_16x16x32_bf16 v[44:47], v[124:127], v[80:83], v[44:47]
    s_movk_i32 s46, 3328
    s_add_u32 m0, s45, 40960
    s_nop 0
    v_mfma_f32_16x16x32_bf16 v[48:51], v[124:127], v[84:87], v[48:51]
    buffer_load_dwordx4 v8, s[8:11], s46 offen sc1 lds
    s_add_u32 m0, s45, 45056
    s_nop 0
    v_mfma_f32_16x16x32_bf16 v[52:55], v[124:127], v[88:91], v[52:55]
    buffer_load_dwordx4 v9, s[8:11], s46 offen sc1 lds
    s_add_u32 m0, s45, 49152
    s_nop 0
    v_mfma_f32_16x16x32_bf16 v[56:59], v[128:131], v[80:83], v[56:59]
    buffer_load_dwordx4 v10, s[8:11], s46 offen sc1 lds
    s_mov_b32 s46, 1310720
    s_add_u32 m0, s45, 53248
    v_mfma_f32_16x16x32_bf16 v[60:63], v[128:131], v[84:87], v[60:63]
    s_nop 0
    buffer_load_dwordx4 v11, s[48:51], s46 offen lds
    s_add_u32 m0, s45, 57344
    v_mfma_f32_16x16x32_bf16 v[64:67], v[128:131], v[88:91], v[64:67]
    s_nop 0
    buffer_load_dwordx4 v12, s[48:51], s46 offen lds
    s_waitcnt vmcnt(20) lgkmcnt(0)
    s_barrier
    v_mfma_f32_16x16x32_bf16 v[44:47], v[132:135], v[92:95], v[44:47]
    v_add_u32 v17, 102400, v13
    v_add_u32 v19, 102400, v15
    v_add_u32 v18, 102400, v14
    v_mfma_f32_16x16x32_bf16 v[48:51], v[132:135], v[96:99], v[48:51]
    v_add_u32 v20, 102400, v16
    ds_read_b64_tr_b16 v[116:117], v19 offset:0
    ds_read_b64_tr_b16 v[118:119], v19 offset:1024
    v_mfma_f32_16x16x32_bf16 v[52:55], v[132:135], v[100:103], v[52:55]
    ds_read_b64_tr_b16 v[120:121], v20 offset:0
    ds_read_b64_tr_b16 v[122:123], v20 offset:1024
    ds_read_b128 v[68:71], v17 offset:0
    v_mfma_f32_16x16x32_bf16 v[56:59], v[136:139], v[92:95], v[56:59]
    ds_read_b128 v[72:75], v17 offset:2048
    ds_read_b128 v[76:79], v17 offset:4096
    ds_read_b64_tr_b16 v[124:125], v19 offset:4096
    v_mfma_f32_16x16x32_bf16 v[60:63], v[136:139], v[96:99], v[60:63]
    ds_read_b64_tr_b16 v[126:127], v19 offset:5120
    ds_read_b64_tr_b16 v[128:129], v20 offset:4096
    ds_read_b64_tr_b16 v[130:131], v20 offset:5120
    v_mfma_f32_16x16x32_bf16 v[64:67], v[136:139], v[100:103], v[64:67]
    ds_read_b128 v[80:83], v18 offset:0
    ds_read_b128 v[84:87], v18 offset:2048
    ds_read_b128 v[88:91], v18 offset:4096
    v_mfma_f32_16x16x32_bf16 v[44:47], v[140:143], v[104:107], v[44:47]
    s_movk_i32 s46, 3456
    s_add_u32 m0, s45, 61440
    s_nop 0
    v_mfma_f32_16x16x32_bf16 v[48:51], v[140:143], v[108:111], v[48:51]
    buffer_load_dwordx4 v8, s[8:11], s46 offen sc1 lds
    s_add_u32 m0, s45, 65536
    s_nop 0
    v_mfma_f32_16x16x32_bf16 v[52:55], v[140:143], v[112:115], v[52:55]
    buffer_load_dwordx4 v9, s[8:11], s46 offen sc1 lds
    s_add_u32 m0, s45, 69632
    s_nop 0
    v_mfma_f32_16x16x32_bf16 v[56:59], v[144:147], v[104:107], v[56:59]
    buffer_load_dwordx4 v10, s[8:11], s46 offen sc1 lds
    s_mov_b32 s46, 1392640
    s_add_u32 m0, s45, 73728
    v_mfma_f32_16x16x32_bf16 v[60:63], v[144:147], v[108:111], v[60:63]
    s_nop 0
    buffer_load_dwordx4 v11, s[48:51], s46 offen lds
    s_add_u32 m0, s45, 77824
    v_mfma_f32_16x16x32_bf16 v[64:67], v[144:147], v[112:115], v[64:67]
    s_nop 0
    buffer_load_dwordx4 v12, s[48:51], s46 offen lds
    s_waitcnt vmcnt(20) lgkmcnt(0)
    s_barrier
    v_mfma_f32_16x16x32_bf16 v[44:47], v[116:119], v[68:71], v[44:47]
    v_add_u32 v17, 122880, v13
    v_add_u32 v19, 122880, v15
    v_add_u32 v18, 122880, v14
    v_mfma_f32_16x16x32_bf16 v[48:51], v[116:119], v[72:75], v[48:51]
    v_add_u32 v20, 122880, v16
    ds_read_b64_tr_b16 v[132:133], v19 offset:0
    ds_read_b64_tr_b16 v[134:135], v19 offset:1024
    v_mfma_f32_16x16x32_bf16 v[52:55], v[116:119], v[76:79], v[52:55]
    ds_read_b64_tr_b16 v[136:137], v20 offset:0
    ds_read_b64_tr_b16 v[138:139], v20 offset:1024
    ds_read_b128 v[92:95], v17 offset:0
    v_mfma_f32_16x16x32_bf16 v[56:59], v[120:123], v[68:71], v[56:59]
    ds_read_b128 v[96:99], v17 offset:2048
    ds_read_b128 v[100:103], v17 offset:4096
    ds_read_b64_tr_b16 v[140:141], v19 offset:4096
    v_mfma_f32_16x16x32_bf16 v[60:63], v[120:123], v[72:75], v[60:63]
    ds_read_b64_tr_b16 v[142:143], v19 offset:5120
    ds_read_b64_tr_b16 v[144:145], v20 offset:4096
    ds_read_b64_tr_b16 v[146:147], v20 offset:5120
    v_mfma_f32_16x16x32_bf16 v[64:67], v[120:123], v[76:79], v[64:67]
    ds_read_b128 v[104:107], v18 offset:0
    ds_read_b128 v[108:111], v18 offset:2048
    ds_read_b128 v[112:115], v18 offset:4096
    v_mfma_f32_16x16x32_bf16 v[44:47], v[124:127], v[80:83], v[44:47]
    s_movk_i32 s46, 3584
    s_add_u32 m0, s45, 81920
    s_nop 0
    v_mfma_f32_16x16x32_bf16 v[48:51], v[124:127], v[84:87], v[48:51]
    buffer_load_dwordx4 v8, s[8:11], s46 offen sc1 lds
    s_add_u32 m0, s45, 86016
    s_nop 0
    v_mfma_f32_16x16x32_bf16 v[52:55], v[124:127], v[88:91], v[52:55]
    buffer_load_dwordx4 v9, s[8:11], s46 offen sc1 lds
    s_add_u32 m0, s45, 90112
    s_nop 0
    v_mfma_f32_16x16x32_bf16 v[56:59], v[128:131], v[80:83], v[56:59]
    buffer_load_dwordx4 v10, s[8:11], s46 offen sc1 lds
    s_mov_b32 s46, 1474560
    s_add_u32 m0, s45, 94208
    v_mfma_f32_16x16x32_bf16 v[60:63], v[128:131], v[84:87], v[60:63]
    s_nop 0
    buffer_load_dwordx4 v11, s[48:51], s46 offen lds
    s_add_u32 m0, s45, 98304
    v_mfma_f32_16x16x32_bf16 v[64:67], v[128:131], v[88:91], v[64:67]
    s_nop 0
    buffer_load_dwordx4 v12, s[48:51], s46 offen lds
    s_waitcnt vmcnt(20) lgkmcnt(0)
    s_barrier
    v_mfma_f32_16x16x32_bf16 v[44:47], v[132:135], v[92:95], v[44:47]
    v_add_u32 v17, 0, v13
    v_add_u32 v19, 0, v15
    v_add_u32 v18, 0, v14
    v_mfma_f32_16x16x32_bf16 v[48:51], v[132:135], v[96:99], v[48:51]
    v_add_u32 v20, 0, v16
    ds_read_b64_tr_b16 v[116:117], v19 offset:0
    ds_read_b64_tr_b16 v[118:119], v19 offset:1024
    v_mfma_f32_16x16x32_bf16 v[52:55], v[132:135], v[100:103], v[52:55]
    ds_read_b64_tr_b16 v[120:121], v20 offset:0
    ds_read_b64_tr_b16 v[122:123], v20 offset:1024
    ds_read_b128 v[68:71], v17 offset:0
    v_mfma_f32_16x16x32_bf16 v[56:59], v[136:139], v[92:95], v[56:59]
    ds_read_b128 v[72:75], v17 offset:2048
    ds_read_b128 v[76:79], v17 offset:4096
    ds_read_b64_tr_b16 v[124:125], v19 offset:4096
    v_mfma_f32_16x16x32_bf16 v[60:63], v[136:139], v[96:99], v[60:63]
    ds_read_b64_tr_b16 v[126:127], v19 offset:5120
    ds_read_b64_tr_b16 v[128:129], v20 offset:4096
    ds_read_b64_tr_b16 v[130:131], v20 offset:5120
    v_mfma_f32_16x16x32_bf16 v[64:67], v[136:139], v[100:103], v[64:67]
    ds_read_b128 v[80:83], v18 offset:0
    ds_read_b128 v[84:87], v18 offset:2048
    ds_read_b128 v[88:91], v18 offset:4096
    v_mfma_f32_16x16x32_bf16 v[44:47], v[140:143], v[104:107], v[44:47]
    s_movk_i32 s46, 3712
    s_add_u32 m0, s45, 102400
    s_nop 0
    v_mfma_f32_16x16x32_bf16 v[48:51], v[140:143], v[108:111], v[48:51]
    buffer_load_dwordx4 v8, s[8:11], s46 offen sc1 lds
    s_add_u32 m0, s45, 106496
    s_nop 0
    v_mfma_f32_16x16x32_bf16 v[52:55], v[140:143], v[112:115], v[52:55]
    buffer_load_dwordx4 v9, s[8:11], s46 offen sc1 lds
    s_add_u32 m0, s45, 110592
    s_nop 0
    v_mfma_f32_16x16x32_bf16 v[56:59], v[144:147], v[104:107], v[56:59]
    buffer_load_dwordx4 v10, s[8:11], s46 offen sc1 lds
    s_mov_b32 s46, 1556480
    s_add_u32 m0, s45, 114688
    v_mfma_f32_16x16x32_bf16 v[60:63], v[144:147], v[108:111], v[60:63]
    s_nop 0
    buffer_load_dwordx4 v11, s[48:51], s46 offen lds
    s_add_u32 m0, s45, 118784
    v_mfma_f32_16x16x32_bf16 v[64:67], v[144:147], v[112:115], v[64:67]
    s_nop 0
    buffer_load_dwordx4 v12, s[48:51], s46 offen lds
    s_waitcnt vmcnt(20) lgkmcnt(0)
    s_barrier
    v_mfma_f32_16x16x32_bf16 v[44:47], v[116:119], v[68:71], v[44:47]
    v_add_u32 v17, 20480, v13
    v_add_u32 v19, 20480, v15
    v_add_u32 v18, 20480, v14
    v_mfma_f32_16x16x32_bf16 v[48:51], v[116:119], v[72:75], v[48:51]
    v_add_u32 v20, 20480, v16
    ds_read_b64_tr_b16 v[132:133], v19 offset:0
    ds_read_b64_tr_b16 v[134:135], v19 offset:1024
    v_mfma_f32_16x16x32_bf16 v[52:55], v[116:119], v[76:79], v[52:55]
    ds_read_b64_tr_b16 v[136:137], v20 offset:0
    ds_read_b64_tr_b16 v[138:139], v20 offset:1024
    ds_read_b128 v[92:95], v17 offset:0
    v_mfma_f32_16x16x32_bf16 v[56:59], v[120:123], v[68:71], v[56:59]
    ds_read_b128 v[96:99], v17 offset:2048
    ds_read_b128 v[100:103], v17 offset:4096
    ds_read_b64_tr_b16 v[140:141], v19 offset:4096
    v_mfma_f32_16x16x32_bf16 v[60:63], v[120:123], v[72:75], v[60:63]
    ds_read_b64_tr_b16 v[142:143], v19 offset:5120
    ds_read_b64_tr_b16 v[144:145], v20 offset:4096
    ds_read_b64_tr_b16 v[146:147], v20 offset:5120
    v_mfma_f32_16x16x32_bf16 v[64:67], v[120:123], v[76:79], v[64:67]
    ds_read_b128 v[104:107], v18 offset:0
    ds_read_b128 v[108:111], v18 offset:2048
    ds_read_b128 v[112:115], v18 offset:4096
    v_mfma_f32_16x16x32_bf16 v[44:47], v[124:127], v[80:83], v[44:47]
    s_movk_i32 s46, 3840
    s_add_u32 m0, s45, 122880
    s_nop 0
    v_mfma_f32_16x16x32_bf16 v[48:51], v[124:127], v[84:87], v[48:51]
    buffer_load_dwordx4 v8, s[8:11], s46 offen sc1 lds
    s_add_u32 m0, s45, 126976
    s_nop 0
    v_mfma_f32_16x16x32_bf16 v[52:55], v[124:127], v[88:91], v[52:55]
    buffer_load_dwordx4 v9, s[8:11], s46 offen sc1 lds
    s_add_u32 m0, s45, 131072
    s_nop 0
    v_mfma_f32_16x16x32_bf16 v[56:59], v[128:131], v[80:83], v[56:59]
    buffer_load_dwordx4 v10, s[8:11], s46 offen sc1 lds
    s_mov_b32 s46, 1638400
    s_add_u32 m0, s45, 135168
    v_mfma_f32_16x16x32_bf16 v[60:63], v[128:131], v[84:87], v[60:63]
    s_nop 0
    buffer_load_dwordx4 v11, s[48:51], s46 offen lds
    s_add_u32 m0, s45, 139264
    v_mfma_f32_16x16x32_bf16 v[64:67], v[128:131], v[88:91], v[64:67]
    s_nop 0
    buffer_load_dwordx4 v12, s[48:51], s46 offen lds
    s_waitcnt vmcnt(20) lgkmcnt(0)
    s_barrier
    v_mfma_f32_16x16x32_bf16 v[44:47], v[132:135], v[92:95], v[44:47]
    v_add_u32 v17, 40960, v13
    v_add_u32 v19, 40960, v15
    v_add_u32 v18, 40960, v14
    v_mfma_f32_16x16x32_bf16 v[48:51], v[132:135], v[96:99], v[48:51]
    v_add_u32 v20, 40960, v16
    ds_read_b64_tr_b16 v[116:117], v19 offset:0
    ds_read_b64_tr_b16 v[118:119], v19 offset:1024
    v_mfma_f32_16x16x32_bf16 v[52:55], v[132:135], v[100:103], v[52:55]
    ds_read_b64_tr_b16 v[120:121], v20 offset:0
    ds_read_b64_tr_b16 v[122:123], v20 offset:1024
    ds_read_b128 v[68:71], v17 offset:0
    v_mfma_f32_16x16x32_bf16 v[56:59], v[136:139], v[92:95], v[56:59]
    ds_read_b128 v[72:75], v17 offset:2048
    ds_read_b128 v[76:79], v17 offset:4096
    ds_read_b64_tr_b16 v[124:125], v19 offset:4096
    v_mfma_f32_16x16x32_bf16 v[60:63], v[136:139], v[96:99], v[60:63]
    ds_read_b64_tr_b16 v[126:127], v19 offset:5120
    ds_read_b64_tr_b16 v[128:129], v20 offset:4096
    ds_read_b64_tr_b16 v[130:131], v20 offset:5120
    v_mfma_f32_16x16x32_bf16 v[64:67], v[136:139], v[100:103], v[64:67]
    ds_read_b128 v[80:83], v18 offset:0
    ds_read_b128 v[84:87], v18 offset:2048
    ds_read_b128 v[88:91], v18 offset:4096
    v_mfma_f32_16x16x32_bf16 v[44:47], v[140:143], v[104:107], v[44:47]
    s_movk_i32 s46, 3968
    s_add_u32 m0, s45, 0
    s_nop 0
    v_mfma_f32_16x16x32_bf16 v[48:51], v[140:143], v[108:111], v[48:51]
    buffer_load_dwordx4 v8, s[8:11], s46 offen sc1 lds
    s_add_u32 m0, s45, 4096
    s_nop 0
    v_mfma_f32_16x16x32_bf16 v[52:55], v[140:143], v[112:115], v[52:55]
    buffer_load_dwordx4 v9, s[8:11], s46 offen sc1 lds
    s_add_u32 m0, s45, 8192
    s_nop 0
    v_mfma_f32_16x16x32_bf16 v[56:59], v[144:147], v[104:107], v[56:59]
    buffer_load_dwordx4 v10, s[8:11], s46 offen sc1 lds
    s_mov_b32 s46, 1720320
    s_add_u32 m0, s45, 12288
    v_mfma_f32_16x16x32_bf16 v[60:63], v[144:147], v[108:111], v[60:63]
    s_nop 0
    buffer_load_dwordx4 v11, s[48:51], s46 offen lds
    s_add_u32 m0, s45, 16384
    v_mfma_f32_16x16x32_bf16 v[64:67], v[144:147], v[112:115], v[64:67]
    s_nop 0
    buffer_load_dwordx4 v12, s[48:51], s46 offen lds
    s_waitcnt vmcnt(20) lgkmcnt(0)
    s_barrier
    v_mfma_f32_16x16x32_bf16 v[44:47], v[116:119], v[68:71], v[44:47]
    v_add_u32 v17, 61440, v13
    v_add_u32 v19, 61440, v15
    v_add_u32 v18, 61440, v14
    v_mfma_f32_16x16x32_bf16 v[48:51], v[116:119], v[72:75], v[48:51]
    v_add_u32 v20, 61440, v16
    ds_read_b64_tr_b16 v[132:133], v19 offset:0
    ds_read_b64_tr_b16 v[134:135], v19 offset:1024
    v_mfma_f32_16x16x32_bf16 v[52:55], v[116:119], v[76:79], v[52:55]
    ds_read_b64_tr_b16 v[136:137], v20 offset:0
    ds_read_b64_tr_b16 v[138:139], v20 offset:1024
    ds_read_b128 v[92:95], v17 offset:0
    v_mfma_f32_16x16x32_bf16 v[56:59], v[120:123], v[68:71], v[56:59]
    ds_read_b128 v[96:99], v17 offset:2048
    ds_read_b128 v[100:103], v17 offset:4096
    ds_read_b64_tr_b16 v[140:141], v19 offset:4096
    v_mfma_f32_16x16x32_bf16 v[60:63], v[120:123], v[72:75], v[60:63]
    ds_read_b64_tr_b16 v[142:143], v19 offset:5120
    ds_read_b64_tr_b16 v[144:145], v20 offset:4096
    ds_read_b64_tr_b16 v[146:147], v20 offset:5120
    v_mfma_f32_16x16x32_bf16 v[64:67], v[120:123], v[76:79], v[64:67]
    ds_read_b128 v[104:107], v18 offset:0
    ds_read_b128 v[108:111], v18 offset:2048
    ds_read_b128 v[112:115], v18 offset:4096
    v_mfma_f32_16x16x32_bf16 v[44:47], v[124:127], v[80:83], v[44:47]
    s_movk_i32 s46, 4096
    s_add_u32 m0, s45, 20480
    s_nop 0
    v_mfma_f32_16x16x32_bf16 v[48:51], v[124:127], v[84:87], v[48:51]
    buffer_load_dwordx4 v8, s[8:11], s46 offen sc1 lds
    s_add_u32 m0, s45, 24576
    s_nop 0
    v_mfma_f32_16x16x32_bf16 v[52:55], v[124:127], v[88:91], v[52:55]
    buffer_load_dwordx4 v9, s[8:11], s46 offen sc1 lds
    s_add_u32 m0, s45, 28672
    s_nop 0
    v_mfma_f32_16x16x32_bf16 v[56:59], v[128:131], v[80:83], v[56:59]
    buffer_load_dwordx4 v10, s[8:11], s46 offen sc1 lds
    s_mov_b32 s46, 1802240
    s_add_u32 m0, s45, 32768
    v_mfma_f32_16x16x32_bf16 v[60:63], v[128:131], v[84:87], v[60:63]
    s_nop 0
    buffer_load_dwordx4 v11, s[48:51], s46 offen lds
    s_add_u32 m0, s45, 36864
    v_mfma_f32_16x16x32_bf16 v[64:67], v[128:131], v[88:91], v[64:67]
    s_nop 0
    buffer_load_dwordx4 v12, s[48:51], s46 offen lds
    s_waitcnt vmcnt(20) lgkmcnt(0)
    s_barrier
    v_mfma_f32_16x16x32_bf16 v[44:47], v[132:135], v[92:95], v[44:47]
    v_add_u32 v17, 81920, v13
    v_add_u32 v19, 81920, v15
    v_add_u32 v18, 81920, v14
    v_mfma_f32_16x16x32_bf16 v[48:51], v[132:135], v[96:99], v[48:51]
    v_add_u32 v20, 81920, v16
    ds_read_b64_tr_b16 v[116:117], v19 offset:0
    ds_read_b64_tr_b16 v[118:119], v19 offset:1024
    v_mfma_f32_16x16x32_bf16 v[52:55], v[132:135], v[100:103], v[52:55]
    ds_read_b64_tr_b16 v[120:121], v20 offset:0
    ds_read_b64_tr_b16 v[122:123], v20 offset:1024
    ds_read_b128 v[68:71], v17 offset:0
    v_mfma_f32_16x16x32_bf16 v[56:59], v[136:139], v[92:95], v[56:59]
    ds_read_b128 v[72:75], v17 offset:2048
    ds_read_b128 v[76:79], v17 offset:4096
    ds_read_b64_tr_b16 v[124:125], v19 offset:4096
    v_mfma_f32_16x16x32_bf16 v[60:63], v[136:139], v[96:99], v[60:63]
    ds_read_b64_tr_b16 v[126:127], v19 offset:5120
    ds_read_b64_tr_b16 v[128:129], v20 offset:4096
    ds_read_b64_tr_b16 v[130:131], v20 offset:5120
    v_mfma_f32_16x16x32_bf16 v[64:67], v[136:139], v[100:103], v[64:67]
    ds_read_b128 v[80:83], v18 offset:0
    ds_read_b128 v[84:87], v18 offset:2048
    ds_read_b128 v[88:91], v18 offset:4096
    v_mfma_f32_16x16x32_bf16 v[44:47], v[140:143], v[104:107], v[44:47]
    s_movk_i32 s46, 4224
    s_add_u32 m0, s45, 40960
    s_nop 0
    v_mfma_f32_16x16x32_bf16 v[48:51], v[140:143], v[108:111], v[48:51]
    buffer_load_dwordx4 v8, s[8:11], s46 offen sc1 lds
    s_add_u32 m0, s45, 45056
    s_nop 0
    v_mfma_f32_16x16x32_bf16 v[52:55], v[140:143], v[112:115], v[52:55]
    buffer_load_dwordx4 v9, s[8:11], s46 offen sc1 lds
    s_add_u32 m0, s45, 49152
    s_nop 0
    v_mfma_f32_16x16x32_bf16 v[56:59], v[144:147], v[104:107], v[56:59]
    buffer_load_dwordx4 v10, s[8:11], s46 offen sc1 lds
    s_mov_b32 s46, 1884160
    s_add_u32 m0, s45, 53248
    v_mfma_f32_16x16x32_bf16 v[60:63], v[144:147], v[108:111], v[60:63]
    s_nop 0
    buffer_load_dwordx4 v11, s[48:51], s46 offen lds
    s_add_u32 m0, s45, 57344
    v_mfma_f32_16x16x32_bf16 v[64:67], v[144:147], v[112:115], v[64:67]
    s_nop 0
    buffer_load_dwordx4 v12, s[48:51], s46 offen lds
    s_waitcnt vmcnt(20) lgkmcnt(0)
    s_cmp_lg_u32 s39, 0
    s_cbranch_scc1 PS_44
    v_mov_b32 v4, s56
    s_mov_b64 exec, 1
    s_mov_b32 s58, 200000
PL_42:
    buffer_load_dword v5, v4, s[52:55], 0 offen offset:4 sc1
    s_waitcnt vmcnt(0)
    v_cmp_gt_u32 vcc, s59, v5
    s_nop 4
    s_cbranch_vccz PD_43
    s_sleep 8
    s_sub_u32 s58, s58, 1
    s_cmp_lg_u32 s58, 0
    s_cbranch_scc1 PL_42
PD_43:
    s_mov_b64 exec, -1
PS_44:
    s_barrier
    v_mfma_f32_16x16x32_bf16 v[44:47], v[116:119], v[68:71], v[44:47]
    v_add_u32 v17, 102400, v13
    v_add_u32 v19, 102400, v15
    v_add_u32 v18, 102400, v14
    v_mfma_f32_16x16x32_bf16 v[48:51], v[116:119], v[72:75], v[48:51]
    v_add_u32 v20, 102400, v16
    ds_read_b64_tr_b16 v[132:133], v19 offset:0
    ds_read_b64_tr_b16 v[134:135], v19 offset:1024
    v_mfma_f32_16x16x32_bf16 v[52:55], v[116:119], v[76:79], v[52:55]
    ds_read_b64_tr_b16 v[136:137], v20 offset:0
    ds_read_b64_tr_b16 v[138:139], v20 offset:1024
    ds_read_b128 v[92:95], v17 offset:0
    v_mfma_f32_16x16x32_bf16 v[56:59], v[120:123], v[68:71], v[56:59]
    ds_read_b128 v[96:99], v17 offset:2048
    ds_read_b128 v[100:103], v17 offset:4096
    ds_read_b64_tr_b16 v[140:141], v19 offset:4096
    v_mfma_f32_16x16x32_bf16 v[60:63], v[120:123], v[72:75], v[60:63]
    ds_read_b64_tr_b16 v[142:143], v19 offset:5120
    ds_read_b64_tr_b16 v[144:145], v20 offset:4096
    ds_read_b64_tr_b16 v[146:147], v20 offset:5120
    v_mfma_f32_16x16x32_bf16 v[64:67], v[120:123], v[76:79], v[64:67]
    ds_read_b128 v[104:107], v18 offset:0
    ds_read_b128 v[108:111], v18 offset:2048
    ds_read_b128 v[112:115], v18 offset:4096
    v_mfma_f32_16x16x32_bf16 v[44:47], v[124:127], v[80:83], v[44:47]
    s_movk_i32 s46, 0
    s_add_u32 m0, s45, 61440
    s_nop 0
    v_mfma_f32_16x16x32_bf16 v[48:51], v[124:127], v[84:87], v[48:51]
    buffer_load_dwordx4 v8, s[8:11], s46 offen sc1 lds
    s_add_u32 m0, s45, 65536
    s_nop 0
    v_mfma_f32_16x16x32_bf16 v[52:55], v[124:127], v[88:91], v[52:55]
    buffer_load_dwordx4 v9, s[8:11], s46 offen sc1 lds
    s_add_u32 m0, s45, 69632
    s_nop 0
    v_mfma_f32_16x16x32_bf16 v[56:59], v[128:131], v[80:83], v[56:59]
    buffer_load_dwordx4 v10, s[8:11], s46 offen sc1 lds
    s_mov_b32 s46, 0
    s_add_u32 m0, s45, 73728
    v_mfma_f32_16x16x32_bf16 v[60:63], v[128:131], v[84:87], v[60:63]
    s_nop 0
    buffer_load_dwordx4 v11, s[12:15], s46 offen lds
    s_add_u32 m0, s45, 77824
    v_mfma_f32_16x16x32_bf16 v[64:67], v[128:131], v[88:91], v[64:67]
    s_nop 0
    buffer_load_dwordx4 v12, s[12:15], s46 offen lds
    s_waitcnt vmcnt(20) lgkmcnt(0)
    s_barrier
    v_mfma_f32_16x16x32_bf16 v[44:47], v[132:135], v[92:95], v[44:47]
    v_add_u32 v17, 122880, v13
    v_add_u32 v19, 122880, v15
    v_add_u32 v18, 122880, v14
    v_mfma_f32_16x16x32_bf16 v[48:51], v[132:135], v[96:99], v[48:51]
    v_add_u32 v20, 122880, v16
    ds_read_b64_tr_b16 v[116:117], v19 offset:0
    ds_read_b64_tr_b16 v[118:119], v19 offset:1024
    v_mfma_f32_16x16x32_bf16 v[52:55], v[132:135], v[100:103], v[52:55]
    ds_read_b64_tr_b16 v[120:121], v20 offset:0
    ds_read_b64_tr_b16 v[122:123], v20 offset:1024
    ds_read_b128 v[68:71], v17 offset:0
    v_mfma_f32_16x16x32_bf16 v[56:59], v[136:139], v[92:95], v[56:59]
    ds_read_b128 v[72:75], v17 offset:2048
    ds_read_b128 v[76:79], v17 offset:4096
    ds_read_b64_tr_b16 v[124:125], v19 offset:4096
    v_mfma_f32_16x16x32_bf16 v[60:63], v[136:139], v[96:99], v[60:63]
    ds_read_b64_tr_b16 v[126:127], v19 offset:5120
    ds_read_b64_tr_b16 v[128:129], v20 offset:4096
    ds_read_b64_tr_b16 v[130:131], v20 offset:5120
    v_mfma_f32_16x16x32_bf16 v[64:67], v[136:139], v[100:103], v[64:67]
    ds_read_b128 v[80:83], v18 offset:0
    ds_read_b128 v[84:87], v18 offset:2048
    ds_read_b128 v[88:91], v18 offset:4096
    v_mfma_f32_16x16x32_bf16 v[44:47], v[140:143], v[104:107], v[44:47]
    s_movk_i32 s46, 128
    s_add_u32 m0, s45, 81920
    s_nop 0
    v_mfma_f32_16x16x32_bf16 v[48:51], v[140:143], v[108:111], v[48:51]
    buffer_load_dwordx4 v8, s[8:11], s46 offen sc1 lds
    s_add_u32 m0, s45, 86016
    s_nop 0
    v_mfma_f32_16x16x32_bf16 v[52:55], v[140:143], v[112:115], v[52:55]
    buffer_load_dwordx4 v9, s[8:11], s46 offen sc1 lds
    s_add_u32 m0, s45, 90112
    s_nop 0
    v_mfma_f32_16x16x32_bf16 v[56:59], v[144:147], v[104:107], v[56:59]
    buffer_load_dwordx4 v10, s[8:11], s46 offen sc1 lds
    s_mov_b32 s46, 81920
    s_add_u32 m0, s45, 94208
    v_mfma_f32_16x16x32_bf16 v[60:63], v[144:147], v[108:111], v[60:63]
    s_nop 0
    buffer_load_dwordx4 v11, s[12:15], s46 offen lds
    s_add_u32 m0, s45, 98304
    v_mfma_f32_16x16x32_bf16 v[64:67], v[144:147], v[112:115], v[64:67]
    s_nop 0
    buffer_load_dwordx4 v12, s[12:15], s46 offen lds
    s_waitcnt vmcnt(20) lgkmcnt(0)
    s_barrier
    v_mfma_f32_16x16x32_bf16 v[44:47], v[116:119], v[68:71], v[44:47]
    v_add_u32 v17, 0, v13
    v_add_u32 v19, 0, v15
    v_add_u32 v18, 0, v14
    v_mfma_f32_16x16x32_bf16 v[48:51], v[116:119], v[72:75], v[48:51]
    v_add_u32 v20, 0, v16
    ds_read_b64_tr_b16 v[132:133], v19 offset:0
    ds_read_b64_tr_b16 v[134:135], v19 offset:1024
    v_mfma_f32_16x16x32_bf16 v[52:55], v[116:119], v[76:79], v[52:55]
    ds_read_b64_tr_b16 v[136:137], v20 offset:0
    ds_read_b64_tr_b16 v[138:139], v20 offset:1024
    ds_read_b128 v[92:95], v17 offset:0
    v_mfma_f32_16x16x32_bf16 v[56:59], v[120:123], v[68:71], v[56:59]
    ds_read_b128 v[96:99], v17 offset:2048
    ds_read_b128 v[100:103], v17 offset:4096
    ds_read_b64_tr_b16 v[140:141], v19 offset:4096
    v_mfma_f32_16x16x32_bf16 v[60:63], v[120:123], v[72:75], v[60:63]
    ds_read_b64_tr_b16 v[142:143], v19 offset:5120
    ds_read_b64_tr_b16 v[144:145], v20 offset:4096
    ds_read_b64_tr_b16 v[146:147], v20 offset:5120
    v_mfma_f32_16x16x32_bf16 v[64:67], v[120:123], v[76:79], v[64:67]
    ds_read_b128 v[104:107], v18 offset:0
    ds_read_b128 v[108:111], v18 offset:2048
    ds_read_b128 v[112:115], v18 offset:4096
    v_mfma_f32_16x16x32_bf16 v[44:47], v[124:127], v[80:83], v[44:47]
    s_movk_i32 s46, 256
    s_add_u32 m0, s45, 102400
    s_nop 0
    v_mfma_f32_16x16x32_bf16 v[48:51], v[124:127], v[84:87], v[48:51]
    buffer_load_dwordx4 v8, s[8:11], s46 offen sc1 lds
    s_add_u32 m0, s45, 106496
    s_nop 0
    v_mfma_f32_16x16x32_bf16 v[52:55], v[124:127], v[88:91], v[52:55]
    buffer_load_dwordx4 v9, s[8:11], s46 offen sc1 lds
    s_add_u32 m0, s45, 110592
    s_nop 0
    v_mfma_f32_16x16x32_bf16 v[56:59], v[128:131], v[80:83], v[56:59]
    buffer_load_dwordx4 v10, s[8:11], s46 offen sc1 lds
    s_mov_b32 s46, 163840
    s_add_u32 m0, s45, 114688
    v_mfma_f32_16x16x32_bf16 v[60:63], v[128:131], v[84:87], v[60:63]
    s_nop 0
    buffer_load_dwordx4 v11, s[12:15], s46 offen lds
    s_add_u32 m0, s45, 118784
    v_mfma_f32_16x16x32_bf16 v[64:67], v[128:131], v[88:91], v[64:67]
    s_nop 0
    buffer_load_dwordx4 v12, s[12:15], s46 offen lds
    s_waitcnt vmcnt(20) lgkmcnt(0)
    s_barrier
    v_mfma_f32_16x16x32_bf16 v[44:47], v[132:135], v[92:95], v[44:47]
    v_add_u32 v17, 20480, v13
    v_add_u32 v19, 20480, v15
    v_add_u32 v18, 20480, v14
    v_mfma_f32_16x16x32_bf16 v[48:51], v[132:135], v[96:99], v[48:51]
    v_add_u32 v20, 20480, v16
    ds_read_b64_tr_b16 v[116:117], v19 offset:0
    ds_read_b64_tr_b16 v[118:119], v19 offset:1024
    v_mfma_f32_16x16x32_bf16 v[52:55], v[132:135], v[100:103], v[52:55]
    ds_read_b64_tr_b16 v[120:121], v20 offset:0
    ds_read_b64_tr_b16 v[122:123], v20 offset:1024
    ds_read_b128 v[68:71], v17 offset:0
    v_mfma_f32_16x16x32_bf16 v[56:59], v[136:139], v[92:95], v[56:59]
    ds_read_b128 v[72:75], v17 offset:2048
    ds_read_b128 v[76:79], v17 offset:4096
    ds_read_b64_tr_b16 v[124:125], v19 offset:4096
    v_mfma_f32_16x16x32_bf16 v[60:63], v[136:139], v[96:99], v[60:63]
    ds_read_b64_tr_b16 v[126:127], v19 offset:5120
    ds_read_b64_tr_b16 v[128:129], v20 offset:4096
    ds_read_b64_tr_b16 v[130:131], v20 offset:5120
    v_mfma_f32_16x16x32_bf16 v[64:67], v[136:139], v[100:103], v[64:67]
    ds_read_b128 v[80:83], v18 offset:0
    ds_read_b128 v[84:87], v18 offset:2048
    ds_read_b128 v[88:91], v18 offset:4096
    v_mfma_f32_16x16x32_bf16 v[44:47], v[140:143], v[104:107], v[44:47]
    s_movk_i32 s46, 384
    s_add_u32 m0, s45, 122880
    s_nop 0
    v_mfma_f32_16x16x32_bf16 v[48:51], v[140:143], v[108:111], v[48:51]
    buffer_load_dwordx4 v8, s[8:11], s46 offen sc1 lds
    s_add_u32 m0, s45, 126976
    s_nop 0
    v_mfma_f32_16x16x32_bf16 v[52:55], v[140:143], v[112:115], v[52:55]
    buffer_load_dwordx4 v9, s[8:11], s46 offen sc1 lds
    s_add_u32 m0, s45, 131072
    s_nop 0
    v_mfma_f32_16x16x32_bf16 v[56:59], v[144:147], v[104:107], v[56:59]
    buffer_load_dwordx4 v10, s[8:11], s46 offen sc1 lds
    s_mov_b32 s46, 245760
    s_add_u32 m0, s45, 135168
    v_mfma_f32_16x16x32_bf16 v[60:63], v[144:147], v[108:111], v[60:63]
    s_nop 0
    buffer_load_dwordx4 v11, s[12:15], s46 offen lds
    s_add_u32 m0, s45, 139264
    v_mfma_f32_16x16x32_bf16 v[64:67], v[144:147], v[112:115], v[64:67]
    s_nop 0
    buffer_load_dwordx4 v12, s[12:15], s46 offen lds
    s_waitcnt vmcnt(20) lgkmcnt(0)
    s_barrier
    v_mfma_f32_16x16x32_bf16 v[44:47], v[116:119], v[68:71], v[44:47]
    v_add_u32 v17, 40960, v13
    v_add_u32 v19, 40960, v15
    v_add_u32 v18, 40960, v14
    v_mfma_f32_16x16x32_bf16 v[48:51], v[116:119], v[72:75], v[48:51]
    v_add_u32 v20, 40960, v16
    ds_read_b64_tr_b16 v[132:133], v19 offset:0
    ds_read_b64_tr_b16 v[134:135], v19 offset:1024
    v_mfma_f32_16x16x32_bf16 v[52:55], v[116:119], v[76:79], v[52:55]
    ds_read_b64_tr_b16 v[136:137], v20 offset:0
    ds_read_b64_tr_b16 v[138:139], v20 offset:1024
    ds_read_b128 v[92:95], v17 offset:0
    v_mfma_f32_16x16x32_bf16 v[56:59], v[120:123], v[68:71], v[56:59]
    ds_read_b128 v[96:99], v17 offset:2048
    ds_read_b128 v[100:103], v17 offset:4096
    ds_read_b64_tr_b16 v[140:141], v19 offset:4096
    v_mfma_f32_16x16x32_bf16 v[60:63], v[120:123], v[72:75], v[60:63]
    ds_read_b64_tr_b16 v[142:143], v19 offset:5120
    ds_read_b64_tr_b16 v[144:145], v20 offset:4096
    ds_read_b64_tr_b16 v[146:147], v20 offset:5120
    v_mfma_f32_16x16x32_bf16 v[64:67], v[120:123], v[76:79], v[64:67]
    ds_read_b128 v[104:107], v18 offset:0
    ds_read_b128 v[108:111], v18 offset:2048
    ds_read_b128 v[112:115], v18 offset:4096
    v_mfma_f32_16x16x32_bf16 v[44:47], v[124:127], v[80:83], v[44:47]
    s_movk_i32 s46, 512
    s_add_u32 m0, s45, 0
    s_nop 0
    v_mfma_f32_16x16x32_bf16 v[48:51], v[124:127], v[84:87], v[48:51]
    buffer_load_dwordx4 v8, s[8:11], s46 offen sc1 lds
    s_add_u32 m0, s45, 4096
    s_nop 0
    v_mfma_f32_16x16x32_bf16 v[52:55], v[124:127], v[88:91], v[52:55]
    buffer_load_dwordx4 v9, s[8:11], s46 offen sc1 lds
    s_add_u32 m0, s45, 8192
    s_nop 0
    v_mfma_f32_16x16x32_bf16 v[56:59], v[128:131], v[80:83], v[56:59]
    buffer_load_dwordx4 v10, s[8:11], s46 offen sc1 lds
    s_mov_b32 s46, 327680
    s_add_u32 m0, s45, 12288
    v_mfma_f32_16x16x32_bf16 v[60:63], v[128:131], v[84:87], v[60:63]
    s_nop 0
    buffer_load_dwordx4 v11, s[12:15], s46 offen lds
    s_add_u32 m0, s45, 16384
    v_mfma_f32_16x16x32_bf16 v[64:67], v[128:131], v[88:91], v[64:67]
    s_nop 0
    buffer_load_dwordx4 v12, s[12:15], s46 offen lds
    s_waitcnt vmcnt(20) lgkmcnt(0)
    s_barrier
    v_mfma_f32_16x16x32_bf16 v[44:47], v[132:135], v[92:95], v[44:47]
    v_add_u32 v17, 61440, v13
    v_add_u32 v19, 61440, v15
    v_add_u32 v18, 61440, v14
    v_mfma_f32_16x16x32_bf16 v[48:51], v[132:135], v[96:99], v[48:51]
    v_add_u32 v20, 61440, v16
    ds_read_b64_tr_b16 v[116:117], v19 offset:0
    ds_read_b64_tr_b16 v[118:119], v19 offset:1024
    v_mfma_f32_16x16x32_bf16 v[52:55], v[132:135], v[100:103], v[52:55]
    ds_read_b64_tr_b16 v[120:121], v20 offset:0
    ds_read_b64_tr_b16 v[122:123], v20 offset:1024
    ds_read_b128 v[68:71], v17 offset:0
    v_mfma_f32_16x16x32_bf16 v[56:59], v[136:139], v[92:95], v[56:59]
    ds_read_b128 v[72:75], v17 offset:2048
    ds_read_b128 v[76:79], v17 offset:4096
    ds_read_b64_tr_b16 v[124:125], v19 offset:4096
    v_mfma_f32_16x16x32_bf16 v[60:63], v[136:139], v[96:99], v[60:63]
    ds_read_b64_tr_b16 v[126:127], v19 offset:5120
    ds_read_b64_tr_b16 v[128:129], v20 offset:4096
    ds_read_b64_tr_b16 v[130:131], v20 offset:5120
    v_mfma_f32_16x16x32_bf16 v[64:67], v[136:139], v[100:103], v[64:67]
    ds_read_b128 v[80:83], v18 offset:0
    ds_read_b128 v[84:87], v18 offset:2048
    ds_read_b128 v[88:91], v18 offset:4096
    v_mfma_f32_16x16x32_bf16 v[44:47], v[140:143], v[104:107], v[44:47]
    s_movk_i32 s46, 640
    s_add_u32 m0, s45, 20480
    s_nop 0
    v_mfma_f32_16x16x32_bf16 v[48:51], v[140:143], v[108:111], v[48:51]
    buffer_load_dwordx4 v8, s[8:11], s46 offen sc1 lds
    s_add_u32 m0, s45, 24576
    s_nop 0
    v_mfma_f32_16x16x32_bf16 v[52:55], v[140:143], v[112:115], v[52:55]
    buffer_load_dwordx4 v9, s[8:11], s46 offen sc1 lds
    s_add_u32 m0, s45, 28672
    s_nop 0
    v_mfma_f32_16x16x32_bf16 v[56:59], v[144:147], v[104:107], v[56:59]
    buffer_load_dwordx4 v10, s[8:11], s46 offen sc1 lds
    s_mov_b32 s46, 409600
    s_add_u32 m0, s45, 32768
    v_mfma_f32_16x16x32_bf16 v[60:63], v[144:147], v[108:111], v[60:63]
    s_nop 0
    buffer_load_dwordx4 v11, s[12:15], s46 offen lds
    s_add_u32 m0, s45, 36864
    v_mfma_f32_16x16x32_bf16 v[64:67], v[144:147], v[112:115], v[64:67]
    s_nop 0
    buffer_load_dwordx4 v12, s[12:15], s46 offen lds
    s_waitcnt vmcnt(20) lgkmcnt(0)
    s_barrier
    v_mfma_f32_16x16x32_bf16 v[44:47], v[116:119], v[68:71], v[44:47]
    v_add_u32 v17, 81920, v13
    v_add_u32 v19, 81920, v15
    v_add_u32 v18, 81920, v14
    v_mfma_f32_16x16x32_bf16 v[48:51], v[116:119], v[72:75], v[48:51]
    v_add_u32 v20, 81920, v16
    ds_read_b64_tr_b16 v[132:133], v19 offset:0
    ds_read_b64_tr_b16 v[134:135], v19 offset:1024
    v_mfma_f32_16x16x32_bf16 v[52:55], v[116:119], v[76:79], v[52:55]
    ds_read_b64_tr_b16 v[136:137], v20 offset:0
    ds_read_b64_tr_b16 v[138:139], v20 offset:1024
    ds_read_b128 v[92:95], v17 offset:0
    v_mfma_f32_16x16x32_bf16 v[56:59], v[120:123], v[68:71], v[56:59]
    ds_read_b128 v[96:99], v17 offset:2048
    ds_read_b128 v[100:103], v17 offset:4096
    ds_read_b64_tr_b16 v[140:141], v19 offset:4096
    v_mfma_f32_16x16x32_bf16 v[60:63], v[120:123], v[72:75], v[60:63]
    ds_read_b64_tr_b16 v[142:143], v19 offset:5120
    ds_read_b64_tr_b16 v[144:145], v20 offset:4096
    ds_read_b64_tr_b16 v[146:147], v20 offset:5120
    v_mfma_f32_16x16x32_bf16 v[64:67], v[120:123], v[76:79], v[64:67]
    ds_read_b128 v[104:107], v18 offset:0
    ds_read_b128 v[108:111], v18 offset:2048
    ds_read_b128 v[112:115], v18 offset:4096
    v_mfma_f32_16x16x32_bf16 v[44:47], v[124:127], v[80:83], v[44:47]
    s_movk_i32 s46, 768
    s_add_u32 m0, s45, 40960
    s_nop 0
    v_mfma_f32_16x16x32_bf16 v[48:51], v[124:127], v[84:87], v[48:51]
    buffer_load_dwordx4 v8, s[8:11], s46 offen sc1 lds
    s_add_u32 m0, s45, 45056
    s_nop 0
    v_mfma_f32_16x16x32_bf16 v[52:55], v[124:127], v[88:91], v[52:55]
    buffer_load_dwordx4 v9, s[8:11], s46 offen sc1 lds
    s_add_u32 m0, s45, 49152
    s_nop 0
    v_mfma_f32_16x16x32_bf16 v[56:59], v[128:131], v[80:83], v[56:59]
    buffer_load_dwordx4 v10, s[8:11], s46 offen sc1 lds
    s_mov_b32 s46, 491520
    s_add_u32 m0, s45, 53248
    v_mfma_f32_16x16x32_bf16 v[60:63], v[128:131], v[84:87], v[60:63]
    s_nop 0
    buffer_load_dwordx4 v11, s[12:15], s46 offen lds
    s_add_u32 m0, s45, 57344
    v_mfma_f32_16x16x32_bf16 v[64:67], v[128:131], v[88:91], v[64:67]
    s_nop 0
    buffer_load_dwordx4 v12, s[12:15], s46 offen lds
    s_waitcnt vmcnt(20) lgkmcnt(0)
    s_barrier
    v_mfma_f32_16x16x32_bf16 v[44:47], v[132:135], v[92:95], v[44:47]
    v_add_u32 v17, 102400, v13
    v_add_u32 v19, 102400, v15
    v_add_u32 v18, 102400, v14
    v_mfma_f32_16x16x32_bf16 v[48:51], v[132:135], v[96:99], v[48:51]
    v_add_u32 v20, 102400, v16
    ds_read_b64_tr_b16 v[116:117], v19 offset:0
    ds_read_b64_tr_b16 v[118:119], v19 offset:1024
    v_mfma_f32_16x16x32_bf16 v[52:55], v[132:135], v[100:103], v[52:55]
    ds_read_b64_tr_b16 v[120:121], v20 offset:0
    ds_read_b64_tr_b16 v[122:123], v20 offset:1024
    ds_read_b128 v[68:71], v17 offset:0
    v_mfma_f32_16x16x32_bf16 v[56:59], v[136:139], v[92:95], v[56:59]
    ds_read_b128 v[72:75], v17 offset:2048
    ds_read_b128 v[76:79], v17 offset:4096
    ds_read_b64_tr_b16 v[124:125], v19 offset:4096
    v_mfma_f32_16x16x32_bf16 v[60:63], v[136:139], v[96:99], v[60:63]
    ds_read_b64_tr_b16 v[126:127], v19 offset:5120
    ds_read_b64_tr_b16 v[128:129], v20 offset:4096
    ds_read_b64_tr_b16 v[130:131], v20 offset:5120
    v_mfma_f32_16x16x32_bf16 v[64:67], v[136:139], v[100:103], v[64:67]
    ds_read_b128 v[80:83], v18 offset:0
    ds_read_b128 v[84:87], v18 offset:2048
    ds_read_b128 v[88:91], v18 offset:4096
    v_mfma_f32_16x16x32_bf16 v[44:47], v[140:143], v[104:107], v[44:47]
    s_movk_i32 s46, 896
    s_add_u32 m0, s45, 61440
    s_nop 0
    v_mfma_f32_16x16x32_bf16 v[48:51], v[140:143], v[108:111], v[48:51]
    buffer_load_dwordx4 v8, s[8:11], s46 offen sc1 lds
    s_add_u32 m0, s45, 65536
    s_nop 0
    v_mfma_f32_16x16x32_bf16 v[52:55], v[140:143], v[112:115], v[52:55]
    buffer_load_dwordx4 v9, s[8:11], s46 offen sc1 lds
    s_add_u32 m0, s45, 69632
    s_nop 0
    v_mfma_f32_16x16x32_bf16 v[56:59], v[144:147], v[104:107], v[56:59]
    buffer_load_dwordx4 v10, s[8:11], s46 offen sc1 lds
    s_mov_b32 s46, 573440
    s_add_u32 m0, s45, 73728
    v_mfma_f32_16x16x32_bf16 v[60:63], v[144:147], v[108:111], v[60:63]
    s_nop 0
    buffer_load_dwordx4 v11, s[12:15], s46 offen lds
    s_add_u32 m0, s45, 77824
    v_mfma_f32_16x16x32_bf16 v[64:67], v[144:147], v[112:115], v[64:67]
    s_nop 0
    buffer_load_dwordx4 v12, s[12:15], s46 offen lds
    s_waitcnt vmcnt(20) lgkmcnt(0)
    s_barrier
    v_mfma_f32_16x16x32_bf16 v[44:47], v[116:119], v[68:71], v[44:47]
    v_add_u32 v17, 122880, v13
    v_add_u32 v19, 122880, v15
    v_add_u32 v18, 122880, v14
    v_mfma_f32_16x16x32_bf16 v[48:51], v[116:119], v[72:75], v[48:51]
    v_add_u32 v20, 122880, v16
    ds_read_b64_tr_b16 v[132:133], v19 offset:0
    ds_read_b64_tr_b16 v[134:135], v19 offset:1024
    v_mfma_f32_16x16x32_bf16 v[52:55], v[116:119], v[76:79], v[52:55]
    ds_read_b64_tr_b16 v[136:137], v20 offset:0
    ds_read_b64_tr_b16 v[138:139], v20 offset:1024
    ds_read_b128 v[92:95], v17 offset:0
    v_mfma_f32_16x16x32_bf16 v[56:59], v[120:123], v[68:71], v[56:59]
    ds_read_b128 v[96:99], v17 offset:2048
    ds_read_b128 v[100:103], v17 offset:4096
    ds_read_b64_tr_b16 v[140:141], v19 offset:4096
    v_mfma_f32_16x16x32_bf16 v[60:63], v[120:123], v[72:75], v[60:63]
    ds_read_b64_tr_b16 v[142:143], v19 offset:5120
    ds_read_b64_tr_b16 v[144:145], v20 offset:4096
    ds_read_b64_tr_b16 v[146:147], v20 offset:5120
    v_mfma_f32_16x16x32_bf16 v[64:67], v[120:123], v[76:79], v[64:67]
    ds_read_b128 v[104:107], v18 offset:0
    ds_read_b128 v[108:111], v18 offset:2048
    ds_read_b128 v[112:115], v18 offset:4096
    v_mfma_f32_16x16x32_bf16 v[44:47], v[124:127], v[80:83], v[44:47]
    s_movk_i32 s46, 1024
    s_add_u32 m0, s45, 81920
    s_nop 0
    v_mfma_f32_16x16x32_bf16 v[48:51], v[124:127], v[84:87], v[48:51]
    buffer_load_dwordx4 v8, s[8:11], s46 offen sc1 lds
    s_add_u32 m0, s45, 86016
    s_nop 0
    v_mfma_f32_16x16x32_bf16 v[52:55], v[124:127], v[88:91], v[52:55]
    buffer_load_dwordx4 v9, s[8:11], s46 offen sc1 lds
    s_add_u32 m0, s45, 90112
    s_nop 0
    v_mfma_f32_16x16x32_bf16 v[56:59], v[128:131], v[80:83], v[56:59]
    buffer_load_dwordx4 v10, s[8:11], s46 offen sc1 lds
    s_mov_b32 s46, 655360
    s_add_u32 m0, s45, 94208
    v_mfma_f32_16x16x32_bf16 v[60:63], v[128:131], v[84:87], v[60:63]
    s_nop 0
    buffer_load_dwordx4 v11, s[12:15], s46 offen lds
    s_add_u32 m0, s45, 98304
    v_mfma_f32_16x16x32_bf16 v[64:67], v[128:131], v[88:91], v[64:67]
    s_nop 0
    buffer_load_dwordx4 v12, s[12:15], s46 offen lds
    s_waitcnt vmcnt(20) lgkmcnt(0)
    s_barrier
    v_mfma_f32_16x16x32_bf16 v[44:47], v[132:135], v[92:95], v[44:47]
    v_add_u32 v17, 0, v13
    v_add_u32 v19, 0, v15
    v_add_u32 v18, 0, v14
    v_mfma_f32_16x16x32_bf16 v[48:51], v[132:135], v[96:99], v[48:51]
    v_add_u32 v20, 0, v16
    ds_read_b64_tr_b16 v[116:117], v19 offset:0
    ds_read_b64_tr_b16 v[118:119], v19 offset:1024
    v_mfma_f32_16x16x32_bf16 v[52:55], v[132:135], v[100:103], v[52:55]
    ds_read_b64_tr_b16 v[120:121], v20 offset:0
    ds_read_b64_tr_b16 v[122:123], v20 offset:1024
    ds_read_b128 v[68:71], v17 offset:0
    v_mfma_f32_16x16x32_bf16 v[56:59], v[136:139], v[92:95], v[56:59]
    ds_read_b128 v[72:75], v17 offset:2048
    ds_read_b128 v[76:79], v17 offset:4096
    ds_read_b64_tr_b16 v[124:125], v19 offset:4096
    v_mfma_f32_16x16x32_bf16 v[60:63], v[136:139], v[96:99], v[60:63]
    ds_read_b64_tr_b16 v[126:127], v19 offset:5120
    ds_read_b64_tr_b16 v[128:129], v20 offset:4096
    ds_read_b64_tr_b16 v[130:131], v20 offset:5120
    v_mfma_f32_16x16x32_bf16 v[64:67], v[136:139], v[100:103], v[64:67]
    ds_read_b128 v[80:83], v18 offset:0
    ds_read_b128 v[84:87], v18 offset:2048
    ds_read_b128 v[88:91], v18 offset:4096
    v_mfma_f32_16x16x32_bf16 v[44:47], v[140:143], v[104:107], v[44:47]
    s_movk_i32 s46, 1152
    s_add_u32 m0, s45, 102400
    s_nop 0
    v_mfma_f32_16x16x32_bf16 v[48:51], v[140:143], v[108:111], v[48:51]
    buffer_load_dwordx4 v8, s[8:11], s46 offen sc1 lds
    s_add_u32 m0, s45, 106496
    s_nop 0
    v_mfma_f32_16x16x32_bf16 v[52:55], v[140:143], v[112:115], v[52:55]
    buffer_load_dwordx4 v9, s[8:11], s46 offen sc1 lds
    s_add_u32 m0, s45, 110592
    s_nop 0
    v_mfma_f32_16x16x32_bf16 v[56:59], v[144:147], v[104:107], v[56:59]
    buffer_load_dwordx4 v10, s[8:11], s46 offen sc1 lds
    s_mov_b32 s46, 737280
    s_add_u32 m0, s45, 114688
    v_mfma_f32_16x16x32_bf16 v[60:63], v[144:147], v[108:111], v[60:63]
    s_nop 0
    buffer_load_dwordx4 v11, s[12:15], s46 offen lds
    s_add_u32 m0, s45, 118784
    v_mfma_f32_16x16x32_bf16 v[64:67], v[144:147], v[112:115], v[64:67]
    s_nop 0
    buffer_load_dwordx4 v12, s[12:15], s46 offen lds
    s_waitcnt vmcnt(20) lgkmcnt(0)
    s_barrier
    v_mfma_f32_16x16x32_bf16 v[44:47], v[116:119], v[68:71], v[44:47]
    v_add_u32 v17, 20480, v13
    v_add_u32 v19, 20480, v15
    v_mfma_f32_16x16x32_bf16 v[48:51], v[116:119], v[72:75], v[48:51]
    v_add_u32 v18, 20480, v14
    v_mfma_f32_16x16x32_bf16 v[52:55], v[116:119], v[76:79], v[52:55]
    v_add_u32 v20, 20480, v16
    ds_read_b64_tr_b16 v[132:133], v19 offset:0
    v_mfma_f32_16x16x32_bf16 v[56:59], v[120:123], v[68:71], v[56:59]
    ds_read_b64_tr_b16 v[134:135], v19 offset:1024
    v_mfma_f32_16x16x32_bf16 v[60:63], v[120:123], v[72:75], v[60:63]
    ds_read_b64_tr_b16 v[136:137], v20 offset:0
    ds_read_b64_tr_b16 v[138:139], v20 offset:1024
    v_mfma_f32_16x16x32_bf16 v[64:67], v[120:123], v[76:79], v[64:67]
    ds_read_b128 v[92:95], v17 offset:0
    v_mfma_f32_16x16x32_bf16 v[44:47], v[124:127], v[80:83], v[44:47]
    ds_read_b128 v[96:99], v17 offset:2048
    ds_read_b128 v[100:103], v17 offset:4096
    v_mfma_f32_16x16x32_bf16 v[48:51], v[124:127], v[84:87], v[48:51]
    ds_read_b64_tr_b16 v[140:141], v19 offset:4096
    v_mfma_f32_16x16x32_bf16 v[52:55], v[124:127], v[88:91], v[52:55]
    ds_read_b64_tr_b16 v[142:143], v19 offset:5120
    ds_read_b64_tr_b16 v[144:145], v20 offset:4096
    v_mfma_f32_16x16x32_bf16 v[56:59], v[128:131], v[80:83], v[56:59]
    ds_read_b64_tr_b16 v[146:147], v20 offset:5120
    v_mfma_f32_16x16x32_bf16 v[60:63], v[128:131], v[84:87], v[60:63]
    ds_read_b128 v[104:107], v18 offset:0
    ds_read_b128 v[108:111], v18 offset:2048
    v_mfma_f32_16x16x32_bf16 v[64:67], v[128:131], v[88:91], v[64:67]
    ds_read_b128 v[112:115], v18 offset:4096
    s_waitcnt vmcnt(15) lgkmcnt(0)
    s_barrier
    v_mfma_f32_16x16x32_bf16 v[44:47], v[132:135], v[92:95], v[44:47]
    v_add_u32 v17, 40960, v13
    v_add_u32 v19, 40960, v15
    v_mfma_f32_16x16x32_bf16 v[48:51], v[132:135], v[96:99], v[48:51]
    v_add_u32 v18, 40960, v14
    v_mfma_f32_16x16x32_bf16 v[52:55], v[132:135], v[100:103], v[52:55]
    v_add_u32 v20, 40960, v16
    ds_read_b64_tr_b16 v[116:117], v19 offset:0
    v_mfma_f32_16x16x32_bf16 v[56:59], v[136:139], v[92:95], v[56:59]
    ds_read_b64_tr_b16 v[118:119], v19 offset:1024
    v_mfma_f32_16x16x32_bf16 v[60:63], v[136:139], v[96:99], v[60:63]
    ds_read_b64_tr_b16 v[120:121], v20 offset:0
    ds_read_b64_tr_b16 v[122:123], v20 offset:1024
    v_mfma_f32_16x16x32_bf16 v[64:67], v[136:139], v[100:103], v[64:67]
    ds_read_b128 v[68:71], v17 offset:0
    v_mfma_f32_16x16x32_bf16 v[44:47], v[140:143], v[104:107], v[44:47]
    ds_read_b128 v[72:75], v17 offset:2048
    ds_read_b128 v[76:79], v17 offset:4096
    v_mfma_f32_16x16x32_bf16 v[48:51], v[140:143], v[108:111], v[48:51]
    ds_read_b64_tr_b16 v[124:125], v19 offset:4096
    v_mfma_f32_16x16x32_bf16 v[52:55], v[140:143], v[112:115], v[52:55]
    ds_read_b64_tr_b16 v[126:127], v19 offset:5120
    ds_read_b64_tr_b16 v[128:129], v20 offset:4096
    v_mfma_f32_16x16x32_bf16 v[56:59], v[144:147], v[104:107], v[56:59]
    ds_read_b64_tr_b16 v[130:131], v20 offset:5120
    v_mfma_f32_16x16x32_bf16 v[60:63], v[144:147], v[108:111], v[60:63]
    ds_read_b128 v[80:83], v18 offset:0
    ds_read_b128 v[84:87], v18 offset:2048
    v_mfma_f32_16x16x32_bf16 v[64:67], v[144:147], v[112:115], v[64:67]
    ds_read_b128 v[88:91], v18 offset:4096
    s_waitcnt vmcnt(10) lgkmcnt(0)
    s_barrier
    v_mfma_f32_16x16x32_bf16 v[44:47], v[116:119], v[68:71], v[44:47]
    v_add_u32 v17, 61440, v13
    v_add_u32 v19, 61440, v15
    v_mfma_f32_16x16x32_bf16 v[48:51], v[116:119], v[72:75], v[48:51]
    v_add_u32 v18, 61440, v14
    v_mfma_f32_16x16x32_bf16 v[52:55], v[116:119], v[76:79], v[52:55]
    v_add_u32 v20, 61440, v16
    ds_read_b64_tr_b16 v[132:133], v19 offset:0
    v_mfma_f32_16x16x32_bf16 v[56:59], v[120:123], v[68:71], v[56:59]
    ds_read_b64_tr_b16 v[134:135], v19 offset:1024
    v_mfma_f32_16x16x32_bf16 v[60:63], v[120:123], v[72:75], v[60:63]
    ds_read_b64_tr_b16 v[136:137], v20 offset:0
    ds_read_b64_tr_b16 v[138:139], v20 offset:1024
    v_mfma_f32_16x16x32_bf16 v[64:67], v[120:123], v[76:79], v[64:67]
    ds_read_b128 v[92:95], v17 offset:0
    v_mfma_f32_16x16x32_bf16 v[44:47], v[124:127], v[80:83], v[44:47]
    ds_read_b128 v[96:99], v17 offset:2048
    ds_read_b128 v[100:103], v17 offset:4096
    v_mfma_f32_16x16x32_bf16 v[48:51], v[124:127], v[84:87], v[48:51]
    ds_read_b64_tr_b16 v[140:141], v19 offset:4096
    v_mfma_f32_16x16x32_bf16 v[52:55], v[124:127], v[88:91], v[52:55]
    ds_read_b64_tr_b16 v[142:143], v19 offset:5120
    ds_read_b64_tr_b16 v[144:145], v20 offset:4096
    v_mfma_f32_16x16x32_bf16 v[56:59], v[128:131], v[80:83], v[56:59]
    ds_read_b64_tr_b16 v[146:147], v20 offset:5120
    v_mfma_f32_16x16x32_bf16 v[60:63], v[128:131], v[84:87], v[60:63]
    ds_read_b128 v[104:107], v18 offset:0
    ds_read_b128 v[108:111], v18 offset:2048
    v_mfma_f32_16x16x32_bf16 v[64:67], v[128:131], v[88:91], v[64:67]
    ds_read_b128 v[112:115], v18 offset:4096
    s_waitcnt vmcnt(5) lgkmcnt(0)
    s_barrier
    v_mfma_f32_16x16x32_bf16 v[44:47], v[132:135], v[92:95], v[44:47]
    v_add_u32 v17, 81920, v13
    v_add_u32 v19, 81920, v15
    v_mfma_f32_16x16x32_bf16 v[48:51], v[132:135], v[96:99], v[48:51]
    v_add_u32 v18, 81920, v14
    v_mfma_f32_16x16x32_bf16 v[52:55], v[132:135], v[100:103], v[52:55]
    v_add_u32 v20, 81920, v16
    ds_read_b64_tr_b16 v[116:117], v19 offset:0
    v_mfma_f32_16x16x32_bf16 v[56:59], v[136:139], v[92:95], v[56:59]
    ds_read_b64_tr_b16 v[118:119], v19 offset:1024
    v_mfma_f32_16x16x32_bf16 v[60:63], v[136:139], v[96:99], v[60:63]
    ds_read_b64_tr_b16 v[120:121], v20 offset:0
    ds_read_b64_tr_b16 v[122:123], v20 offset:1024
    v_mfma_f32_16x16x32_bf16 v[64:67], v[136:139], v[100:103], v[64:67]
    ds_read_b128 v[68:71], v17 offset:0
    v_mfma_f32_16x16x32_bf16 v[44:47], v[140:143], v[104:107], v[44:47]
    ds_read_b128 v[72:75], v17 offset:2048
    ds_read_b128 v[76:79], v17 offset:4096
    v_mfma_f32_16x16x32_bf16 v[48:51], v[140:143], v[108:111], v[48:51]
    ds_read_b64_tr_b16 v[124:125], v19 offset:4096
    v_mfma_f32_16x16x32_bf16 v[52:55], v[140:143], v[112:115], v[52:55]
    ds_read_b64_tr_b16 v[126:127], v19 offset:5120
    ds_read_b64_tr_b16 v[128:129], v20 offset:4096
    v_mfma_f32_16x16x32_bf16 v[56:59], v[144:147], v[104:107], v[56:59]
    ds_read_b64_tr_b16 v[130:131], v20 offset:5120
    v_mfma_f32_16x16x32_bf16 v[60:63], v[144:147], v[108:111], v[60:63]
    ds_read_b128 v[80:83], v18 offset:0
    ds_read_b128 v[84:87], v18 offset:2048
    v_mfma_f32_16x16x32_bf16 v[64:67], v[144:147], v[112:115], v[64:67]
    ds_read_b128 v[88:91], v18 offset:4096
    s_waitcnt vmcnt(0) lgkmcnt(0)
    s_barrier
    v_mfma_f32_16x16x32_bf16 v[44:47], v[116:119], v[68:71], v[44:47]
    v_add_u32 v17, 102400, v13
    v_add_u32 v19, 102400, v15
    v_mfma_f32_16x16x32_bf16 v[48:51], v[116:119], v[72:75], v[48:51]
    v_add_u32 v18, 102400, v14
    v_mfma_f32_16x16x32_bf16 v[52:55], v[116:119], v[76:79], v[52:55]
    v_add_u32 v20, 102400, v16
    ds_read_b64_tr_b16 v[132:133], v19 offset:0
    v_mfma_f32_16x16x32_bf16 v[56:59], v[120:123], v[68:71], v[56:59]
    ds_read_b64_tr_b16 v[134:135], v19 offset:1024
    v_mfma_f32_16x16x32_bf16 v[60:63], v[120:123], v[72:75], v[60:63]
    ds_read_b64_tr_b16 v[136:137], v20 offset:0
    ds_read_b64_tr_b16 v[138:139], v20 offset:1024
    v_mfma_f32_16x16x32_bf16 v[64:67], v[120:123], v[76:79], v[64:67]
    ds_read_b128 v[92:95], v17 offset:0
    v_mfma_f32_16x16x32_bf16 v[44:47], v[124:127], v[80:83], v[44:47]
    ds_read_b128 v[96:99], v17 offset:2048
    ds_read_b128 v[100:103], v17 offset:4096
    v_mfma_f32_16x16x32_bf16 v[48:51], v[124:127], v[84:87], v[48:51]
    ds_read_b64_tr_b16 v[140:141], v19 offset:4096
    v_mfma_f32_16x16x32_bf16 v[52:55], v[124:127], v[88:91], v[52:55]
    ds_read_b64_tr_b16 v[142:143], v19 offset:5120
    ds_read_b64_tr_b16 v[144:145], v20 offset:4096
    v_mfma_f32_16x16x32_bf16 v[56:59], v[128:131], v[80:83], v[56:59]
    ds_read_b64_tr_b16 v[146:147], v20 offset:5120
    v_mfma_f32_16x16x32_bf16 v[60:63], v[128:131], v[84:87], v[60:63]
    ds_read_b128 v[104:107], v18 offset:0
    ds_read_b128 v[108:111], v18 offset:2048
    v_mfma_f32_16x16x32_bf16 v[64:67], v[128:131], v[88:91], v[64:67]
    ds_read_b128 v[112:115], v18 offset:4096
    s_waitcnt lgkmcnt(0)
    v_mfma_f32_16x16x32_bf16 v[44:47], v[132:135], v[92:95], v[44:47]
    v_mfma_f32_16x16x32_bf16 v[48:51], v[132:135], v[96:99], v[48:51]
    v_mfma_f32_16x16x32_bf16 v[52:55], v[132:135], v[100:103], v[52:55]
    v_mfma_f32_16x16x32_bf16 v[56:59], v[136:139], v[92:95], v[56:59]
    v_mfma_f32_16x16x32_bf16 v[60:63], v[136:139], v[96:99], v[60:63]
    v_mfma_f32_16x16x32_bf16 v[64:67], v[136:139], v[100:103], v[64:67]
    v_mfma_f32_16x16x32_bf16 v[44:47], v[140:143], v[104:107], v[44:47]
    v_mfma_f32_16x16x32_bf16 v[48:51], v[140:143], v[108:111], v[48:51]
    v_mfma_f32_16x16x32_bf16 v[52:55], v[140:143], v[112:115], v[52:55]
    v_mfma_f32_16x16x32_bf16 v[56:59], v[144:147], v[104:107], v[56:59]
    v_mfma_f32_16x16x32_bf16 v[60:63], v[144:147], v[108:111], v[60:63]
    v_mfma_f32_16x16x32_bf16 v[64:67], v[144:147], v[112:115], v[64:67]
    s_waitcnt vmcnt(0)
    s_nop 7
    v_lshlrev_b32 v4, 16, v26
    v_and_b32 v5, 0xffff0000, v26
    v_lshlrev_b32 v6, 16, v38
    v_and_b32 v7, 0xffff0000, v38
    v_add_f32 v4, v4, v6
    v_add_f32 v5, v5, v7
    v_add_f32 v44, v44, v4
    v_add_f32 v45, v45, v5
    v_lshlrev_b32 v4, 16, v27
    v_and_b32 v5, 0xffff0000, v27
    v_lshlrev_b32 v6, 16, v39
    v_and_b32 v7, 0xffff0000, v39
    v_add_f32 v4, v4, v6
    v_add_f32 v5, v5, v7
    v_add_f32 v46, v46, v4
    v_add_f32 v47, v47, v5
    v_cvt_pk_bf16_f32 v44, v44, v45
    v_cvt_pk_bf16_f32 v45, v46, v47
    buffer_store_dwordx2 v[44:45], v21, s[20:23], 0 offen offset:0
    v_lshlrev_b32 v4, 16, v30
    v_and_b32 v5, 0xffff0000, v30
    v_lshlrev_b32 v6, 16, v38
    v_and_b32 v7, 0xffff0000, v38
    v_add_f32 v4, v4, v6
    v_add_f32 v5, v5, v7
    v_add_f32 v48, v48, v4
    v_add_f32 v49, v49, v5
    v_lshlrev_b32 v4, 16, v31
    v_and_b32 v5, 0xffff0000, v31
    v_lshlrev_b32 v6, 16, v39
    v_and_b32 v7, 0xffff0000, v39
    v_add_f32 v4, v4, v6
    v_add_f32 v5, v5, v7
    v_add_f32 v50, v50, v4
    v_add_f32 v51, v51, v5
    v_cvt_pk_bf16_f32 v48, v48, v49
    v_cvt_pk_bf16_f32 v49, v50, v51
    buffer_store_dwordx2 v[48:49], v22, s[20:23], 0 offen offset:0
    v_lshlrev_b32 v4, 16, v34
    v_and_b32 v5, 0xffff0000, v34
    v_lshlrev_b32 v6, 16, v38
    v_and_b32 v7, 0xffff0000, v38
    v_add_f32 v4, v4, v6
    v_add_f32 v5, v5, v7
    v_add_f32 v52, v52, v4
    v_add_f32 v53, v53, v5
    v_lshlrev_b32 v4, 16, v35
    v_and_b32 v5, 0xffff0000, v35
    v_lshlrev_b32 v6, 16, v39
    v_and_b32 v7, 0xffff0000, v39
    v_add_f32 v4, v4, v6
    v_add_f32 v5, v5, v7
    v_add_f32 v54, v54, v4
    v_add_f32 v55, v55, v5
    v_cvt_pk_bf16_f32 v52, v52, v53
    v_cvt_pk_bf16_f32 v53, v54, v55
    buffer_store_dwordx2 v[52:53], v23, s[20:23], 0 offen offset:0
    v_lshlrev_b32 v4, 16, v28
    v_and_b32 v5, 0xffff0000, v28
    v_lshlrev_b32 v6, 16, v40
    v_and_b32 v7, 0xffff0000, v40
    v_add_f32 v4, v4, v6
    v_add_f32 v5, v5, v7
    v_add_f32 v56, v56, v4
    v_add_f32 v57, v57, v5
    v_lshlrev_b32 v4, 16, v29
    v_and_b32 v5, 0xffff0000, v29
    v_lshlrev_b32 v6, 16, v41
    v_and_b32 v7, 0xffff0000, v41
    v_add_f32 v4, v4, v6
    v_add_f32 v5, v5, v7
    v_add_f32 v58, v58, v4
    v_add_f32 v59, v59, v5
    v_cvt_pk_bf16_f32 v56, v56, v57
    v_cvt_pk_bf16_f32 v57, v58, v59
    buffer_store_dwordx2 v[56:57], v21, s[20:23], 0 offen offset:32
    v_lshlrev_b32 v4, 16, v32
    v_and_b32 v5, 0xffff0000, v32
    v_lshlrev_b32 v6, 16, v40
    v_and_b32 v7, 0xffff0000, v40
    v_add_f32 v4, v4, v6
    v_add_f32 v5, v5, v7
    v_add_f32 v60, v60, v4
    v_add_f32 v61, v61, v5
    v_lshlrev_b32 v4, 16, v33
    v_and_b32 v5, 0xffff0000, v33
    v_lshlrev_b32 v6, 16, v41
    v_and_b32 v7, 0xffff0000, v41
    v_add_f32 v4, v4, v6
    v_add_f32 v5, v5, v7
    v_add_f32 v62, v62, v4
    v_add_f32 v63, v63, v5
    v_cvt_pk_bf16_f32 v60, v60, v61
    v_cvt_pk_bf16_f32 v61, v62, v63
    buffer_store_dwordx2 v[60:61], v22, s[20:23], 0 offen offset:32
    v_lshlrev_b32 v4, 16, v36
    v_and_b32 v5, 0xffff0000, v36
    v_lshlrev_b32 v6, 16, v40
    v_and_b32 v7, 0xffff0000, v40
    v_add_f32 v4, v4, v6
    v_add_f32 v5, v5, v7
    v_add_f32 v64, v64, v4
    v_add_f32 v65, v65, v5
    v_lshlrev_b32 v4, 16, v37
    v_and_b32 v5, 0xffff0000, v37
    v_lshlrev_b32 v6, 16, v41
    v_and_b32 v7, 0xffff0000, v41
    v_add_f32 v4, v4, v6
    v_add_f32 v5, v5, v7
    v_add_f32 v66, v66, v4
    v_add_f32 v67, v67, v5
    v_cvt_pk_bf16_f32 v64, v64, v65
    v_cvt_pk_bf16_f32 v65, v66, v67
    buffer_store_dwordx2 v[64:65], v23, s[20:23], 0 offen offset:32
K1_END:
    s_endpgm
.section .rodata,"a"
.p2align 6
.amdhsa_kernel parallel_sum__sliding_local_dilated__mixer_channel_mlp__prompt_kernel
  .amdhsa_next_free_vgpr 244
  .amdhsa_next_free_sgpr 102
  .amdhsa_accum_offset 244
  .amdhsa_group_segment_fixed_size 0
  .amdhsa_kernarg_size 88
  .amdhsa_user_sgpr_count 2
  .amdhsa_user_sgpr_kernarg_segment_ptr 1
  .amdhsa_system_sgpr_workgroup_id_x 1
.end_amdhsa_kernel
```
